```python
import torch

def _softmax(x, axis=-1):
    return torch.softmax(x, dim=axis)
def _gelu(x):
    return torch.nn.functional.gelu(x, approximate="tanh")
def _silu(x):
    return torch.nn.functional.silu(x)
def _sigmoid(x):
    return torch.sigmoid(x)
def _layernorm(x, axis=-1, eps=1e-5):
    m = x.mean(dim=axis, keepdim=True)
    v = x.var(dim=axis, keepdim=True, unbiased=False)
    return (x - m) / torch.sqrt(v + eps)
def _scatter_add(tgt, idx, src, axis=0):
    return tgt.clone().index_add_(axis, idx, src)
def _segment_sum(src, seg, n):
    out = torch.zeros((n,) + src.shape[1:], dtype=src.dtype)
    return out.index_add_(0, seg, src)
def _pad(x, pw):
    flat = tuple(v for pair in reversed(pw) for v in pair)
    return torch.nn.functional.pad(x, flat)

kernel_name = 'interleave_layers__spectral_gfnet__glu_gated_bilinear__prompt'

def setup_inputs():

    _w = (lambda a: (lambda t: t.to(torch.bfloat16) if t.is_floating_point() else t)(torch.as_tensor(a)))
    def _A_setup():
        B, S, D = 1, 2048, 1024
        Df = D // 2 + 1
        return {
            "x": _w((lambda *s: torch.randn(*s, dtype=torch.bfloat16) * 0.05)(B, S, D)),
            "w_r": _w((lambda *s: torch.randn(*s, dtype=torch.bfloat16) * 0.4)(S, Df) * 0.02),
            "w_i": _w((lambda *s: torch.randn(*s, dtype=torch.bfloat16) * 0.4)(S, Df) * 0.02),
        }
    _A_in = _A_setup()

    def _B_setup():
        B, S, D, F = 1, 2048, 1024, 3584
        return {
            "x": _w((lambda *s: torch.randn(*s, dtype=torch.bfloat16) * 0.05)(B, S, D)),
            "w_gate": _w((lambda *s: torch.randn(*s, dtype=torch.bfloat16) * 0.2)(D, F) * (D ** -0.5)),
            "w_up": _w((lambda *s: torch.randn(*s, dtype=torch.bfloat16) * 0.2)(D, F) * (D ** -0.5)),
            "w_down": _w((lambda *s: torch.randn(*s, dtype=torch.bfloat16) * 0.2)(F, D) * (F ** -0.5)),
        }
    _B_in = _B_setup()

    return {
        "A_x": _A_in["x"],
        "A_w_r": _A_in["w_r"],
        "A_w_i": _A_in["w_i"],
        "B_x": _B_in["x"],
        "B_w_gate": _B_in["w_gate"],
        "B_w_up": _B_in["w_up"],
        "B_w_down": _B_in["w_down"],
    }

def reference(A_x, A_w_r, A_w_i, B_x, B_w_gate, B_w_up, B_w_down):
    def _A_ref(x, w_r, w_i):
        B, S, D = x.shape
        X = (lambda x, axes=(-2,-1): torch.fft.rfft2(x.float(), dim=axes))(x, axes=(-2, -1))
        W = w_r + 1j * w_i
        X = X * W
        y = (lambda x, s, axes=(-2,-1): torch.fft.irfft2(x, s=s, dim=axes).to(torch.bfloat16))(X, (S, D), axes=(-2, -1))
        return y

    def _B_ref(x, w_gate, w_up, w_down):
        g = torch.einsum("bsd,df->bsf", x, w_gate)
        u = torch.einsum("bsd,df->bsf", x, w_up)
        h = g * u
        return torch.einsum("bsf,fd->bsd", h, w_down)

    x = A_x
    x = x + _A_ref(_layernorm(x, axis=-1), A_w_r, A_w_i)
    x = x + _B_ref(_layernorm(x, axis=-1), B_w_gate, B_w_up, B_w_down)
    x = x + _A_ref(_layernorm(x, axis=-1), A_w_r, A_w_i)
    x = x + _B_ref(_layernorm(x, axis=-1), B_w_gate, B_w_up, B_w_down)
    return x
```

```asm
; @launch kernel=k1_kernel grid=(256,1,1) block=(256,1,1) lds=36352
; @launch kernel=m_kernel grid=(256,1,1) block=(256,1,1) lds=163840
.amdgcn_target "amdgcn-amd-amdhsa--gfx950"
.text
.globl k1_kernel
.p2align 8
.type k1_kernel,@function
k1_kernel:
s_getpc_b64 s[60:61]
L_k1_pc:
s_add_u32 s60, s60, L_f-L_k1_pc
s_addc_u32 s61, s61, (L_f-L_k1_pc)>>32
s_mov_b32 s62, L_f_last-L_f
s_mov_b32 s58, 0
s_mov_b32 s3, 5242880
s_mov_b32 s4, 0
s_mov_b32 s5, 10485760
s_mov_b32 s28, 15728640
s_mov_b32 s55, 19922944
L_k1:
s_cmp_ge_u32 s2, 256
s_cbranch_scc1 L_k1_end
s_load_dwordx4 s[36:39], s[0:1], 0
s_load_dwordx2 s[40:41], s[0:1], 16
s_load_dwordx2 s[6:7], s[0:1], 72
v_lshrrev_b32 v3, 6, v0
v_and_b32 v2, 63, v0
v_readfirstlane_b32 s29, v3
v_lshlrev_b32 v5, 4, v2
s_and_b32 s94, s2, 1
s_lshl_b32 s94, s94, 2
s_bfe_u32 s30, s2, 0x20003
s_add_u32 s94, s94, s30
s_lshl_b32 s94, s94, 2
s_bfe_u32 s30, s2, 0x20001
s_add_u32 s94, s94, s30
s_lshl_b32 s94, s94, 3
s_lshr_b32 s30, s2, 5
s_add_u32 s94, s94, s30
s_and_b32 s34, s94, 31
s_lshr_b32 s31, s94, 5
s_lshl_b32 s31, s31, 6
s_add_u32 s34, s34, s31
s_lshr_b32 s31, s29, 1
s_lshl_b32 s31, s31, 5
s_add_u32 s34, s34, s31
s_and_b32 s31, s29, 1
s_lshl_b32 s31, s31, 9
s_add_u32 s34, s34, s31
s_lshl_b32 s34, s34, 11
s_add_u32 s35, s34, 2097152
v_lshrrev_b32 v3, 4, v2
v_and_b32 v4, 15, v2
v_mul_u32_u24 v239, 2052, v3
v_lshl_add_u32 v239, v4, 3, v239
s_and_b32 s30, s2, 1
s_lshl_b32 s30, s30, 2
s_add_u32 s30, s30, s29
s_lshl_b32 s30, s30, 6
s_add_u32 s30, s30, 1
s_lshr_b32 s31, s2, 5
s_bfe_u32 s32, s2, 0x30002
s_bfe_u32 s33, s2, 0x10001
s_lshl_b32 s50, s31, 5
s_add_u32 s50, s50, s32
s_lshl_b32 s50, s50, 3
s_add_u32 s50, s50, s33
s_mul_i32 s50, s50, 1026
s_lshl_b32 s51, s30, 1
s_add_u32 s50, s50, s51
s_and_b32 s52, s50, 2
s_sub_u32 s50, s50, s52
s_lshl_b32 s51, s31, 3
s_add_u32 s51, s51, s32
s_lshl_b32 s51, s51, 6
s_lshl_b32 s33, s33, 12
s_add_u32 s51, s51, s33
v_lshl_add_u32 v4, v4, 2, s30
v_add_u32 v6, 0, v4
v_and_b32 v240, 255, v6
v_mul_u32_u24 v240, 16512, v240
v_bfe_u32 v6, v6, 8, 1
v_lshl_add_u32 v240, v6, 13, v240
v_lshl_add_u32 v240, v3, 4, v240
v_add_u32 v6, 1, v4
v_and_b32 v241, 255, v6
v_mul_u32_u24 v241, 16512, v241
v_bfe_u32 v6, v6, 8, 1
v_lshl_add_u32 v241, v6, 13, v241
v_lshl_add_u32 v241, v3, 4, v241
v_add_u32 v6, 2, v4
v_and_b32 v242, 255, v6
v_mul_u32_u24 v242, 16512, v242
v_bfe_u32 v6, v6, 8, 1
v_lshl_add_u32 v242, v6, 13, v242
v_lshl_add_u32 v242, v3, 4, v242
v_add_u32 v6, 3, v4
v_and_b32 v243, 255, v6
v_mul_u32_u24 v243, 16512, v243
v_bfe_u32 v6, v6, 8, 1
v_lshl_add_u32 v243, v6, 13, v243
v_lshl_add_u32 v243, v3, 4, v243
v_and_b32 v8, 31, v2
v_cvt_f32_u32 v8, v8
v_mul_f32 v8, 0x3d000000, v8
v_lshrrev_b32 v9, 5, v2
v_cvt_f32_u32 v9, v9
v_mul_f32 v9, 4.0, v9
v_mul_f32 v9, v9, v8
v_cos_f32 v32, v9
v_sin_f32 v48, v9
v_fmamk_f32 v7, v8, 0x3f800000, v9
v_cos_f32 v33, v7
v_sin_f32 v49, v7
v_fmamk_f32 v6, v8, 0x40000000, v9
v_cos_f32 v34, v6
v_sin_f32 v50, v6
v_fmamk_f32 v7, v8, 0x40400000, v9
v_cos_f32 v35, v7
v_sin_f32 v51, v7
v_fmamk_f32 v6, v8, 0x41000000, v9
v_cos_f32 v36, v6
v_sin_f32 v52, v6
v_fmamk_f32 v7, v8, 0x41100000, v9
v_cos_f32 v37, v7
v_sin_f32 v53, v7
v_fmamk_f32 v6, v8, 0x41200000, v9
v_cos_f32 v38, v6
v_sin_f32 v54, v6
v_fmamk_f32 v7, v8, 0x41300000, v9
v_cos_f32 v39, v7
v_sin_f32 v55, v7
v_fmamk_f32 v6, v8, 0x41800000, v9
v_cos_f32 v40, v6
v_sin_f32 v56, v6
v_fmamk_f32 v7, v8, 0x41880000, v9
v_cos_f32 v41, v7
v_sin_f32 v57, v7
v_fmamk_f32 v6, v8, 0x41900000, v9
v_cos_f32 v42, v6
v_sin_f32 v58, v6
v_fmamk_f32 v7, v8, 0x41980000, v9
v_cos_f32 v43, v7
v_sin_f32 v59, v7
v_fmamk_f32 v6, v8, 0x41c00000, v9
v_cos_f32 v44, v6
v_sin_f32 v60, v6
v_fmamk_f32 v7, v8, 0x41c80000, v9
v_cos_f32 v45, v7
v_sin_f32 v61, v7
v_fmamk_f32 v6, v8, 0x41d00000, v9
v_cos_f32 v46, v6
v_sin_f32 v62, v6
v_fmamk_f32 v7, v8, 0x41d80000, v9
v_cos_f32 v47, v7
v_sin_f32 v63, v7
v_cvt_pk_bf16_f32 v64, v32, v33
v_cvt_pk_bf16_f32 v72, v48, v49
v_cvt_pk_bf16_f32 v80, -v48, -v49
v_cvt_pk_bf16_f32 v65, v34, v35
v_cvt_pk_bf16_f32 v73, v50, v51
v_cvt_pk_bf16_f32 v81, -v50, -v51
v_cvt_pk_bf16_f32 v66, v36, v37
v_cvt_pk_bf16_f32 v74, v52, v53
v_cvt_pk_bf16_f32 v82, -v52, -v53
v_cvt_pk_bf16_f32 v67, v38, v39
v_cvt_pk_bf16_f32 v75, v54, v55
v_cvt_pk_bf16_f32 v83, -v54, -v55
v_cvt_pk_bf16_f32 v68, v40, v41
v_cvt_pk_bf16_f32 v76, v56, v57
v_cvt_pk_bf16_f32 v84, -v56, -v57
v_cvt_pk_bf16_f32 v69, v42, v43
v_cvt_pk_bf16_f32 v77, v58, v59
v_cvt_pk_bf16_f32 v85, -v58, -v59
v_cvt_pk_bf16_f32 v70, v44, v45
v_cvt_pk_bf16_f32 v78, v60, v61
v_cvt_pk_bf16_f32 v86, -v60, -v61
v_cvt_pk_bf16_f32 v71, v46, v47
v_cvt_pk_bf16_f32 v79, v62, v63
v_cvt_pk_bf16_f32 v87, -v62, -v63
v_mul_f32 v8, 0x3d000000, v8
v_mul_f32 v9, 0x3d000000, v9
v_cos_f32 v88, v9
v_sin_f32 v104, v9
v_fmamk_f32 v7, v8, 0x3f800000, v9
v_cos_f32 v89, v7
v_sin_f32 v105, v7
v_fmamk_f32 v6, v8, 0x40000000, v9
v_cos_f32 v90, v6
v_sin_f32 v106, v6
v_fmamk_f32 v7, v8, 0x40400000, v9
v_cos_f32 v91, v7
v_sin_f32 v107, v7
v_fmamk_f32 v6, v8, 0x41000000, v9
v_cos_f32 v92, v6
v_sin_f32 v108, v6
v_fmamk_f32 v7, v8, 0x41100000, v9
v_cos_f32 v93, v7
v_sin_f32 v109, v7
v_fmamk_f32 v6, v8, 0x41200000, v9
v_cos_f32 v94, v6
v_sin_f32 v110, v6
s_waitcnt lgkmcnt(0)
s_mov_b32 s8, s36
s_and_b32 s9, s37, 0xffff
s_mov_b32 s10, 4194304
s_mov_b32 s11, 0x20000
buffer_load_dwordx4 v[16:19], v5, s[8:11], s34 offen offset:0
buffer_load_dwordx4 v[20:23], v5, s[8:11], s34 offen offset:1024
buffer_load_dwordx4 v[24:27], v5, s[8:11], s35 offen offset:0
buffer_load_dwordx4 v[28:31], v5, s[8:11], s35 offen offset:1024
v_fmamk_f32 v7, v8, 0x41300000, v9
v_cos_f32 v95, v7
v_sin_f32 v111, v7
v_fmamk_f32 v6, v8, 0x41800000, v9
v_cos_f32 v96, v6
v_sin_f32 v112, v6
v_fmamk_f32 v7, v8, 0x41880000, v9
v_cos_f32 v97, v7
v_sin_f32 v113, v7
v_fmamk_f32 v6, v8, 0x41900000, v9
v_cos_f32 v98, v6
v_sin_f32 v114, v6
v_fmamk_f32 v7, v8, 0x41980000, v9
v_cos_f32 v99, v7
v_sin_f32 v115, v7
v_fmamk_f32 v6, v8, 0x41c00000, v9
v_cos_f32 v100, v6
v_sin_f32 v116, v6
v_fmamk_f32 v7, v8, 0x41c80000, v9
v_cos_f32 v101, v7
v_sin_f32 v117, v7
v_fmamk_f32 v6, v8, 0x41d00000, v9
v_cos_f32 v102, v6
v_sin_f32 v118, v6
v_fmamk_f32 v7, v8, 0x41d80000, v9
v_cos_f32 v103, v7
v_sin_f32 v119, v7
s_lshr_b32 s30, s29, 1
s_and_b32 s31, s29, 1
s_lshl_b32 s32, s30, 13
s_lshl_b32 s33, s31, 11
s_add_u32 s32, s32, s33
v_add_u32 v120, s32, v5
v_lshrrev_b32 v3, 5, v2
v_bfe_u32 v4, v2, 2, 2
v_lshl_add_u32 v4, v3, 2, v4
v_lshlrev_b32 v121, 6, v4
v_bfe_u32 v4, v2, 4, 1
v_lshl_add_u32 v121, v4, 5, v121
v_and_b32 v4, 3, v2
v_lshl_add_u32 v121, v4, 3, v121
s_lshl_b32 s32, s29, 12
v_add_u32 v121, s32, v121
s_mul_i32 s32, s30, 9984
s_mul_i32 s33, s31, 4896
s_add_u32 s32, s32, s33
s_add_u32 s32, s32, 16384
v_and_b32 v4, 31, v2
v_mul_u32_u24 v122, 144, v4
v_lshrrev_b32 v4, 3, v4
v_lshl_add_u32 v122, v4, 6, v122
v_lshl_add_u32 v122, v3, 4, v122
v_add_u32 v122, s32, v122
s_lshl_b32 s32, s29, 4
v_lshrrev_b32 v3, 2, v2
v_add_u32 v3, s32, v3
v_mul_u32_u24 v123, 16512, v3
v_and_b32 v4, 3, v2
v_lshl_add_u32 v123, v4, 4, v123
v_bfe_u32 v4, v2, 1, 1
v_lshl_add_u32 v3, v4, 8, v3
v_and_b32 v4, 1, v2
v_mul_u32_u24 v4, 4896, v4
v_add_u32 v4, 16384, v4
v_mov_b32 v10, 512
v_cmp_eq_u32 vcc, 0, v3
v_sub_u32 v11, 1024, v3
s_nop 0
v_cndmask_b32 v12, v3, v10, vcc
v_lshrrev_b32 v6, 5, v12
v_lshl_add_u32 v6, v6, 2, v12
v_lshrrev_b32 v7, 8, v12
v_lshl_add_u32 v6, v7, 4, v6
v_lshl_add_u32 v124, v6, 2, v4
v_cndmask_b32 v12, v11, v10, vcc
v_lshrrev_b32 v6, 5, v12
v_lshl_add_u32 v6, v6, 2, v12
v_lshrrev_b32 v7, 8, v12
v_lshl_add_u32 v6, v7, 4, v6
v_lshl_add_u32 v128, v6, 2, v4
v_add_u32 v12, 64, v3
v_lshrrev_b32 v6, 5, v12
v_lshl_add_u32 v6, v6, 2, v12
v_lshrrev_b32 v7, 8, v12
v_lshl_add_u32 v6, v7, 4, v6
v_lshl_add_u32 v125, v6, 2, v4
v_subrev_u32 v12, 64, v11
v_lshrrev_b32 v6, 5, v12
v_lshl_add_u32 v6, v6, 2, v12
v_lshrrev_b32 v7, 8, v12
v_lshl_add_u32 v6, v7, 4, v6
v_lshl_add_u32 v129, v6, 2, v4
v_add_u32 v126, 288, v125
v_subrev_u32 v130, 288, v129
v_add_u32 v127, 576, v125
v_subrev_u32 v131, 576, v129
s_lshl_b32 s42, s94, 6
s_add_u32 s43, s42, 1056768
s_add_u32 s44, s42, 2113536
s_add_u32 s45, s42, 3170304
s_mov_b32 s16, s38
s_and_b32 s17, s39, 0xffff
s_mov_b32 s18, 2101248
s_mov_b32 s19, 0x20000
s_mov_b32 s20, s40
s_and_b32 s21, s41, 0xffff
s_mov_b32 s22, 2101248
s_mov_b32 s23, 0x20000
buffer_load_dwordx3 v[180:182], v239, s[16:19], s50 offen nt
buffer_load_dwordx3 v[184:186], v239, s[20:23], s50 offen nt
s_add_u32 s50, s50, 65664
buffer_load_dwordx3 v[188:190], v239, s[16:19], s50 offen nt
buffer_load_dwordx3 v[192:194], v239, s[20:23], s50 offen nt
s_add_u32 s50, s50, 65664
buffer_load_dwordx3 v[196:198], v239, s[16:19], s50 offen nt
buffer_load_dwordx3 v[200:202], v239, s[20:23], s50 offen nt
s_add_u32 s50, s50, 65664
buffer_load_dwordx3 v[204:206], v239, s[16:19], s50 offen nt
buffer_load_dwordx3 v[208:210], v239, s[20:23], s50 offen nt
s_add_u32 s12, s6, s4
s_addc_u32 s13, s7, 0
s_and_b32 s13, s13, 0xffff
s_mov_b32 s14, 4227072
s_mov_b32 s15, 0x20000
s_add_u32 s24, s6, s5
s_addc_u32 s25, s7, 0
s_and_b32 s25, s25, 0xffff
s_mov_b32 s26, 4227072
s_mov_b32 s27, 0x20000
v_mov_b32 v10, 0x3f803f80
s_waitcnt vmcnt(10)
v_dot2_f32_bf16 v6, v16, v10, 0
v_dot2_f32_bf16 v7, v16, v16, 0
v_dot2_f32_bf16 v6, v17, v10, v6
v_dot2_f32_bf16 v7, v17, v17, v7
v_dot2_f32_bf16 v6, v18, v10, v6
v_dot2_f32_bf16 v7, v18, v18, v7
v_dot2_f32_bf16 v6, v19, v10, v6
v_dot2_f32_bf16 v7, v19, v19, v7
v_dot2_f32_bf16 v6, v20, v10, v6
v_dot2_f32_bf16 v7, v20, v20, v7
v_dot2_f32_bf16 v6, v21, v10, v6
v_dot2_f32_bf16 v7, v21, v21, v7
v_dot2_f32_bf16 v6, v22, v10, v6
v_dot2_f32_bf16 v7, v22, v22, v7
v_dot2_f32_bf16 v6, v23, v10, v6
v_dot2_f32_bf16 v7, v23, v23, v7
s_waitcnt vmcnt(8)
v_dot2_f32_bf16 v8, v24, v10, 0
v_dot2_f32_bf16 v9, v24, v24, 0
v_dot2_f32_bf16 v8, v25, v10, v8
v_dot2_f32_bf16 v9, v25, v25, v9
v_dot2_f32_bf16 v8, v26, v10, v8
v_dot2_f32_bf16 v9, v26, v26, v9
v_dot2_f32_bf16 v8, v27, v10, v8
v_dot2_f32_bf16 v9, v27, v27, v9
v_dot2_f32_bf16 v8, v28, v10, v8
v_dot2_f32_bf16 v9, v28, v28, v9
v_dot2_f32_bf16 v8, v29, v10, v8
v_dot2_f32_bf16 v9, v29, v29, v9
v_dot2_f32_bf16 v8, v30, v10, v8
v_dot2_f32_bf16 v9, v30, v30, v9
v_dot2_f32_bf16 v8, v31, v10, v8
v_dot2_f32_bf16 v9, v31, v31, v9
s_lshr_b32 s53, s2, 3
s_lshl_b32 s53, s53, 11
v_lshrrev_b32 v1, 4, v0
v_lshl_add_u32 v1, v1, 7, s53
v_min_u32 v1, s62, v1
global_load_dword v1, v1, s[60:61]
v_lshlrev_b32 v32, 16, v16
v_and_b32 v33, 0xffff0000, v16
v_lshlrev_b32 v34, 16, v17
v_permlane32_swap_b32 v6, v7
v_permlane32_swap_b32 v8, v9
v_add_f32 v6, v6, v7
v_and_b32 v35, 0xffff0000, v17
v_lshlrev_b32 v36, 16, v18
v_add_f32 v8, v8, v9
v_and_b32 v37, 0xffff0000, v18
v_lshlrev_b32 v38, 16, v19
v_permlane16_swap_b32 v6, v8
v_add_f32 v6, v6, v8
v_and_b32 v39, 0xffff0000, v19
v_lshlrev_b32 v40, 16, v20
v_add_f32_dpp v6, v6, v6 row_ror:8 row_mask:0xf bank_mask:0xf
v_and_b32 v41, 0xffff0000, v20
v_lshlrev_b32 v42, 16, v21
v_add_f32_dpp v6, v6, v6 row_ror:4 row_mask:0xf bank_mask:0xf
v_and_b32 v43, 0xffff0000, v21
v_lshlrev_b32 v44, 16, v22
v_add_f32_dpp v6, v6, v6 row_ror:2 row_mask:0xf bank_mask:0xf
v_and_b32 v45, 0xffff0000, v22
v_lshlrev_b32 v46, 16, v23
v_add_f32_dpp v6, v6, v6 row_ror:1 row_mask:0xf bank_mask:0xf
v_and_b32 v47, 0xffff0000, v23
v_lshlrev_b32 v48, 16, v24
v_readlane_b32 s46, v6, 0
v_readlane_b32 s47, v6, 32
v_readlane_b32 s48, v6, 16
v_readlane_b32 s49, v6, 48
v_and_b32 v49, 0xffff0000, v24
v_lshlrev_b32 v50, 16, v25
v_and_b32 v51, 0xffff0000, v25
v_lshlrev_b32 v52, 16, v26
v_and_b32 v53, 0xffff0000, v26
v_lshlrev_b32 v54, 16, v27
v_and_b32 v55, 0xffff0000, v27
v_lshlrev_b32 v56, 16, v28
v_and_b32 v57, 0xffff0000, v28
v_lshlrev_b32 v58, 16, v29
v_and_b32 v59, 0xffff0000, v29
v_lshlrev_b32 v60, 16, v30
v_and_b32 v61, 0xffff0000, v30
v_lshlrev_b32 v62, 16, v31
v_and_b32 v63, 0xffff0000, v31
v_mov_b32 v6, s46
v_mov_b32 v10, s48
v_mov_b32 v8, s47
v_mov_b32 v12, s49
v_mul_f32 v6, 0x3a800000, v6
v_mul_f32 v10, 0x3a800000, v10
v_mul_f32 v8, 0x3a800000, v8
v_mul_f32 v12, 0x3a800000, v12
v_fma_f32 v8, -v6, v6, v8
v_fma_f32 v12, -v10, v10, v12
v_max_f32 v8, 0, v8
v_max_f32 v12, 0, v12
v_add_f32 v8, 0x3727c5ac, v8
v_add_f32 v12, 0x3727c5ac, v12
v_rsq_f32 v8, v8
v_rsq_f32 v12, v12
v_mul_f32 v6, v6, v8
v_mul_f32 v10, v10, v12
v_sub_f32 v6, 0, v6
v_sub_f32 v10, 0, v10
v_pk_fma_f32 v[32:33], v[32:33], v[8:9], v[6:7] op_sel_hi:[1,0,0]
v_pk_fma_f32 v[48:49], v[48:49], v[12:13], v[10:11] op_sel_hi:[1,0,0]
v_pk_add_f32 v[148:149], v[32:33], v[48:49]
v_pk_add_f32 v[150:151], v[32:33], v[48:49] neg_lo:[0,1] neg_hi:[0,1]
v_cvt_pk_bf16_f32 v132, v148, v149
v_cvt_pk_bf16_f32 v140, v150, v151
v_pk_fma_f32 v[34:35], v[34:35], v[8:9], v[6:7] op_sel_hi:[1,0,0]
v_pk_fma_f32 v[50:51], v[50:51], v[12:13], v[10:11] op_sel_hi:[1,0,0]
v_pk_add_f32 v[152:153], v[34:35], v[50:51]
v_pk_add_f32 v[154:155], v[34:35], v[50:51] neg_lo:[0,1] neg_hi:[0,1]
v_cvt_pk_bf16_f32 v133, v152, v153
v_cvt_pk_bf16_f32 v141, v154, v155
v_pk_fma_f32 v[36:37], v[36:37], v[8:9], v[6:7] op_sel_hi:[1,0,0]
v_pk_fma_f32 v[52:53], v[52:53], v[12:13], v[10:11] op_sel_hi:[1,0,0]
v_pk_add_f32 v[148:149], v[36:37], v[52:53]
v_pk_add_f32 v[150:151], v[36:37], v[52:53] neg_lo:[0,1] neg_hi:[0,1]
v_cvt_pk_bf16_f32 v134, v148, v149
v_cvt_pk_bf16_f32 v142, v150, v151
v_pk_fma_f32 v[38:39], v[38:39], v[8:9], v[6:7] op_sel_hi:[1,0,0]
v_pk_fma_f32 v[54:55], v[54:55], v[12:13], v[10:11] op_sel_hi:[1,0,0]
v_pk_add_f32 v[152:153], v[38:39], v[54:55]
v_pk_add_f32 v[154:155], v[38:39], v[54:55] neg_lo:[0,1] neg_hi:[0,1]
v_cvt_pk_bf16_f32 v135, v152, v153
v_cvt_pk_bf16_f32 v143, v154, v155
ds_write_b128 v120, v[132:135]
ds_write_b128 v120, v[140:143] offset:4096
v_pk_fma_f32 v[40:41], v[40:41], v[8:9], v[6:7] op_sel_hi:[1,0,0]
v_pk_fma_f32 v[56:57], v[56:57], v[12:13], v[10:11] op_sel_hi:[1,0,0]
v_pk_add_f32 v[148:149], v[40:41], v[56:57]
v_pk_add_f32 v[150:151], v[40:41], v[56:57] neg_lo:[0,1] neg_hi:[0,1]
v_cvt_pk_bf16_f32 v136, v148, v149
v_cvt_pk_bf16_f32 v144, v150, v151
v_pk_fma_f32 v[42:43], v[42:43], v[8:9], v[6:7] op_sel_hi:[1,0,0]
v_pk_fma_f32 v[58:59], v[58:59], v[12:13], v[10:11] op_sel_hi:[1,0,0]
v_pk_add_f32 v[152:153], v[42:43], v[58:59]
v_pk_add_f32 v[154:155], v[42:43], v[58:59] neg_lo:[0,1] neg_hi:[0,1]
v_cvt_pk_bf16_f32 v137, v152, v153
v_cvt_pk_bf16_f32 v145, v154, v155
v_pk_fma_f32 v[44:45], v[44:45], v[8:9], v[6:7] op_sel_hi:[1,0,0]
v_pk_fma_f32 v[60:61], v[60:61], v[12:13], v[10:11] op_sel_hi:[1,0,0]
v_pk_add_f32 v[148:149], v[44:45], v[60:61]
v_pk_add_f32 v[150:151], v[44:45], v[60:61] neg_lo:[0,1] neg_hi:[0,1]
v_cvt_pk_bf16_f32 v138, v148, v149
v_cvt_pk_bf16_f32 v146, v150, v151
v_pk_fma_f32 v[46:47], v[46:47], v[8:9], v[6:7] op_sel_hi:[1,0,0]
v_pk_fma_f32 v[62:63], v[62:63], v[12:13], v[10:11] op_sel_hi:[1,0,0]
v_pk_add_f32 v[152:153], v[46:47], v[62:63]
v_pk_add_f32 v[154:155], v[46:47], v[62:63] neg_lo:[0,1] neg_hi:[0,1]
v_cvt_pk_bf16_f32 v139, v152, v153
v_cvt_pk_bf16_f32 v147, v154, v155
ds_write_b128 v120, v[136:139] offset:1024
ds_write_b128 v120, v[144:147] offset:5120
s_waitcnt lgkmcnt(0)
s_barrier
ds_read_b64_tr_b16 v[132:133], v121 offset:0
ds_read_b64_tr_b16 v[134:135], v121 offset:512
ds_read_b64_tr_b16 v[140:141], v121 offset:2048
ds_read_b64_tr_b16 v[142:143], v121 offset:2560
ds_read_b64_tr_b16 v[136:137], v121 offset:1024
ds_read_b64_tr_b16 v[138:139], v121 offset:1536
ds_read_b64_tr_b16 v[144:145], v121 offset:3072
ds_read_b64_tr_b16 v[146:147], v121 offset:3584
s_waitcnt lgkmcnt(4)
v_mfma_f32_32x32x16_bf16 v[148:163], v[132:135], v[64:67], 0
v_mfma_f32_32x32x16_bf16 v[164:179], v[140:143], v[64:67], 0
v_mfma_f32_32x32x16_bf16 v[148:163], v[140:143], v[72:75], v[148:163]
v_mfma_f32_32x32x16_bf16 v[164:179], v[132:135], v[80:83], v[164:179]
s_waitcnt lgkmcnt(0)
v_mfma_f32_32x32x16_bf16 v[148:163], v[136:139], v[68:71], v[148:163]
v_mfma_f32_32x32x16_bf16 v[164:179], v[144:147], v[68:71], v[164:179]
v_mfma_f32_32x32x16_bf16 v[148:163], v[144:147], v[76:79], v[148:163]
v_mfma_f32_32x32x16_bf16 v[164:179], v[136:139], v[84:87], v[164:179]
s_nop 10
v_pk_mul_f32 v[6:7], v[148:149], v[88:89]
v_pk_mul_f32 v[8:9], v[164:165], v[88:89]
v_pk_fma_f32 v[6:7], v[164:165], v[104:105], v[6:7]
v_pk_fma_f32 v[8:9], v[148:149], v[104:105], v[8:9] neg_lo:[0,1,0] neg_hi:[0,1,0]
v_cvt_pk_bf16_f32 v132, v6, v7
v_cvt_pk_bf16_f32 v140, v8, v9
v_pk_mul_f32 v[10:11], v[150:151], v[90:91]
v_pk_mul_f32 v[12:13], v[166:167], v[90:91]
v_pk_fma_f32 v[10:11], v[166:167], v[106:107], v[10:11]
v_pk_fma_f32 v[12:13], v[150:151], v[106:107], v[12:13] neg_lo:[0,1,0] neg_hi:[0,1,0]
v_cvt_pk_bf16_f32 v133, v10, v11
v_cvt_pk_bf16_f32 v141, v12, v13
v_pk_mul_f32 v[6:7], v[152:153], v[92:93]
v_pk_mul_f32 v[8:9], v[168:169], v[92:93]
v_pk_fma_f32 v[6:7], v[168:169], v[108:109], v[6:7]
v_pk_fma_f32 v[8:9], v[152:153], v[108:109], v[8:9] neg_lo:[0,1,0] neg_hi:[0,1,0]
v_cvt_pk_bf16_f32 v134, v6, v7
v_cvt_pk_bf16_f32 v142, v8, v9
v_pk_mul_f32 v[10:11], v[154:155], v[94:95]
v_pk_mul_f32 v[12:13], v[170:171], v[94:95]
v_pk_fma_f32 v[10:11], v[170:171], v[110:111], v[10:11]
v_pk_fma_f32 v[12:13], v[154:155], v[110:111], v[12:13] neg_lo:[0,1,0] neg_hi:[0,1,0]
v_cvt_pk_bf16_f32 v135, v10, v11
v_cvt_pk_bf16_f32 v143, v12, v13
v_mul_f32 v6, v156, v96
v_mul_f32 v8, v172, v96
v_mfma_f32_32x32x16_bf16 v[32:47], v[132:135], v[64:67], 0
v_mul_f32 v7, v157, v97
v_mul_f32 v9, v173, v97
v_fmac_f32 v6, v172, v112
v_fma_f32 v8, -v156, v112, v8
v_fmac_f32 v7, v173, v113
v_fma_f32 v9, -v157, v113, v9
v_cvt_pk_bf16_f32 v136, v6, v7
v_cvt_pk_bf16_f32 v144, v8, v9
v_mul_f32 v10, v158, v98
v_mul_f32 v12, v174, v98
v_mfma_f32_32x32x16_bf16 v[48:63], v[140:143], v[64:67], 0
v_mul_f32 v11, v159, v99
v_mul_f32 v13, v175, v99
v_fmac_f32 v10, v174, v114
v_fma_f32 v12, -v158, v114, v12
v_fmac_f32 v11, v175, v115
v_fma_f32 v13, -v159, v115, v13
v_cvt_pk_bf16_f32 v137, v10, v11
v_cvt_pk_bf16_f32 v145, v12, v13
v_mul_f32 v6, v160, v100
v_mul_f32 v8, v176, v100
v_mfma_f32_32x32x16_bf16 v[32:47], v[140:143], v[72:75], v[32:47]
v_mul_f32 v7, v161, v101
v_mul_f32 v9, v177, v101
v_fmac_f32 v6, v176, v116
v_fma_f32 v8, -v160, v116, v8
v_fmac_f32 v7, v177, v117
v_fma_f32 v9, -v161, v117, v9
v_cvt_pk_bf16_f32 v138, v6, v7
v_cvt_pk_bf16_f32 v146, v8, v9
v_mul_f32 v10, v162, v102
v_mul_f32 v12, v178, v102
v_mfma_f32_32x32x16_bf16 v[48:63], v[132:135], v[80:83], v[48:63]
v_mul_f32 v11, v163, v103
v_mul_f32 v13, v179, v103
v_fmac_f32 v10, v178, v118
v_fma_f32 v12, -v162, v118, v12
v_fmac_f32 v11, v179, v119
v_fma_f32 v13, -v163, v119, v13
v_cvt_pk_bf16_f32 v139, v10, v11
v_cvt_pk_bf16_f32 v147, v12, v13
s_nop 0
v_mfma_f32_32x32x16_bf16 v[32:47], v[136:139], v[68:71], v[32:47]
v_mfma_f32_32x32x16_bf16 v[48:63], v[144:147], v[68:71], v[48:63]
v_mfma_f32_32x32x16_bf16 v[32:47], v[144:147], v[76:79], v[32:47]
v_mfma_f32_32x32x16_bf16 v[48:63], v[136:139], v[84:87], v[48:63]
s_nop 11
v_cvt_pk_bf16_f32 v16, v32, v48
v_cvt_pk_bf16_f32 v17, v33, v49
v_cvt_pk_bf16_f32 v18, v34, v50
v_cvt_pk_bf16_f32 v19, v35, v51
ds_write_b128 v122, v[16:19] offset:0
v_cvt_pk_bf16_f32 v20, v36, v52
v_cvt_pk_bf16_f32 v21, v37, v53
v_cvt_pk_bf16_f32 v22, v38, v54
v_cvt_pk_bf16_f32 v23, v39, v55
ds_write_b128 v122, v[20:23] offset:32
v_cvt_pk_bf16_f32 v24, v40, v56
v_cvt_pk_bf16_f32 v25, v41, v57
v_cvt_pk_bf16_f32 v26, v42, v58
v_cvt_pk_bf16_f32 v27, v43, v59
ds_write_b128 v122, v[24:27] offset:64
v_cvt_pk_bf16_f32 v28, v44, v60
v_cvt_pk_bf16_f32 v29, v45, v61
v_cvt_pk_bf16_f32 v30, v46, v62
v_cvt_pk_bf16_f32 v31, v47, v63
ds_write_b128 v122, v[28:31] offset:96
s_waitcnt lgkmcnt(0)
s_barrier
ds_read2st64_b32 v[16:17], v124 offset0:0 offset1:39
ds_read2st64_b32 v[18:19], v128 offset0:0 offset1:39
ds_read2st64_b32 v[20:21], v125 offset0:0 offset1:39
ds_read2st64_b32 v[22:23], v129 offset0:0 offset1:39
ds_read2st64_b32 v[24:25], v126 offset0:0 offset1:39
ds_read2st64_b32 v[26:27], v130 offset0:0 offset1:39
ds_read2st64_b32 v[28:29], v127 offset0:0 offset1:39
ds_read2st64_b32 v[30:31], v131 offset0:0 offset1:39
s_waitcnt lgkmcnt(6)
v_bfi_b32 v16, 1, 0, v16
buffer_store_dwordx4 v[16:19], v123, s[12:15], s42 offen sc1
s_waitcnt lgkmcnt(4)
v_bfi_b32 v20, 1, 0, v20
buffer_store_dwordx4 v[20:23], v123, s[12:15], s43 offen sc1
s_waitcnt lgkmcnt(2)
v_bfi_b32 v24, 1, 0, v24
buffer_store_dwordx4 v[24:27], v123, s[12:15], s44 offen sc1
s_waitcnt lgkmcnt(0)
v_bfi_b32 v28, 1, 0, v28
buffer_store_dwordx4 v[28:31], v123, s[12:15], s45 offen sc1
s_waitcnt vmcnt(5)
s_mov_b32 s30, 0x05040100
s_mov_b32 s31, 0x07060302
v_alignbyte_b32 v180, v181, v180, s52
v_alignbyte_b32 v184, v185, v184, s52
v_alignbyte_b32 v188, v189, v188, s52
v_alignbyte_b32 v192, v193, v192, s52
v_alignbyte_b32 v196, v197, v196, s52
v_alignbyte_b32 v200, v201, v200, s52
v_alignbyte_b32 v204, v205, v204, s52
v_alignbyte_b32 v208, v209, v208, s52
v_perm_b32 v212, v184, v180, s30
v_perm_b32 v213, v192, v188, s30
v_perm_b32 v214, v200, v196, s30
v_perm_b32 v215, v208, v204, s30
buffer_store_dwordx4 v[212:215], v240, s[24:27], s51 offen sc1
v_perm_b32 v216, v184, v180, s31
v_perm_b32 v217, v192, v188, s31
v_perm_b32 v218, v200, v196, s31
v_perm_b32 v219, v208, v204, s31
buffer_store_dwordx4 v[216:219], v241, s[24:27], s51 offen sc1
v_alignbyte_b32 v181, v182, v181, s52
v_alignbyte_b32 v185, v186, v185, s52
v_alignbyte_b32 v189, v190, v189, s52
v_alignbyte_b32 v193, v194, v193, s52
v_alignbyte_b32 v197, v198, v197, s52
v_alignbyte_b32 v201, v202, v201, s52
v_alignbyte_b32 v205, v206, v205, s52
v_alignbyte_b32 v209, v210, v209, s52
v_perm_b32 v220, v185, v181, s30
v_perm_b32 v221, v193, v189, s30
v_perm_b32 v222, v201, v197, s30
v_perm_b32 v223, v209, v205, s30
buffer_store_dwordx4 v[220:223], v242, s[24:27], s51 offen sc1
v_perm_b32 v224, v185, v181, s31
v_perm_b32 v225, v193, v189, s31
v_perm_b32 v226, v201, v197, s31
v_perm_b32 v227, v209, v205, s31
buffer_store_dwordx4 v[224:227], v243, s[24:27], s51 offen sc1
s_add_u32 s56, s6, s3
s_addc_u32 s57, s7, 0
s_and_b32 s57, s57, 0xffff
s_mov_b32 s58, 4227072
s_mov_b32 s59, 0x20000
v_mov_b32 v228, -1
v_mov_b32 v229, -1
v_mov_b32 v230, -1
v_mov_b32 v231, -1
s_mul_i32 s53, s2, 16512
s_lshl_b32 s54, s29, 12
s_add_u32 s53, s53, s54
buffer_store_dwordx4 v[228:231], v5, s[56:59], s53 offen offset:0 sc1
buffer_store_dwordx4 v[228:231], v5, s[56:59], s53 offen offset:1024 sc1
buffer_store_dwordx4 v[228:231], v5, s[56:59], s53 offen offset:2048 sc1
buffer_store_dwordx4 v[228:231], v5, s[56:59], s53 offen offset:3072 sc1
s_add_u32 s56, s6, s28
s_addc_u32 s57, s7, 0
s_and_b32 s57, s57, 0xffff
s_mov_b32 s58, 4194304
s_mov_b32 s59, 0x20000
s_lshr_b32 s54, s2, 1
s_lshl_b32 s54, s54, 15
s_and_b32 s53, s2, 1
s_lshl_b32 s53, s53, 11
s_add_u32 s53, s53, s54
v_lshlrev_b32 v236, 3, v0
buffer_store_dwordx2 v[228:229], v236, s[56:59], s53 offen sc1
s_add_u32 s56, s6, s55
s_addc_u32 s57, s7, 0
s_and_b32 s57, s57, 0xffff
s_mov_b32 s58, 1048576
s_mov_b32 s59, 0x20000
v_mov_b32 v232, 0
v_mov_b32 v233, 0
v_mov_b32 v234, 0
v_mov_b32 v235, 0
s_lshl_b32 s53, s2, 12
v_lshlrev_b32 v237, 4, v0
buffer_store_dwordx4 v[232:235], v237, s[56:59], s53 offen sc1
L_k1_end:
s_endpgm
.section .rodata,"a"
.p2align 6
.amdhsa_kernel k1_kernel
  .amdhsa_next_free_vgpr 244
  .amdhsa_next_free_sgpr 102
  .amdhsa_accum_offset 244
  .amdhsa_group_segment_fixed_size 0
  .amdhsa_kernarg_size 80
  .amdhsa_user_sgpr_count 2
  .amdhsa_user_sgpr_kernarg_segment_ptr 1
  .amdhsa_system_sgpr_workgroup_id_x 1
  .amdhsa_float_denorm_mode_32 3
.end_amdhsa_kernel
.text

.globl m_kernel
.p2align 8
.type m_kernel,@function
m_kernel:
s_mov_b32 s58, 7340032
L_f:
s_cmp_ge_u32 s2, 256
s_cbranch_scc1 L_f_end
s_load_dwordx2 s[6:7], s[0:1], 72
s_load_dwordx2 s[20:21], s[0:1], 0
v_lshrrev_b32 v1, 6, v0
s_mov_b32 s99, 0
v_readfirstlane_b32 s29, v1
s_and_b32 s97, s2, 7
s_lshr_b32 s98, s2, 3
s_and_b32 s94, s97, 1
s_lshl_b32 s94, s94, 2
s_and_b32 s48, s98, 3
s_add_u32 s94, s94, s48
s_lshr_b32 s48, s97, 1
s_lshl_b32 s48, s48, 3
s_lshr_b32 s98, s98, 2
s_add_u32 s48, s48, s98
s_lshl_b32 s95, s94, 5
s_add_u32 s95, s95, s48
L_f_top:
s_load_dwordx4 s[36:39], s[0:1], 32
s_load_dwordx2 s[54:55], s[0:1], 48
v_and_b32 v1, 63, v0
v_lshlrev_b32 v4, 6, v1
v_lshlrev_b32 v14, 4, v1
s_mul_i32 s33, s2, 16512
s_lshl_b32 s31, s29, 4
s_add_u32 s30, s33, s31
s_lshl_b32 s31, s29, 12
s_add_u32 s31, s31, s33
s_and_b32 s32, s29, 1
v_and_b32 v2, 31, v1
v_lshl_add_u32 v5, v2, 1, s32
v_cvt_f32_u32 v5, v5
v_fma_f32 v6, v5, 0.5, 0.5
v_mul_f32 v6, 0.5, v6
v_cos_f32 v7, v6
v_sin_f32 v250, v6
v_mul_f32 v8, 0x3c800000, v5
v_add_f32 v248, 1.0, v7
v_sub_f32 v249, 1.0, v7
v_lshrrev_b32 v2, 5, v1
v_cvt_f32_u32 v251, v2
v_mul_f32 v9, v251, v8
v_add_f32 v9, v9, v9
v_cos_f32 v10, v9
v_sin_f32 v11, v9
v_mul_f32 v12, v10, v250
v_mul_f32 v13, v11, v250
v_fma_f32 v216, v10, v248, -v13
v_fma_f32 v217, v11, v248, v12
v_fma_f32 v218, v10, v249, v13
v_fma_f32 v219, -v11, v249, v12
v_cvt_pk_bf16_f32 v48, v216, v217
v_cvt_pk_bf16_f32 v50, v218, v219
v_cvt_pk_bf16_f32 v64, -v217, v216
v_cvt_pk_bf16_f32 v66, v219, -v218
v_fmamk_f32 v6, v8, 0x3f800000, v9
v_cos_f32 v10, v6
v_sin_f32 v11, v6
v_mul_f32 v12, v10, v250
v_mul_f32 v13, v11, v250
v_fma_f32 v216, v10, v248, -v13
v_fma_f32 v217, v11, v248, v12
v_fma_f32 v218, v10, v249, v13
v_fma_f32 v219, -v11, v249, v12
v_cvt_pk_bf16_f32 v49, v216, v217
v_cvt_pk_bf16_f32 v51, v218, v219
v_cvt_pk_bf16_f32 v65, -v217, v216
v_cvt_pk_bf16_f32 v67, v219, -v218
v_fmamk_f32 v6, v8, 0x40800000, v9
v_cos_f32 v10, v6
v_sin_f32 v11, v6
v_mul_f32 v12, v10, v250
v_mul_f32 v13, v11, v250
v_fma_f32 v216, v10, v248, -v13
v_fma_f32 v217, v11, v248, v12
v_fma_f32 v218, v10, v249, v13
v_fma_f32 v219, -v11, v249, v12
v_cvt_pk_bf16_f32 v52, v216, v217
v_cvt_pk_bf16_f32 v54, v218, v219
v_cvt_pk_bf16_f32 v68, -v217, v216
v_cvt_pk_bf16_f32 v70, v219, -v218
v_fmamk_f32 v6, v8, 0x40a00000, v9
v_cos_f32 v10, v6
v_sin_f32 v11, v6
v_mul_f32 v12, v10, v250
v_mul_f32 v13, v11, v250
v_fma_f32 v216, v10, v248, -v13
v_fma_f32 v217, v11, v248, v12
s_waitcnt lgkmcnt(0)
s_add_u32 s8, s6, 0
s_addc_u32 s9, s7, 0
s_and_b32 s9, s9, 0xffff
s_mov_b32 s10, 4227072
s_mov_b32 s11, 0x20000
s_add_u32 s16, s6, 10485760
s_addc_u32 s17, s7, 0
s_and_b32 s17, s17, 0xffff
s_mov_b32 s18, 4227072
s_mov_b32 s19, 0x20000
s_cmp_lg_u32 s99, 0
s_cbranch_scc1 L_fc_c1
buffer_load_dwordx4 v[16:19], v4, s[8:11], s30 offen
s_add_u32 s53, s30, 4096
buffer_load_dwordx4 v[20:23], v4, s[8:11], s53 offen
s_add_u32 s53, s30, 8192
buffer_load_dwordx4 v[24:27], v4, s[8:11], s53 offen
s_add_u32 s53, s30, 12288
buffer_load_dwordx4 v[28:31], v4, s[8:11], s53 offen
L_fc_c1:
v_fma_f32 v218, v10, v249, v13
v_fma_f32 v219, -v11, v249, v12
v_cvt_pk_bf16_f32 v53, v216, v217
v_cvt_pk_bf16_f32 v55, v218, v219
v_cvt_pk_bf16_f32 v69, -v217, v216
v_cvt_pk_bf16_f32 v71, v219, -v218
v_fmamk_f32 v6, v8, 0x41000000, v9
v_cos_f32 v10, v6
v_sin_f32 v11, v6
v_mul_f32 v12, v10, v250
v_mul_f32 v13, v11, v250
v_fma_f32 v216, v10, v248, -v13
v_fma_f32 v217, v11, v248, v12
v_fma_f32 v218, v10, v249, v13
v_fma_f32 v219, -v11, v249, v12
v_cvt_pk_bf16_f32 v56, v216, v217
v_cvt_pk_bf16_f32 v58, v218, v219
v_cvt_pk_bf16_f32 v72, -v217, v216
v_cvt_pk_bf16_f32 v74, v219, -v218
v_fmamk_f32 v6, v8, 0x41100000, v9
v_cos_f32 v10, v6
v_sin_f32 v11, v6
v_mul_f32 v12, v10, v250
v_mul_f32 v13, v11, v250
v_fma_f32 v216, v10, v248, -v13
v_fma_f32 v217, v11, v248, v12
v_fma_f32 v218, v10, v249, v13
v_fma_f32 v219, -v11, v249, v12
v_cvt_pk_bf16_f32 v57, v216, v217
v_cvt_pk_bf16_f32 v59, v218, v219
v_cvt_pk_bf16_f32 v73, -v217, v216
v_cvt_pk_bf16_f32 v75, v219, -v218
v_fmamk_f32 v6, v8, 0x41400000, v9
v_cos_f32 v10, v6
v_sin_f32 v11, v6
v_mul_f32 v12, v10, v250
v_mul_f32 v13, v11, v250
v_fma_f32 v216, v10, v248, -v13
v_fma_f32 v217, v11, v248, v12
v_fma_f32 v218, v10, v249, v13
v_fma_f32 v219, -v11, v249, v12
v_cvt_pk_bf16_f32 v60, v216, v217
v_cvt_pk_bf16_f32 v62, v218, v219
v_cvt_pk_bf16_f32 v76, -v217, v216
v_cvt_pk_bf16_f32 v78, v219, -v218
v_fmamk_f32 v6, v8, 0x41500000, v9
v_cos_f32 v10, v6
v_sin_f32 v11, v6
v_mul_f32 v12, v10, v250
v_mul_f32 v13, v11, v250
v_fma_f32 v216, v10, v248, -v13
v_fma_f32 v217, v11, v248, v12
v_fma_f32 v218, v10, v249, v13
v_fma_f32 v219, -v11, v249, v12
v_cvt_pk_bf16_f32 v61, v216, v217
v_cvt_pk_bf16_f32 v63, v218, v219
v_cvt_pk_bf16_f32 v77, -v217, v216
v_cvt_pk_bf16_f32 v79, v219, -v218
s_mul_i32 s33, s29, 8704
s_add_u32 s33, s33, 114688
v_and_b32 v3, 31, v1
v_mul_u32_u24 v3, 272, v3
v_lshl_add_u32 v3, v2, 4, v3
v_add_u32 v3, s33, v3
v_mul_f32 v8, 0x39800000, v5
v_lshl_add_u32 v9, v2, 3, s32
v_cvt_f32_u32 v9, v9
v_mul_f32 v9, v9, v8
ds_write_b128 v3, v[48:51] offset:0
v_cos_f32 v136, v9
v_sin_f32 v152, v9
v_fmamk_f32 v7, v8, 0x40000000, v9
v_cos_f32 v137, v7
v_sin_f32 v153, v7
ds_write_b128 v3, v[64:67] offset:128
v_fmamk_f32 v6, v8, 0x40800000, v9
v_cos_f32 v138, v6
v_sin_f32 v154, v6
v_fmamk_f32 v7, v8, 0x40c00000, v9
v_cos_f32 v139, v7
ds_write_b128 v3, v[52:55] offset:32
v_sin_f32 v155, v7
v_fmamk_f32 v6, v8, 0x41800000, v9
v_cos_f32 v140, v6
v_sin_f32 v156, v6
v_fmamk_f32 v7, v8, 0x41900000, v9
ds_write_b128 v3, v[68:71] offset:160
v_cos_f32 v141, v7
v_sin_f32 v157, v7
v_fmamk_f32 v6, v8, 0x41a00000, v9
s_cmp_lg_u32 s99, 0
s_cbranch_scc1 L_fc_c3
buffer_load_dwordx4 v[32:35], v14, s[16:19], s31 offen offset:0
buffer_load_dwordx4 v[36:39], v14, s[16:19], s31 offen offset:1024
buffer_load_dwordx4 v[40:43], v14, s[16:19], s31 offen offset:2048
buffer_load_dwordx4 v[44:47], v14, s[16:19], s31 offen offset:3072
s_and_b32 s21, s21, 0xffff
s_mov_b32 s22, 4194304
s_mov_b32 s23, 0x20000
s_and_b32 s42, s95, 31
s_lshr_b32 s31, s95, 5
s_lshl_b32 s31, s31, 6
s_add_u32 s42, s42, s31
s_lshr_b32 s31, s29, 1
s_lshl_b32 s31, s31, 5
s_add_u32 s42, s42, s31
s_and_b32 s31, s29, 1
s_lshl_b32 s31, s31, 9
s_add_u32 s42, s42, s31
s_lshl_b32 s42, s42, 11
s_add_u32 s43, s42, 2097152
s_mul_i32 s53, s29, 4128
s_add_u32 m0, s53, 36352
s_nop 0
buffer_load_dwordx4 v14, s[20:23], s42 offen offset:0 lds
buffer_load_dwordx4 v14, s[20:23], s42 offen offset:1024 lds
s_add_u32 m0, s53, 38416
s_nop 0
buffer_load_dwordx4 v14, s[20:23], s43 offen offset:0 lds
buffer_load_dwordx4 v14, s[20:23], s43 offen offset:1024 lds
s_cmp_ge_u32 s29, 2
s_cselect_b32 s56, s38, s36
s_cselect_b32 s57, s39, s37
s_and_b32 s57, s57, 0xffff
s_mov_b32 s59, 0x20000
s_mul_i32 s53, s2, 4096
v_and_b32 v254, 127, v0
v_mul_u32_u24 v254, 1, v254
v_lshrrev_b32 v254, 2, v254
v_lshlrev_b32 v254, 7, v254
buffer_load_dword v254, v254, s[56:59], s53 offen
s_branch L_fc_c4
L_fc_c3:
s_waitcnt vmcnt(4)
v_accvgpr_read_b32 v32, a64
v_accvgpr_read_b32 v33, a65
v_accvgpr_read_b32 v34, a66
v_accvgpr_read_b32 v35, a67
v_accvgpr_read_b32 v36, a68
v_accvgpr_read_b32 v37, a69
v_accvgpr_read_b32 v38, a70
v_accvgpr_read_b32 v39, a71
v_accvgpr_read_b32 v40, a72
v_accvgpr_read_b32 v41, a73
v_accvgpr_read_b32 v42, a74
v_accvgpr_read_b32 v43, a75
v_accvgpr_read_b32 v44, a76
v_accvgpr_read_b32 v45, a77
v_accvgpr_read_b32 v46, a78
v_accvgpr_read_b32 v47, a79
s_waitcnt vmcnt(0)
s_barrier
L_fc_c4:
v_cos_f32 v142, v6
v_sin_f32 v158, v6
ds_write_b128 v3, v[56:59] offset:64
v_fmamk_f32 v7, v8, 0x41b00000, v9
v_cos_f32 v143, v7
v_sin_f32 v159, v7
v_fmamk_f32 v6, v8, 0x42000000, v9
v_cos_f32 v144, v6
ds_write_b128 v3, v[72:75] offset:192
v_sin_f32 v160, v6
v_fmamk_f32 v7, v8, 0x42080000, v9
v_cos_f32 v145, v7
v_sin_f32 v161, v7
v_fmamk_f32 v6, v8, 0x42100000, v9
ds_write_b128 v3, v[60:63] offset:96
v_cos_f32 v146, v6
v_sin_f32 v162, v6
v_fmamk_f32 v7, v8, 0x42180000, v9
v_cos_f32 v147, v7
v_sin_f32 v163, v7
ds_write_b128 v3, v[76:79] offset:224
v_fmamk_f32 v6, v8, 0x42400000, v9
v_cos_f32 v148, v6
v_sin_f32 v164, v6
v_fmamk_f32 v7, v8, 0x42480000, v9
v_cos_f32 v149, v7
v_sin_f32 v165, v7
v_fmamk_f32 v6, v8, 0x42500000, v9
v_cos_f32 v150, v6
v_sin_f32 v166, v6
v_fmamk_f32 v7, v8, 0x42580000, v9
v_cos_f32 v151, v7
v_sin_f32 v167, v7
v_bfe_u32 v15, v1, 2, 2
v_lshl_add_u32 v15, v2, 2, v15
v_mul_u32_u24 v15, 272, v15
v_bfe_u32 v5, v1, 4, 1
v_lshl_add_u32 v15, v5, 5, v15
v_and_b32 v5, 1, v1
v_lshl_add_u32 v15, v5, 4, v15
v_bfe_u32 v5, v1, 1, 1
v_lshl_add_u32 v15, v5, 3, v15
v_add_u32 v15, s33, v15
s_waitcnt lgkmcnt(0)
ds_read_b64_tr_b16 v[80:81], v15 offset:0
v_and_b32 v8, 31, v1
v_cvt_f32_u32 v8, v8
v_mul_f32 v8, 0x3d000000, v8
ds_read_b64_tr_b16 v[82:83], v15 offset:2176
v_lshrrev_b32 v9, 5, v1
v_cvt_f32_u32 v9, v9
v_mul_f32 v9, 4.0, v9
ds_read_b64_tr_b16 v[84:85], v15 offset:4352
v_mul_f32 v9, v9, v8
v_cos_f32 v168, v9
v_sin_f32 v184, v9
ds_read_b64_tr_b16 v[86:87], v15 offset:6528
v_fmamk_f32 v7, v8, 0x3f800000, v9
v_cos_f32 v169, v7
v_sin_f32 v185, v7
s_cmp_eq_u32 s99, 0
s_cbranch_scc1 L_fc_c5
buffer_load_dwordx4 v[16:19], v4, s[8:11], s30 offen
s_add_u32 s53, s30, 4096
buffer_load_dwordx4 v[20:23], v4, s[8:11], s53 offen
s_add_u32 s53, s30, 8192
buffer_load_dwordx4 v[24:27], v4, s[8:11], s53 offen
s_add_u32 s53, s30, 12288
buffer_load_dwordx4 v[28:31], v4, s[8:11], s53 offen
L_fc_c5:
ds_read_b64_tr_b16 v[88:89], v15 offset:64
v_fmamk_f32 v6, v8, 0x40000000, v9
v_cos_f32 v170, v6
v_sin_f32 v186, v6
ds_read_b64_tr_b16 v[90:91], v15 offset:2240
v_fmamk_f32 v7, v8, 0x40400000, v9
v_cos_f32 v171, v7
v_sin_f32 v187, v7
ds_read_b64_tr_b16 v[92:93], v15 offset:4416
v_fmamk_f32 v6, v8, 0x41000000, v9
v_cos_f32 v172, v6
v_sin_f32 v188, v6
ds_read_b64_tr_b16 v[94:95], v15 offset:6592
v_fmamk_f32 v7, v8, 0x41100000, v9
v_cos_f32 v173, v7
v_sin_f32 v189, v7
ds_read_b64_tr_b16 v[96:97], v15 offset:128
v_fmamk_f32 v6, v8, 0x41200000, v9
v_cos_f32 v174, v6
v_sin_f32 v190, v6
ds_read_b64_tr_b16 v[98:99], v15 offset:2304
v_fmamk_f32 v7, v8, 0x41300000, v9
v_cos_f32 v175, v7
v_sin_f32 v191, v7
ds_read_b64_tr_b16 v[100:101], v15 offset:4480
v_fmamk_f32 v6, v8, 0x41800000, v9
v_cos_f32 v176, v6
v_sin_f32 v192, v6
ds_read_b64_tr_b16 v[102:103], v15 offset:6656
v_fmamk_f32 v7, v8, 0x41880000, v9
v_cos_f32 v177, v7
v_sin_f32 v193, v7
ds_read_b64_tr_b16 v[104:105], v15 offset:192
v_fmamk_f32 v6, v8, 0x41900000, v9
v_cos_f32 v178, v6
v_sin_f32 v194, v6
ds_read_b64_tr_b16 v[106:107], v15 offset:2368
v_fmamk_f32 v7, v8, 0x41980000, v9
v_cos_f32 v179, v7
v_sin_f32 v195, v7
ds_read_b64_tr_b16 v[108:109], v15 offset:4544
v_fmamk_f32 v6, v8, 0x41c00000, v9
v_cos_f32 v180, v6
v_sin_f32 v196, v6
ds_read_b64_tr_b16 v[110:111], v15 offset:6720
v_fmamk_f32 v7, v8, 0x41c80000, v9
v_cos_f32 v181, v7
v_sin_f32 v197, v7
v_fmamk_f32 v6, v8, 0x41d00000, v9
v_cos_f32 v182, v6
v_sin_f32 v198, v6
v_fmamk_f32 v7, v8, 0x41d80000, v9
v_cos_f32 v183, v7
v_sin_f32 v199, v7
s_cmp_ge_u32 s29, 2
s_cselect_b32 s12, s38, s36
s_cselect_b32 s13, s39, s37
s_and_b32 s13, s13, 0xffff
s_mov_b32 s14, 7340032
s_mov_b32 s15, 0x20000
s_mul_i32 s52, s48, 224
s_mul_i32 s3, s29, 7168
s_and_b32 s97, s29, 1
s_mul_i32 s97, s97, 448
s_movk_i32 s98, 6944
v_add_u32 v200, s97, v1
v_mul_u32_u24 v201, 4682, v200
v_lshlrev_b32 v200, 4, v200
v_lshrrev_b32 v202, 16, v201
v_mad_u32_u24 v202, v202, s98, v200
v_accvgpr_write_b32 a0, v202
v_add_u32 v201, 299648, v201
v_lshrrev_b32 v202, 16, v201
v_mad_u32_u24 v202, v202, s98, v200
v_accvgpr_write_b32 a1, v202
v_add_u32 v201, 299648, v201
v_lshrrev_b32 v202, 16, v201
v_mad_u32_u24 v202, v202, s98, v200
v_accvgpr_write_b32 a2, v202
v_add_u32 v201, 299648, v201
v_lshrrev_b32 v202, 16, v201
v_mad_u32_u24 v202, v202, s98, v200
v_accvgpr_write_b32 a3, v202
v_add_u32 v200, 4096, v200
v_add_u32 v201, 299648, v201
v_lshrrev_b32 v202, 16, v201
v_mad_u32_u24 v202, v202, s98, v200
v_accvgpr_write_b32 a4, v202
v_add_u32 v201, 299648, v201
v_lshrrev_b32 v202, 16, v201
v_mad_u32_u24 v202, v202, s98, v200
v_accvgpr_write_b32 a5, v202
v_add_u32 v201, 299648, v201
v_lshrrev_b32 v202, 16, v201
v_mad_u32_u24 v202, v202, s98, v200
v_accvgpr_write_b32 a6, v202
s_mov_b32 s51, 0x40000
L_fc_s1:
s_cmp_eq_u32 s99, 0
s_waitcnt vmcnt(12)
s_cbranch_scc1 L_fc_w0
s_waitcnt vmcnt(3)
L_fc_w0:
v_mfma_f32_32x32x16_bf16 v[216:231], v[16:19], v[48:51], 0
v_cvt_pk_bf16_f32 v112, v168, v169
v_cvt_pk_bf16_f32 v120, v184, v185
v_cvt_pk_bf16_f32 v128, -v184, -v185
v_mfma_f32_32x32x16_bf16 v[232:247], v[16:19], v[64:67], 0
v_cvt_pk_bf16_f32 v113, v170, v171
v_cvt_pk_bf16_f32 v121, v186, v187
v_cvt_pk_bf16_f32 v129, -v186, -v187
s_waitcnt vmcnt(11)
s_cbranch_scc1 L_fc_w1
s_waitcnt vmcnt(2)
L_fc_w1:
v_mfma_f32_32x32x16_bf16 v[216:231], v[20:23], v[52:55], v[216:231]
v_cvt_pk_bf16_f32 v114, v172, v173
v_cvt_pk_bf16_f32 v122, v188, v189
v_cvt_pk_bf16_f32 v130, -v188, -v189
v_mfma_f32_32x32x16_bf16 v[232:247], v[20:23], v[68:71], v[232:247]
v_cvt_pk_bf16_f32 v115, v174, v175
v_cvt_pk_bf16_f32 v123, v190, v191
v_cvt_pk_bf16_f32 v131, -v190, -v191
s_waitcnt vmcnt(10)
s_cbranch_scc1 L_fc_w2
s_waitcnt vmcnt(1)
L_fc_w2:
v_mfma_f32_32x32x16_bf16 v[216:231], v[24:27], v[56:59], v[216:231]
v_cvt_pk_bf16_f32 v116, v176, v177
v_cvt_pk_bf16_f32 v124, v192, v193
v_cvt_pk_bf16_f32 v132, -v192, -v193
v_mfma_f32_32x32x16_bf16 v[232:247], v[24:27], v[72:75], v[232:247]
v_cvt_pk_bf16_f32 v117, v178, v179
v_cvt_pk_bf16_f32 v125, v194, v195
v_cvt_pk_bf16_f32 v133, -v194, -v195
s_waitcnt vmcnt(9)
s_cbranch_scc1 L_fc_w3
s_waitcnt vmcnt(0)
L_fc_w3:
v_mfma_f32_32x32x16_bf16 v[216:231], v[28:31], v[60:63], v[216:231]
v_cvt_pk_bf16_f32 v118, v180, v181
v_cvt_pk_bf16_f32 v126, v196, v197
v_cvt_pk_bf16_f32 v134, -v196, -v197
v_mfma_f32_32x32x16_bf16 v[232:247], v[28:31], v[76:79], v[232:247]
v_cvt_pk_bf16_f32 v119, v182, v183
v_cvt_pk_bf16_f32 v127, v198, v199
v_cvt_pk_bf16_f32 v135, -v198, -v199
v_xor_b32 v248, s99, v16
v_xor_b32 v249, s99, v20
v_or_b32 v248, v248, v249
v_xor_b32 v249, s99, v24
v_or_b32 v248, v248, v249
v_xor_b32 v249, s99, v28
v_or_b32 v248, v248, v249
v_and_b32 v248, 1, v248
v_cmp_ne_u32 vcc, 0, v248
s_cbranch_vccz L_fc_zok
L_fc_zok_l:
s_sub_u32 s51, s51, 1
s_cmp_eq_u32 s51, 0
s_cbranch_scc1 L_fc_zok
v_and_b32 v248, 1, v16
v_cmp_ne_u32 vcc, s99, v248
s_nop 0
s_and_b64 exec, vcc, exec
buffer_load_dwordx4 v[16:19], v4, s[8:11], s30 offen sc1
s_mov_b64 exec, -1
s_add_u32 s53, s30, 4096
v_and_b32 v248, 1, v20
v_cmp_ne_u32 vcc, s99, v248
s_nop 0
s_and_b64 exec, vcc, exec
buffer_load_dwordx4 v[20:23], v4, s[8:11], s53 offen sc1
s_mov_b64 exec, -1
s_add_u32 s53, s30, 8192
v_and_b32 v248, 1, v24
v_cmp_ne_u32 vcc, s99, v248
s_nop 0
s_and_b64 exec, vcc, exec
buffer_load_dwordx4 v[24:27], v4, s[8:11], s53 offen sc1
s_mov_b64 exec, -1
s_add_u32 s53, s30, 12288
v_and_b32 v248, 1, v28
v_cmp_ne_u32 vcc, s99, v248
s_nop 0
s_and_b64 exec, vcc, exec
buffer_load_dwordx4 v[28:31], v4, s[8:11], s53 offen sc1
s_mov_b64 exec, -1
s_waitcnt vmcnt(0)
v_xor_b32 v248, s99, v16
v_xor_b32 v249, s99, v20
v_or_b32 v248, v248, v249
v_xor_b32 v249, s99, v24
v_or_b32 v248, v248, v249
v_xor_b32 v249, s99, v28
v_or_b32 v248, v248, v249
v_and_b32 v248, 1, v248
v_cmp_ne_u32 vcc, 0, v248
s_nop 4
s_cbranch_vccnz L_fc_zok_l
s_branch L_fc_s1
L_fc_zok:
s_waitcnt lgkmcnt(0)
v_accvgpr_read_b32 v16, a0
v_accvgpr_read_b32 v17, a1
v_accvgpr_read_b32 v18, a2
v_accvgpr_read_b32 v19, a3
v_accvgpr_read_b32 v20, a4
v_accvgpr_read_b32 v21, a5
v_accvgpr_read_b32 v22, a6
v_pk_mul_f32 v[6:7], v[216:217], v[136:137]
v_pk_mul_f32 v[8:9], v[232:233], v[136:137]
v_pk_fma_f32 v[6:7], v[232:233], v[152:153], v[6:7]
v_pk_fma_f32 v[8:9], v[216:217], v[152:153], v[8:9] neg_lo:[0,1,0] neg_hi:[0,1,0]
v_cvt_pk_bf16_f32 v200, v6, v7
v_cvt_pk_bf16_f32 v208, v8, v9
v_pk_mul_f32 v[10:11], v[218:219], v[138:139]
v_pk_mul_f32 v[12:13], v[234:235], v[138:139]
v_pk_fma_f32 v[10:11], v[234:235], v[154:155], v[10:11]
v_pk_fma_f32 v[12:13], v[218:219], v[154:155], v[12:13] neg_lo:[0,1,0] neg_hi:[0,1,0]
v_cvt_pk_bf16_f32 v201, v10, v11
v_cvt_pk_bf16_f32 v209, v12, v13
v_pk_mul_f32 v[6:7], v[220:221], v[140:141]
v_pk_mul_f32 v[8:9], v[236:237], v[140:141]
v_pk_fma_f32 v[6:7], v[236:237], v[156:157], v[6:7]
v_pk_fma_f32 v[8:9], v[220:221], v[156:157], v[8:9] neg_lo:[0,1,0] neg_hi:[0,1,0]
v_cvt_pk_bf16_f32 v202, v6, v7
v_cvt_pk_bf16_f32 v210, v8, v9
v_pk_mul_f32 v[10:11], v[222:223], v[142:143]
v_pk_mul_f32 v[12:13], v[238:239], v[142:143]
v_pk_fma_f32 v[10:11], v[238:239], v[158:159], v[10:11]
v_pk_fma_f32 v[12:13], v[222:223], v[158:159], v[12:13] neg_lo:[0,1,0] neg_hi:[0,1,0]
v_cvt_pk_bf16_f32 v203, v10, v11
v_cvt_pk_bf16_f32 v211, v12, v13
v_mul_f32 v6, v224, v144
v_mul_f32 v8, v240, v144
v_mfma_f32_32x32x16_bf16 v[48:63], v[112:115], v[200:203], 0
v_mul_f32 v7, v225, v145
v_mul_f32 v9, v241, v145
v_fmac_f32 v6, v240, v160
v_fma_f32 v8, -v224, v160, v8
v_fmac_f32 v7, v241, v161
v_fma_f32 v9, -v225, v161, v9
v_cvt_pk_bf16_f32 v204, v6, v7
v_cvt_pk_bf16_f32 v212, v8, v9
v_mul_f32 v10, v226, v146
v_mul_f32 v12, v242, v146
v_mfma_f32_32x32x16_bf16 v[64:79], v[112:115], v[208:211], 0
v_mul_f32 v11, v227, v147
v_mul_f32 v13, v243, v147
v_fmac_f32 v10, v242, v162
v_fma_f32 v12, -v226, v162, v12
v_fmac_f32 v11, v243, v163
v_fma_f32 v13, -v227, v163, v13
v_cvt_pk_bf16_f32 v205, v10, v11
v_cvt_pk_bf16_f32 v213, v12, v13
v_mul_f32 v6, v228, v148
v_mul_f32 v8, v244, v148
v_mfma_f32_32x32x16_bf16 v[48:63], v[120:123], v[208:211], v[48:63]
v_mul_f32 v7, v229, v149
v_mul_f32 v9, v245, v149
v_fmac_f32 v6, v244, v164
v_fma_f32 v8, -v228, v164, v8
v_fmac_f32 v7, v245, v165
v_fma_f32 v9, -v229, v165, v9
v_cvt_pk_bf16_f32 v206, v6, v7
v_cvt_pk_bf16_f32 v214, v8, v9
v_mul_f32 v10, v230, v150
v_mul_f32 v12, v246, v150
v_mfma_f32_32x32x16_bf16 v[64:79], v[128:131], v[200:203], v[64:79]
v_mul_f32 v11, v231, v151
v_mul_f32 v13, v247, v151
v_fmac_f32 v10, v246, v166
v_fma_f32 v12, -v230, v166, v12
v_fmac_f32 v11, v247, v167
v_fma_f32 v13, -v231, v167, v13
v_cvt_pk_bf16_f32 v207, v10, v11
v_cvt_pk_bf16_f32 v215, v12, v13
s_nop 0
v_mfma_f32_32x32x16_bf16 v[48:63], v[116:119], v[204:207], v[48:63]
s_waitcnt vmcnt(5)
v_lshlrev_b32 v168, 16, v32
v_and_b32 v184, 0xffff0000, v32
v_lshlrev_b32 v169, 16, v33
v_and_b32 v185, 0xffff0000, v33
v_lshlrev_b32 v170, 16, v34
v_mfma_f32_32x32x16_bf16 v[64:79], v[116:119], v[212:215], v[64:79]
v_and_b32 v186, 0xffff0000, v34
v_lshlrev_b32 v171, 16, v35
v_and_b32 v187, 0xffff0000, v35
v_lshlrev_b32 v172, 16, v36
v_and_b32 v188, 0xffff0000, v36
v_lshlrev_b32 v173, 16, v37
v_mfma_f32_32x32x16_bf16 v[48:63], v[124:127], v[212:215], v[48:63]
v_and_b32 v189, 0xffff0000, v37
v_lshlrev_b32 v174, 16, v38
v_and_b32 v190, 0xffff0000, v38
v_lshlrev_b32 v175, 16, v39
v_and_b32 v191, 0xffff0000, v39
v_lshlrev_b32 v176, 16, v40
v_mfma_f32_32x32x16_bf16 v[64:79], v[132:135], v[204:207], v[64:79]
v_and_b32 v192, 0xffff0000, v40
v_lshlrev_b32 v177, 16, v41
v_and_b32 v193, 0xffff0000, v41
v_lshlrev_b32 v178, 16, v42
v_and_b32 v194, 0xffff0000, v42
v_lshlrev_b32 v179, 16, v43
v_and_b32 v195, 0xffff0000, v43
v_lshlrev_b32 v180, 16, v44
v_and_b32 v196, 0xffff0000, v44
v_lshlrev_b32 v181, 16, v45
v_and_b32 v197, 0xffff0000, v45
v_lshlrev_b32 v182, 16, v46
v_and_b32 v198, 0xffff0000, v46
v_lshlrev_b32 v183, 16, v47
v_and_b32 v199, 0xffff0000, v47
v_pk_mul_f32 v[6:7], v[48:49], v[168:169]
v_pk_mul_f32 v[8:9], v[64:65], v[168:169]
v_pk_fma_f32 v[6:7], v[64:65], v[184:185], v[6:7] neg_lo:[0,1,0] neg_hi:[0,1,0]
v_pk_fma_f32 v[8:9], v[48:49], v[184:185], v[8:9]
v_cvt_pk_bf16_f32 v200, v6, v7
v_cvt_pk_bf16_f32 v208, v8, v9
v_pk_mul_f32 v[10:11], v[50:51], v[170:171]
v_pk_mul_f32 v[12:13], v[66:67], v[170:171]
v_pk_fma_f32 v[10:11], v[66:67], v[186:187], v[10:11] neg_lo:[0,1,0] neg_hi:[0,1,0]
v_pk_fma_f32 v[12:13], v[50:51], v[186:187], v[12:13]
v_cvt_pk_bf16_f32 v201, v10, v11
v_cvt_pk_bf16_f32 v209, v12, v13
v_pk_mul_f32 v[6:7], v[52:53], v[172:173]
v_pk_mul_f32 v[8:9], v[68:69], v[172:173]
v_pk_fma_f32 v[6:7], v[68:69], v[188:189], v[6:7] neg_lo:[0,1,0] neg_hi:[0,1,0]
v_pk_fma_f32 v[8:9], v[52:53], v[188:189], v[8:9]
v_cvt_pk_bf16_f32 v202, v6, v7
v_cvt_pk_bf16_f32 v210, v8, v9
v_pk_mul_f32 v[10:11], v[54:55], v[174:175]
v_pk_mul_f32 v[12:13], v[70:71], v[174:175]
v_pk_fma_f32 v[10:11], v[70:71], v[190:191], v[10:11] neg_lo:[0,1,0] neg_hi:[0,1,0]
v_pk_fma_f32 v[12:13], v[54:55], v[190:191], v[12:13]
v_cvt_pk_bf16_f32 v203, v10, v11
v_cvt_pk_bf16_f32 v211, v12, v13
v_mul_f32 v6, v56, v176
v_mul_f32 v8, v72, v176
v_mfma_f32_32x32x16_bf16 v[216:231], v[200:203], v[112:115], 0
s_add_u32 m0, s3, 86016
s_nop 0
buffer_load_dwordx4 v16, s[12:15], s52 offen offset:0  lds
v_mul_f32 v7, v57, v177
v_mul_f32 v9, v73, v177
v_fma_f32 v6, -v72, v192, v6
v_fmac_f32 v8, v56, v192
v_fma_f32 v7, -v73, v193, v7
v_fmac_f32 v9, v57, v193
v_cvt_pk_bf16_f32 v204, v6, v7
v_cvt_pk_bf16_f32 v212, v8, v9
v_mul_f32 v10, v58, v178
v_mul_f32 v12, v74, v178
v_mfma_f32_32x32x16_bf16 v[232:247], v[208:211], v[112:115], 0
buffer_load_dwordx4 v17, s[12:15], s52 offen offset:1024  lds
v_mul_f32 v11, v59, v179
v_mul_f32 v13, v75, v179
v_fma_f32 v10, -v74, v194, v10
v_fmac_f32 v12, v58, v194
v_fma_f32 v11, -v75, v195, v11
v_fmac_f32 v13, v59, v195
v_cvt_pk_bf16_f32 v205, v10, v11
v_cvt_pk_bf16_f32 v213, v12, v13
v_mul_f32 v6, v60, v180
v_mul_f32 v8, v76, v180
v_mfma_f32_32x32x16_bf16 v[216:231], v[208:211], v[128:131], v[216:231]
buffer_load_dwordx4 v18, s[12:15], s52 offen offset:2048  lds
v_mul_f32 v7, v61, v181
v_mul_f32 v9, v77, v181
v_fma_f32 v6, -v76, v196, v6
v_fmac_f32 v8, v60, v196
v_fma_f32 v7, -v77, v197, v7
v_fmac_f32 v9, v61, v197
v_cvt_pk_bf16_f32 v206, v6, v7
v_cvt_pk_bf16_f32 v214, v8, v9
v_mul_f32 v10, v62, v182
v_mul_f32 v12, v78, v182
v_mfma_f32_32x32x16_bf16 v[232:247], v[200:203], v[120:123], v[232:247]
buffer_load_dwordx4 v19, s[12:15], s52 offen offset:3072  lds
s_add_u32 m0, s3, 90112
v_mul_f32 v11, v63, v183
v_mul_f32 v13, v79, v183
v_fma_f32 v10, -v78, v198, v10
v_fmac_f32 v12, v62, v198
v_fma_f32 v11, -v79, v199, v11
v_fmac_f32 v13, v63, v199
v_cvt_pk_bf16_f32 v207, v10, v11
v_cvt_pk_bf16_f32 v215, v12, v13
s_nop 0
v_mfma_f32_32x32x16_bf16 v[216:231], v[204:207], v[116:119], v[216:231]
buffer_load_dwordx4 v20, s[12:15], s52 offen offset:0  lds
s_add_u32 s24, s6, 5242880
s_addc_u32 s25, s7, 0
s_and_b32 s25, s25, 0xffff
s_mov_b32 s26, 4227072
s_mov_b32 s27, 0x20000
s_lshl_b32 s33, s29, 12
v_mfma_f32_32x32x16_bf16 v[232:247], v[212:215], v[116:119], v[232:247]
buffer_load_dwordx4 v21, s[12:15], s52 offen offset:1024  lds
s_add_u32 s33, s33, 0
v_lshl_add_u32 v14, v1, 4, s33
s_lshl_b32 s33, s29, 8
s_add_u32 s33, s33, 0
v_lshl_add_u32 v252, v1, 2, s33
s_cmp_eq_u32 s2, 0
s_cselect_b32 s33, 8192, 0
v_mfma_f32_32x32x16_bf16 v[216:231], v[212:215], v[132:135], v[216:231]
buffer_load_dwordx4 v22, s[12:15], s52 offen offset:2048  lds
s_add_u32 s52, s52, 458752
v_bfe_u32 v4, v1, 1, 1
v_mul_u32_u24 v4, s33, v4
v_sub_u32 v253, v252, v4
v_add_u32 v253, 8192, v253
v_add_u32 v252, v252, v4
s_lshl_b32 s33, s29, 4
v_mfma_f32_32x32x16_bf16 v[232:247], v[204:207], v[124:127], v[232:247]
v_lshrrev_b32 v4, 2, v1
v_add_u32 v4, s33, v4
v_mul_u32_u24 v15, 16512, v4
v_and_b32 v4, 3, v1
v_lshl_add_u32 v15, v4, 4, v15
s_lshl_b32 s42, s2, 6
s_add_u32 s43, s42, 1056768
s_add_u32 s44, s42, 2113536
s_add_u32 s45, s42, 3170304
v_pk_mul_f32 v[6:7], v[216:217], v[136:137]
s_nop 1
v_pk_mul_f32 v[8:9], v[232:233], v[136:137]
v_pk_fma_f32 v[6:7], v[232:233], v[152:153], v[6:7] neg_lo:[0,1,0] neg_hi:[0,1,0]
v_pk_fma_f32 v[8:9], v[216:217], v[152:153], v[8:9]
v_cvt_pk_bf16_f32 v200, v6, v7
v_cvt_pk_bf16_f32 v208, v8, v9
v_pk_mul_f32 v[10:11], v[218:219], v[138:139]
v_pk_mul_f32 v[12:13], v[234:235], v[138:139]
v_pk_fma_f32 v[10:11], v[234:235], v[154:155], v[10:11] neg_lo:[0,1,0] neg_hi:[0,1,0]
v_pk_fma_f32 v[12:13], v[218:219], v[154:155], v[12:13]
v_cvt_pk_bf16_f32 v201, v10, v11
v_cvt_pk_bf16_f32 v209, v12, v13
v_pk_mul_f32 v[6:7], v[220:221], v[140:141]
v_pk_mul_f32 v[8:9], v[236:237], v[140:141]
v_pk_fma_f32 v[6:7], v[236:237], v[156:157], v[6:7] neg_lo:[0,1,0] neg_hi:[0,1,0]
v_pk_fma_f32 v[8:9], v[220:221], v[156:157], v[8:9]
v_cvt_pk_bf16_f32 v202, v6, v7
v_cvt_pk_bf16_f32 v210, v8, v9
v_pk_mul_f32 v[10:11], v[222:223], v[142:143]
v_pk_mul_f32 v[12:13], v[238:239], v[142:143]
v_pk_fma_f32 v[10:11], v[238:239], v[158:159], v[10:11] neg_lo:[0,1,0] neg_hi:[0,1,0]
v_pk_fma_f32 v[12:13], v[222:223], v[158:159], v[12:13]
v_cvt_pk_bf16_f32 v203, v10, v11
v_cvt_pk_bf16_f32 v211, v12, v13
v_mul_f32 v6, v224, v144
v_mul_f32 v8, v240, v144
v_mfma_f32_32x32x16_bf16 v[48:63], v[80:83], v[200:203], 0
v_mul_f32 v7, v225, v145
v_mul_f32 v9, v241, v145
v_fma_f32 v6, -v240, v160, v6
v_fmac_f32 v8, v224, v160
v_fma_f32 v7, -v241, v161, v7
v_fmac_f32 v9, v225, v161
v_cvt_pk_bf16_f32 v204, v6, v7
v_cvt_pk_bf16_f32 v212, v8, v9
v_mul_f32 v10, v226, v146
v_mul_f32 v12, v242, v146
v_mfma_f32_32x32x16_bf16 v[48:63], v[96:99], v[208:211], v[48:63]
v_mul_f32 v11, v227, v147
v_mul_f32 v13, v243, v147
v_fma_f32 v10, -v242, v162, v10
v_fmac_f32 v12, v226, v162
v_fma_f32 v11, -v243, v163, v11
v_fmac_f32 v13, v227, v163
v_cvt_pk_bf16_f32 v205, v10, v11
v_cvt_pk_bf16_f32 v213, v12, v13
v_mul_f32 v6, v228, v148
v_mul_f32 v8, v244, v148
v_mfma_f32_32x32x16_bf16 v[64:79], v[88:91], v[200:203], 0
v_mul_f32 v7, v229, v149
v_mul_f32 v9, v245, v149
v_fma_f32 v6, -v244, v164, v6
v_fmac_f32 v8, v228, v164
v_fma_f32 v7, -v245, v165, v7
v_fmac_f32 v9, v229, v165
v_cvt_pk_bf16_f32 v206, v6, v7
v_cvt_pk_bf16_f32 v214, v8, v9
v_mul_f32 v10, v230, v150
v_mul_f32 v12, v246, v150
v_mfma_f32_32x32x16_bf16 v[64:79], v[104:107], v[208:211], v[64:79]
v_mul_f32 v11, v231, v151
v_mul_f32 v13, v247, v151
v_fma_f32 v10, -v246, v166, v10
v_fmac_f32 v12, v230, v166
v_fma_f32 v11, -v247, v167, v11
v_fmac_f32 v13, v231, v167
v_cvt_pk_bf16_f32 v207, v10, v11
v_cvt_pk_bf16_f32 v215, v12, v13
s_nop 0
v_mfma_f32_32x32x16_bf16 v[48:63], v[84:87], v[204:207], v[48:63]
s_lshr_b32 s33, s29, 1
s_or_b32 s33, s33, s2
v_mfma_f32_32x32x16_bf16 v[48:63], v[100:103], v[212:215], v[48:63]
v_mfma_f32_32x32x16_bf16 v[64:79], v[92:95], v[204:207], v[64:79]
v_mfma_f32_32x32x16_bf16 v[64:79], v[108:111], v[212:215], v[64:79]
s_cmp_lg_u32 s33, 0
s_nop 7
s_cbranch_scc1 L_fc_nofix
v_pk_add_f32 v[52:53], v[48:49], v[52:53]
v_pk_mul_f32 v[52:53], v[52:53], 0.5 op_sel_hi:[1,0]
v_mov_b32 v48, 0
v_mov_b32 v49, 0
v_pk_add_f32 v[54:55], v[50:51], v[54:55]
v_pk_mul_f32 v[54:55], v[54:55], 0.5 op_sel_hi:[1,0]
v_mov_b32 v50, 0
v_mov_b32 v51, 0
v_pk_add_f32 v[60:61], v[56:57], v[60:61]
v_pk_mul_f32 v[60:61], v[60:61], 0.5 op_sel_hi:[1,0]
v_mov_b32 v56, 0
v_mov_b32 v57, 0
v_pk_add_f32 v[62:63], v[58:59], v[62:63]
v_pk_mul_f32 v[62:63], v[62:63], 0.5 op_sel_hi:[1,0]
v_mov_b32 v58, 0
v_mov_b32 v59, 0
v_pk_add_f32 v[68:69], v[64:65], v[68:69]
v_pk_mul_f32 v[68:69], v[68:69], 0.5 op_sel_hi:[1,0]
v_mov_b32 v64, 0
v_mov_b32 v65, 0
v_pk_add_f32 v[70:71], v[66:67], v[70:71]
v_pk_mul_f32 v[70:71], v[70:71], 0.5 op_sel_hi:[1,0]
v_mov_b32 v66, 0
v_mov_b32 v67, 0
v_pk_add_f32 v[76:77], v[72:73], v[76:77]
v_pk_mul_f32 v[76:77], v[76:77], 0.5 op_sel_hi:[1,0]
v_mov_b32 v72, 0
v_mov_b32 v73, 0
v_pk_add_f32 v[78:79], v[74:75], v[78:79]
v_pk_mul_f32 v[78:79], v[78:79], 0.5 op_sel_hi:[1,0]
v_mov_b32 v74, 0
v_mov_b32 v75, 0
L_fc_nofix:
v_cvt_pk_bf16_f32 v216, v48, v49
v_cvt_pk_bf16_f32 v217, v50, v51
v_cvt_pk_bf16_f32 v218, v52, v53
v_cvt_pk_bf16_f32 v219, v54, v55
ds_write_b128 v14, v[216:219] offset:0
v_cvt_pk_bf16_f32 v220, v56, v57
v_cvt_pk_bf16_f32 v221, v58, v59
v_cvt_pk_bf16_f32 v222, v60, v61
v_cvt_pk_bf16_f32 v223, v62, v63
ds_write_b128 v14, v[220:223] offset:1024
v_cvt_pk_bf16_f32 v224, v64, v65
v_cvt_pk_bf16_f32 v225, v66, v67
v_cvt_pk_bf16_f32 v226, v68, v69
v_cvt_pk_bf16_f32 v227, v70, v71
ds_write_b128 v14, v[224:227] offset:2048
v_cvt_pk_bf16_f32 v228, v72, v73
v_cvt_pk_bf16_f32 v229, v74, v75
v_cvt_pk_bf16_f32 v230, v76, v77
v_cvt_pk_bf16_f32 v231, v78, v79
ds_write_b128 v14, v[228:231] offset:3072
s_waitcnt vmcnt(8) lgkmcnt(0)
s_barrier
ds_read2st64_b32 v[232:233], v252 offset0:0 offset1:16
ds_read2st64_b32 v[234:235], v253 offset0:0 offset1:16
ds_read2st64_b32 v[236:237], v252 offset0:4 offset1:20
ds_read2st64_b32 v[238:239], v253 offset0:4 offset1:20
ds_read2st64_b32 v[240:241], v252 offset0:8 offset1:24
ds_read2st64_b32 v[242:243], v253 offset0:8 offset1:24
ds_read2st64_b32 v[244:245], v252 offset0:12 offset1:28
ds_read2st64_b32 v[246:247], v253 offset0:12 offset1:28
s_waitcnt lgkmcnt(6)
v_bfi_b32 v232, 1, s99, v232
buffer_store_dwordx4 v[232:235], v15, s[24:27], s42 offen sc1
s_waitcnt lgkmcnt(4)
v_bfi_b32 v236, 1, s99, v236
buffer_store_dwordx4 v[236:239], v15, s[24:27], s43 offen sc1
s_waitcnt lgkmcnt(2)
v_bfi_b32 v240, 1, s99, v240
buffer_store_dwordx4 v[240:243], v15, s[24:27], s44 offen sc1
s_waitcnt lgkmcnt(0)
v_bfi_b32 v244, 1, s99, v244
buffer_store_dwordx4 v[244:247], v15, s[24:27], s45 offen sc1
v_and_b32 v223, 63, v0
v_and_b32 v1, 63, v0
v_bfe_u32 v8, v1, 3, 2
v_and_b32 v9, 3, v1
v_lshl_add_u32 v8, v8, 2, v9
v_bfe_u32 v9, v1, 2, 1
v_lshl_add_u32 v3, v9, 4, v8
v_mul_u32_u24 v9, 31, v9
v_xor_b32 v8, v8, v9
v_lshrrev_b32 v2, 5, v1
v_sub_u32 v4, 32, v8
v_cmp_eq_u32 vcc, 0, v2
v_lshlrev_b32 v6, 6, v3
v_lshl_add_u32 v6, v2, 5, v6
v_cndmask_b32 v4, v4, v8, vcc
v_add_u32 v5, 224, v4
v_and_b32 v5, 255, v5
v_lshlrev_b32 v4, 6, v4
v_lshl_add_u32 v4, v2, 5, v4
v_lshlrev_b32 v5, 6, v5
v_lshl_add_u32 v5, v2, 5, v5
s_lshr_b32 s32, s29, 1
s_and_b32 s33, s29, 1
s_mul_i32 s30, s95, 16512
s_lshl_b32 s31, s32, 4
s_add_u32 s30, s30, s31
s_add_u32 s16, s6, 5242880
s_addc_u32 s17, s7, 0
s_and_b32 s17, s17, 0xffff
s_mov_b32 s18, 4227072
s_mov_b32 s19, 0x20000
s_lshl_b32 s31, s32, 2
s_add_u32 s31, s31, s33
s_mul_i32 s31, s31, 2064
s_add_u32 s31, s31, 36352
v_add_u32 v6, s31, v6
ds_read_b128 v[48:51], v6 offset:0
ds_read_b128 v[52:55], v6 offset:16
ds_read_b128 v[56:59], v6 offset:4128
ds_read_b128 v[60:63], v6 offset:4144
v_cvt_f32_u32 v12, v3
v_mul_f32 v12, 0x3d000000, v12
v_cvt_f32_u32 v13, v2
v_fma_f32 v10, v13, -2.0, 1.0
v_mul_f32 v10, v10, v12
v_mul_f32 v11, v13, v12
v_mul_f32 v11, 0x41f80000, v11
v_cos_f32 v184, v11
v_sin_f32 v200, v11
v_fmamk_f32 v9, v10, 0x3f800000, v11
v_cos_f32 v185, v9
v_sin_f32 v201, v9
v_fmamk_f32 v8, v10, 0x40000000, v11
v_cos_f32 v186, v8
v_sin_f32 v202, v8
v_fmamk_f32 v9, v10, 0x40400000, v11
v_cos_f32 v187, v9
v_sin_f32 v203, v9
v_fmamk_f32 v8, v10, 0x40800000, v11
v_cos_f32 v188, v8
v_sin_f32 v204, v8
v_fmamk_f32 v9, v10, 0x40a00000, v11
v_cos_f32 v189, v9
v_sin_f32 v205, v9
v_fmamk_f32 v8, v10, 0x40c00000, v11
v_cos_f32 v190, v8
v_sin_f32 v206, v8
v_fmamk_f32 v9, v10, 0x40e00000, v11
v_cos_f32 v191, v9
v_sin_f32 v207, v9
v_fmamk_f32 v8, v10, 0x41000000, v11
v_cos_f32 v192, v8
v_sin_f32 v208, v8
v_fmamk_f32 v9, v10, 0x41100000, v11
v_cos_f32 v193, v9
v_sin_f32 v209, v9
v_fmamk_f32 v8, v10, 0x41200000, v11
v_cos_f32 v194, v8
v_sin_f32 v210, v8
v_fmamk_f32 v9, v10, 0x41300000, v11
v_cos_f32 v195, v9
v_sin_f32 v211, v9
v_fmamk_f32 v8, v10, 0x41400000, v11
v_cos_f32 v196, v8
v_sin_f32 v212, v8
v_fmamk_f32 v9, v10, 0x41500000, v11
v_cos_f32 v197, v9
v_sin_f32 v213, v9
v_fmamk_f32 v8, v10, 0x41600000, v11
v_cos_f32 v198, v8
v_sin_f32 v214, v8
v_fmamk_f32 v9, v10, 0x41700000, v11
v_cos_f32 v199, v9
v_sin_f32 v215, v9
s_mul_i32 s31, s33, 0x80008000
v_cvt_pk_bf16_f32 v64, v184, -v200
v_cvt_pk_bf16_f32 v96, v200, v184
v_xor_b32 v65, s31, v64
v_xor_b32 v97, s31, v96
v_cvt_pk_bf16_f32 v66, v192, -v208
v_cvt_pk_bf16_f32 v98, v208, v192
v_xor_b32 v67, s31, v66
v_xor_b32 v99, s31, v98
v_cvt_pk_bf16_f32 v68, v185, -v201
v_cvt_pk_bf16_f32 v100, v201, v185
v_xor_b32 v69, s31, v68
v_xor_b32 v101, s31, v100
v_cvt_pk_bf16_f32 v70, v193, -v209
v_cvt_pk_bf16_f32 v102, v209, v193
v_xor_b32 v71, s31, v70
v_xor_b32 v103, s31, v102
v_cvt_pk_bf16_f32 v72, v186, -v202
v_cvt_pk_bf16_f32 v104, v202, v186
v_xor_b32 v73, s31, v72
v_xor_b32 v105, s31, v104
v_cvt_pk_bf16_f32 v74, v194, -v210
v_cvt_pk_bf16_f32 v106, v210, v194
v_xor_b32 v75, s31, v74
v_xor_b32 v107, s31, v106
v_cvt_pk_bf16_f32 v76, v187, -v203
v_cvt_pk_bf16_f32 v108, v203, v187
v_xor_b32 v77, s31, v76
v_xor_b32 v109, s31, v108
v_cvt_pk_bf16_f32 v78, v195, -v211
v_cvt_pk_bf16_f32 v110, v211, v195
v_xor_b32 v79, s31, v78
v_xor_b32 v111, s31, v110
v_cvt_pk_bf16_f32 v80, v188, -v204
v_cvt_pk_bf16_f32 v112, v204, v188
v_xor_b32 v81, s31, v80
v_xor_b32 v113, s31, v112
v_cvt_pk_bf16_f32 v82, v196, -v212
v_cvt_pk_bf16_f32 v114, v212, v196
v_xor_b32 v83, s31, v82
v_xor_b32 v115, s31, v114
v_cvt_pk_bf16_f32 v84, v189, -v205
v_cvt_pk_bf16_f32 v116, v205, v189
v_xor_b32 v85, s31, v84
v_xor_b32 v117, s31, v116
v_cvt_pk_bf16_f32 v86, v197, -v213
v_cvt_pk_bf16_f32 v118, v213, v197
v_xor_b32 v87, s31, v86
v_xor_b32 v119, s31, v118
v_cvt_pk_bf16_f32 v88, v190, -v206
v_cvt_pk_bf16_f32 v120, v206, v190
v_xor_b32 v89, s31, v88
v_xor_b32 v121, s31, v120
v_cvt_pk_bf16_f32 v90, v198, -v214
v_cvt_pk_bf16_f32 v122, v214, v198
v_xor_b32 v91, s31, v90
v_xor_b32 v123, s31, v122
v_cvt_pk_bf16_f32 v92, v191, -v207
v_cvt_pk_bf16_f32 v124, v207, v191
v_xor_b32 v93, s31, v92
v_xor_b32 v125, s31, v124
v_cvt_pk_bf16_f32 v94, v199, -v215
v_cvt_pk_bf16_f32 v126, v215, v199
v_xor_b32 v95, s31, v94
v_xor_b32 v127, s31, v126
v_cvt_pk_bf16_f32 v128, v184, v185
v_cvt_pk_bf16_f32 v136, v200, v201
v_cvt_pk_bf16_f32 v144, -v200, -v201
v_cvt_pk_bf16_f32 v129, v186, v187
v_cvt_pk_bf16_f32 v137, v202, v203
v_cvt_pk_bf16_f32 v145, -v202, -v203
v_cvt_pk_bf16_f32 v130, v188, v189
v_cvt_pk_bf16_f32 v138, v204, v205
v_cvt_pk_bf16_f32 v146, -v204, -v205
v_cvt_pk_bf16_f32 v131, v190, v191
v_cvt_pk_bf16_f32 v139, v206, v207
v_cvt_pk_bf16_f32 v147, -v206, -v207
v_cvt_pk_bf16_f32 v132, v192, v193
v_cvt_pk_bf16_f32 v140, v208, v209
v_cvt_pk_bf16_f32 v148, -v208, -v209
v_cvt_pk_bf16_f32 v133, v194, v195
v_cvt_pk_bf16_f32 v141, v210, v211
v_cvt_pk_bf16_f32 v149, -v210, -v211
v_cvt_pk_bf16_f32 v134, v196, v197
v_cvt_pk_bf16_f32 v142, v212, v213
v_cvt_pk_bf16_f32 v150, -v212, -v213
v_cvt_pk_bf16_f32 v135, v198, v199
v_cvt_pk_bf16_f32 v143, v214, v215
v_cvt_pk_bf16_f32 v151, -v214, -v215
v_mul_f32 v10, 0x3d000000, v10
v_mul_f32 v11, 0x3d000000, v11
v_cos_f32 v152, v11
v_sin_f32 v168, v11
v_fmamk_f32 v9, v10, 0x3f800000, v11
v_cos_f32 v153, v9
v_sin_f32 v169, v9
v_fmamk_f32 v8, v10, 0x40000000, v11
v_cos_f32 v154, v8
v_sin_f32 v170, v8
v_fmamk_f32 v9, v10, 0x40400000, v11
v_cos_f32 v155, v9
v_sin_f32 v171, v9
v_fmamk_f32 v8, v10, 0x40800000, v11
v_cos_f32 v156, v8
v_sin_f32 v172, v8
v_fmamk_f32 v9, v10, 0x40a00000, v11
v_cos_f32 v157, v9
v_sin_f32 v173, v9
v_fmamk_f32 v8, v10, 0x40c00000, v11
v_cos_f32 v158, v8
v_sin_f32 v174, v8
v_fmamk_f32 v9, v10, 0x40e00000, v11
v_cos_f32 v159, v9
v_sin_f32 v175, v9
v_fmamk_f32 v8, v10, 0x41000000, v11
v_cos_f32 v160, v8
v_sin_f32 v176, v8
v_fmamk_f32 v9, v10, 0x41100000, v11
v_cos_f32 v161, v9
v_sin_f32 v177, v9
v_fmamk_f32 v8, v10, 0x41200000, v11
v_cos_f32 v162, v8
v_sin_f32 v178, v8
v_fmamk_f32 v9, v10, 0x41300000, v11
v_cos_f32 v163, v9
v_sin_f32 v179, v9
v_fmamk_f32 v8, v10, 0x41400000, v11
v_cos_f32 v164, v8
v_sin_f32 v180, v8
v_fmamk_f32 v9, v10, 0x41500000, v11
v_cos_f32 v165, v9
v_sin_f32 v181, v9
v_fmamk_f32 v8, v10, 0x41600000, v11
v_cos_f32 v166, v8
v_sin_f32 v182, v8
v_fmamk_f32 v9, v10, 0x41700000, v11
v_cos_f32 v167, v9
v_sin_f32 v183, v9
v_mov_b32 v12, 0x34800000
v_pk_mul_f32 v[152:153], v[152:153], v[12:13] op_sel_hi:[1,0]
v_pk_mul_f32 v[154:155], v[154:155], v[12:13] op_sel_hi:[1,0]
v_pk_mul_f32 v[156:157], v[156:157], v[12:13] op_sel_hi:[1,0]
v_pk_mul_f32 v[158:159], v[158:159], v[12:13] op_sel_hi:[1,0]
v_pk_mul_f32 v[160:161], v[160:161], v[12:13] op_sel_hi:[1,0]
v_pk_mul_f32 v[162:163], v[162:163], v[12:13] op_sel_hi:[1,0]
v_pk_mul_f32 v[164:165], v[164:165], v[12:13] op_sel_hi:[1,0]
v_pk_mul_f32 v[166:167], v[166:167], v[12:13] op_sel_hi:[1,0]
v_pk_mul_f32 v[168:169], v[168:169], v[12:13] op_sel_hi:[1,0]
v_pk_mul_f32 v[170:171], v[170:171], v[12:13] op_sel_hi:[1,0]
v_pk_mul_f32 v[172:173], v[172:173], v[12:13] op_sel_hi:[1,0]
v_pk_mul_f32 v[174:175], v[174:175], v[12:13] op_sel_hi:[1,0]
v_pk_mul_f32 v[176:177], v[176:177], v[12:13] op_sel_hi:[1,0]
v_pk_mul_f32 v[178:179], v[178:179], v[12:13] op_sel_hi:[1,0]
v_pk_mul_f32 v[180:181], v[180:181], v[12:13] op_sel_hi:[1,0]
v_pk_mul_f32 v[182:183], v[182:183], v[12:13] op_sel_hi:[1,0]
s_waitcnt lgkmcnt(0)
v_mov_b32 v12, 0x3f803f80
v_dot2_f32_bf16 v8, v48, v12, 0
v_dot2_f32_bf16 v9, v56, v12, 0
v_dot2_f32_bf16 v8, v49, v12, v8
v_dot2_f32_bf16 v9, v57, v12, v9
v_dot2_f32_bf16 v8, v50, v12, v8
v_dot2_f32_bf16 v9, v58, v12, v9
v_dot2_f32_bf16 v8, v51, v12, v8
v_dot2_f32_bf16 v9, v59, v12, v9
v_dot2_f32_bf16 v8, v52, v12, v8
v_dot2_f32_bf16 v9, v60, v12, v9
v_dot2_f32_bf16 v8, v53, v12, v8
v_dot2_f32_bf16 v9, v61, v12, v9
v_dot2_f32_bf16 v8, v54, v12, v8
v_dot2_f32_bf16 v9, v62, v12, v9
v_dot2_f32_bf16 v8, v55, v12, v8
v_dot2_f32_bf16 v9, v63, v12, v9
v_lshlrev_b32 v16, 16, v48
v_and_b32 v17, 0xffff0000, v48
v_lshlrev_b32 v18, 16, v49
s_waitcnt vmcnt(0)
s_barrier
v_and_b32 v19, 0xffff0000, v49
v_lshlrev_b32 v20, 16, v50
v_and_b32 v21, 0xffff0000, v50
v_lshlrev_b32 v22, 16, v51
v_and_b32 v23, 0xffff0000, v51
v_lshlrev_b32 v24, 16, v52
v_and_b32 v25, 0xffff0000, v52
v_lshlrev_b32 v26, 16, v53
v_and_b32 v27, 0xffff0000, v53
v_lshlrev_b32 v28, 16, v54
v_and_b32 v29, 0xffff0000, v54
v_lshlrev_b32 v30, 16, v55
v_and_b32 v31, 0xffff0000, v55
v_lshlrev_b32 v32, 16, v56
v_and_b32 v33, 0xffff0000, v56
v_lshlrev_b32 v34, 16, v57
v_and_b32 v35, 0xffff0000, v57
v_lshlrev_b32 v36, 16, v58
v_and_b32 v37, 0xffff0000, v58
v_lshlrev_b32 v38, 16, v59
v_and_b32 v39, 0xffff0000, v59
v_lshlrev_b32 v40, 16, v60
v_and_b32 v41, 0xffff0000, v60
v_lshlrev_b32 v42, 16, v61
v_and_b32 v43, 0xffff0000, v61
v_lshlrev_b32 v44, 16, v62
v_and_b32 v45, 0xffff0000, v62
v_lshlrev_b32 v46, 16, v63
v_and_b32 v47, 0xffff0000, v63
v_permlane32_swap_b32 v8, v9
v_add_f32 v8, v8, v9
v_mov_b32 v9, v8
s_nop 1
v_permlane16_swap_b32 v8, v9
v_add_f32 v8, v8, v9
s_nop 1
v_add_f32_dpp v8, v8, v8 row_ror:8 row_mask:0xf bank_mask:0xf
s_nop 1
v_add_f32_dpp v8, v8, v8 row_ror:4 row_mask:0xf bank_mask:0xf
s_nop 1
v_add_f32_dpp v8, v8, v8 row_ror:2 row_mask:0xf bank_mask:0xf
s_nop 1
v_add_f32_dpp v8, v8, v8 row_ror:1 row_mask:0xf bank_mask:0xf
v_mul_f32 v8, 0x3a800000, v8
s_nop 0
v_readlane_b32 s40, v8, 0
buffer_load_dwordx4 a[32:35], v4, s[16:19], s30 offen offset:0
buffer_load_dwordx4 a[36:39], v4, s[16:19], s30 offen offset:2048
s_add_u32 s53, s30, 4096
buffer_load_dwordx4 a[40:43], v4, s[16:19], s53 offen offset:0
buffer_load_dwordx4 a[44:47], v4, s[16:19], s53 offen offset:2048
s_add_u32 s53, s30, 8192
buffer_load_dwordx4 a[48:51], v4, s[16:19], s53 offen offset:0
buffer_load_dwordx4 a[52:55], v4, s[16:19], s53 offen offset:2048
s_add_u32 s53, s30, 12288
buffer_load_dwordx4 a[56:59], v4, s[16:19], s53 offen offset:0
buffer_load_dwordx4 a[60:63], v5, s[16:19], s30 offen
s_cmp_ge_u32 s29, 2
s_cselect_b32 s56, s38, s36
s_cselect_b32 s57, s39, s37
s_and_b32 s57, s57, 0xffff
s_mov_b32 s59, 0x20000
s_mul_i32 s53, s2, 4096
s_add_u32 s53, s53, 1048576
v_and_b32 v252, 127, v0
v_mul_u32_u24 v252, 1, v252
v_lshrrev_b32 v252, 2, v252
v_lshlrev_b32 v252, 7, v252
buffer_load_dword v252, v252, s[56:59], s53 offen
v_readlane_b32 s41, v8, 32
v_subrev_f32 v16, s40, v16
v_subrev_f32 v17, s40, v17
v_subrev_f32 v18, s40, v18
v_subrev_f32 v19, s40, v19
v_subrev_f32 v20, s40, v20
v_subrev_f32 v21, s40, v21
v_subrev_f32 v22, s40, v22
v_subrev_f32 v23, s40, v23
v_subrev_f32 v24, s40, v24
v_subrev_f32 v25, s40, v25
v_subrev_f32 v26, s40, v26
v_subrev_f32 v27, s40, v27
v_subrev_f32 v28, s40, v28
v_subrev_f32 v29, s40, v29
v_subrev_f32 v30, s40, v30
v_subrev_f32 v31, s40, v31
v_subrev_f32 v32, s41, v32
v_subrev_f32 v33, s41, v33
v_subrev_f32 v34, s41, v34
v_subrev_f32 v35, s41, v35
v_subrev_f32 v36, s41, v36
v_subrev_f32 v37, s41, v37
v_subrev_f32 v38, s41, v38
v_subrev_f32 v39, s41, v39
v_subrev_f32 v40, s41, v40
v_subrev_f32 v41, s41, v41
v_subrev_f32 v42, s41, v42
v_subrev_f32 v43, s41, v43
v_subrev_f32 v44, s41, v44
v_subrev_f32 v45, s41, v45
v_subrev_f32 v46, s41, v46
v_subrev_f32 v47, s41, v47
v_and_b32 v3, 31, v1
s_lshl_b32 s31, s32, 2
s_add_u32 s31, s31, s33
s_lshl_b32 s31, s31, 4
s_add_u32 s31, s31, 130048
v_mul_u32_u24 v216, 528, v3
v_lshl_add_u32 v216, v2, 8, v216
v_add_u32 v216, s31, v216
s_mul_i32 s31, s29, 1056
s_add_u32 s31, s31, 130048
v_mul_u32_u24 v217, 528, v2
v_lshl_add_u32 v217, v3, 4, v217
v_add_u32 v217, s31, v217
s_lshl_b32 s31, s33, 2
s_add_u32 s31, s31, s32
s_mul_i32 s31, s31, 2112
s_add_u32 s31, s31, 130048
v_mul_u32_u24 v219, 4224, v2
v_and_b32 v8, 7, v1
v_lshl_add_u32 v219, v8, 4, v219
v_bfe_u32 v9, v1, 4, 1
v_lshl_add_u32 v219, v9, 7, v219
v_bfe_u32 v9, v1, 3, 1
v_lshl_add_u32 v219, v9, 3, v219
v_add_u32 v219, s31, v219
v_lshrrev_b32 v218, 3, v1
v_lshlrev_b32 v218, 8, v218
v_lshl_add_u32 v218, v8, 4, v218
s_lshr_b32 s36, s95, 1
s_lshl_b32 s36, s36, 15
s_and_b32 s31, s95, 1
s_lshl_b32 s31, s31, 7
s_add_u32 s36, s36, s31
s_lshl_b32 s31, s32, 3
s_add_u32 s31, s31, s33
s_lshl_b32 s31, s31, 11
s_add_u32 s36, s36, s31
s_add_u32 s37, s36, 4096
s_add_u32 s38, s36, 8192
s_add_u32 s39, s36, 12288
s_add_u32 s8, s6, 15728640
s_addc_u32 s9, s7, 0
s_and_b32 s9, s9, 0xffff
s_mov_b32 s10, 4194304
s_mov_b32 s11, 0x20000
s_add_u32 s44, s6, 19922944
s_addc_u32 s45, s7, 0
s_and_b32 s45, s45, 0xffff
s_mov_b32 s46, 1048576
s_mov_b32 s47, 0x20000
v_accvgpr_read_b32 v228, a0
v_accvgpr_read_b32 v229, a1
v_accvgpr_read_b32 v230, a2
v_accvgpr_read_b32 v231, a3
v_accvgpr_read_b32 v232, a4
v_accvgpr_read_b32 v233, a5
v_accvgpr_read_b32 v234, a6
s_mov_b32 s51, 0x40000
L_f_s3:
s_waitcnt vmcnt(8)
v_mfma_f32_32x32x16_bf16 v[184:199], a[32:35], v[64:67], 0
v_accvgpr_read_b32 v10, a32
v_xor_b32 v10, s99, v10
v_mfma_f32_32x32x16_bf16 v[200:215], a[32:35], v[96:99], 0
s_waitcnt vmcnt(7)
v_mfma_f32_32x32x16_bf16 v[184:199], a[36:39], v[68:71], v[184:199]
v_accvgpr_read_b32 v11, a36
v_xor_b32 v11, s99, v11
v_or_b32 v10, v10, v11
v_mfma_f32_32x32x16_bf16 v[200:215], a[36:39], v[100:103], v[200:215]
s_waitcnt vmcnt(6)
v_mfma_f32_32x32x16_bf16 v[184:199], a[40:43], v[72:75], v[184:199]
v_accvgpr_read_b32 v11, a40
v_xor_b32 v11, s99, v11
v_or_b32 v10, v10, v11
v_mfma_f32_32x32x16_bf16 v[200:215], a[40:43], v[104:107], v[200:215]
s_waitcnt vmcnt(5)
v_mfma_f32_32x32x16_bf16 v[184:199], a[44:47], v[76:79], v[184:199]
v_accvgpr_read_b32 v11, a44
v_xor_b32 v11, s99, v11
v_or_b32 v10, v10, v11
v_mfma_f32_32x32x16_bf16 v[200:215], a[44:47], v[108:111], v[200:215]
s_waitcnt vmcnt(4)
v_mfma_f32_32x32x16_bf16 v[184:199], a[48:51], v[80:83], v[184:199]
v_accvgpr_read_b32 v11, a48
v_xor_b32 v11, s99, v11
v_or_b32 v10, v10, v11
v_mfma_f32_32x32x16_bf16 v[200:215], a[48:51], v[112:115], v[200:215]
s_waitcnt vmcnt(3)
v_mfma_f32_32x32x16_bf16 v[184:199], a[52:55], v[84:87], v[184:199]
v_accvgpr_read_b32 v11, a52
v_xor_b32 v11, s99, v11
v_or_b32 v10, v10, v11
v_mfma_f32_32x32x16_bf16 v[200:215], a[52:55], v[116:119], v[200:215]
s_waitcnt vmcnt(2)
v_mfma_f32_32x32x16_bf16 v[184:199], a[56:59], v[88:91], v[184:199]
v_accvgpr_read_b32 v11, a56
v_xor_b32 v11, s99, v11
v_or_b32 v10, v10, v11
v_mfma_f32_32x32x16_bf16 v[200:215], a[56:59], v[120:123], v[200:215]
s_waitcnt vmcnt(1)
v_mfma_f32_32x32x16_bf16 v[184:199], a[60:63], v[92:95], v[184:199]
v_accvgpr_read_b32 v11, a60
v_xor_b32 v11, s99, v11
v_or_b32 v10, v10, v11
v_mfma_f32_32x32x16_bf16 v[200:215], a[60:63], v[124:127], v[200:215]
v_and_b32 v10, 1, v10
v_cmp_ne_u32 vcc, 0, v10
s_nop 3
s_cbranch_vccz L_f_vok
L_f_vok_l:
s_sub_u32 s51, s51, 1
s_cmp_eq_u32 s51, 0
s_cbranch_scc1 L_f_vok
v_accvgpr_read_b32 v10, a32
v_and_b32 v10, 1, v10
v_cmp_ne_u32 vcc, s99, v10
s_nop 0
s_and_b64 exec, vcc, exec
buffer_load_dwordx4 a[32:35], v4, s[16:19], s30 offen offset:0 sc1
s_mov_b64 exec, -1
v_accvgpr_read_b32 v10, a36
v_and_b32 v10, 1, v10
v_cmp_ne_u32 vcc, s99, v10
s_nop 0
s_and_b64 exec, vcc, exec
buffer_load_dwordx4 a[36:39], v4, s[16:19], s30 offen offset:2048 sc1
s_mov_b64 exec, -1
s_add_u32 s53, s30, 4096
v_accvgpr_read_b32 v10, a40
v_and_b32 v10, 1, v10
v_cmp_ne_u32 vcc, s99, v10
s_nop 0
s_and_b64 exec, vcc, exec
buffer_load_dwordx4 a[40:43], v4, s[16:19], s53 offen offset:0 sc1
s_mov_b64 exec, -1
v_accvgpr_read_b32 v10, a44
v_and_b32 v10, 1, v10
v_cmp_ne_u32 vcc, s99, v10
s_nop 0
s_and_b64 exec, vcc, exec
buffer_load_dwordx4 a[44:47], v4, s[16:19], s53 offen offset:2048 sc1
s_mov_b64 exec, -1
s_add_u32 s53, s30, 8192
v_accvgpr_read_b32 v10, a48
v_and_b32 v10, 1, v10
v_cmp_ne_u32 vcc, s99, v10
s_nop 0
s_and_b64 exec, vcc, exec
buffer_load_dwordx4 a[48:51], v4, s[16:19], s53 offen offset:0 sc1
s_mov_b64 exec, -1
v_accvgpr_read_b32 v10, a52
v_and_b32 v10, 1, v10
v_cmp_ne_u32 vcc, s99, v10
s_nop 0
s_and_b64 exec, vcc, exec
buffer_load_dwordx4 a[52:55], v4, s[16:19], s53 offen offset:2048 sc1
s_mov_b64 exec, -1
s_add_u32 s53, s30, 12288
v_accvgpr_read_b32 v10, a56
v_and_b32 v10, 1, v10
v_cmp_ne_u32 vcc, s99, v10
s_nop 0
s_and_b64 exec, vcc, exec
buffer_load_dwordx4 a[56:59], v4, s[16:19], s53 offen offset:0 sc1
s_mov_b64 exec, -1
v_accvgpr_read_b32 v10, a60
v_and_b32 v10, 1, v10
v_cmp_ne_u32 vcc, s99, v10
s_nop 0
s_and_b64 exec, vcc, exec
buffer_load_dwordx4 a[60:63], v5, s[16:19], s30 offen sc1
s_mov_b64 exec, -1
s_waitcnt vmcnt(0)
v_accvgpr_read_b32 v10, a32
v_xor_b32 v10, s99, v10
v_accvgpr_read_b32 v11, a36
v_xor_b32 v11, s99, v11
v_or_b32 v10, v10, v11
v_accvgpr_read_b32 v11, a40
v_xor_b32 v11, s99, v11
v_or_b32 v10, v10, v11
v_accvgpr_read_b32 v11, a44
v_xor_b32 v11, s99, v11
v_or_b32 v10, v10, v11
v_accvgpr_read_b32 v11, a48
v_xor_b32 v11, s99, v11
v_or_b32 v10, v10, v11
v_accvgpr_read_b32 v11, a52
v_xor_b32 v11, s99, v11
v_or_b32 v10, v10, v11
v_accvgpr_read_b32 v11, a56
v_xor_b32 v11, s99, v11
v_or_b32 v10, v10, v11
v_accvgpr_read_b32 v11, a60
v_xor_b32 v11, s99, v11
v_or_b32 v10, v10, v11
v_and_b32 v10, 1, v10
v_cmp_ne_u32 vcc, 0, v10
s_nop 4
s_cbranch_vccnz L_f_vok_l
s_branch L_f_s3
L_f_vok:
s_add_u32 m0, s3, 57344
s_nop 0
buffer_load_dwordx4 v228, s[12:15], s52 offen offset:0  lds
buffer_load_dwordx4 v229, s[12:15], s52 offen offset:1024  lds
buffer_load_dwordx4 v230, s[12:15], s52 offen offset:2048  lds
buffer_load_dwordx4 v231, s[12:15], s52 offen offset:3072  lds
s_add_u32 m0, s3, 61440
s_nop 0
buffer_load_dwordx4 v232, s[12:15], s52 offen offset:0  lds
buffer_load_dwordx4 v233, s[12:15], s52 offen offset:1024  lds
buffer_load_dwordx4 v234, s[12:15], s52 offen offset:2048  lds
s_add_u32 s52, s52, 458752
v_pk_mul_f32 v[8:9], v[184:185], v[152:153]
v_pk_mul_f32 v[10:11], v[200:201], v[152:153]
v_pk_fma_f32 v[8:9], v[200:201], v[168:169], v[8:9] neg_lo:[0,1,0] neg_hi:[0,1,0]
v_pk_fma_f32 v[10:11], v[184:185], v[168:169], v[10:11]
v_cvt_pk_bf16_f32 v48, v8, v9
v_cvt_pk_bf16_f32 v56, v10, v11
v_pk_mul_f32 v[12:13], v[186:187], v[154:155]
v_pk_mul_f32 v[14:15], v[202:203], v[154:155]
v_pk_fma_f32 v[12:13], v[202:203], v[170:171], v[12:13] neg_lo:[0,1,0] neg_hi:[0,1,0]
v_pk_fma_f32 v[14:15], v[186:187], v[170:171], v[14:15]
v_cvt_pk_bf16_f32 v49, v12, v13
v_cvt_pk_bf16_f32 v57, v14, v15
v_pk_mul_f32 v[8:9], v[188:189], v[156:157]
v_pk_mul_f32 v[10:11], v[204:205], v[156:157]
v_pk_fma_f32 v[8:9], v[204:205], v[172:173], v[8:9] neg_lo:[0,1,0] neg_hi:[0,1,0]
v_pk_fma_f32 v[10:11], v[188:189], v[172:173], v[10:11]
v_cvt_pk_bf16_f32 v50, v8, v9
v_cvt_pk_bf16_f32 v58, v10, v11
v_pk_mul_f32 v[12:13], v[190:191], v[158:159]
v_pk_mul_f32 v[14:15], v[206:207], v[158:159]
v_pk_fma_f32 v[12:13], v[206:207], v[174:175], v[12:13] neg_lo:[0,1,0] neg_hi:[0,1,0]
v_pk_fma_f32 v[14:15], v[190:191], v[174:175], v[14:15]
v_cvt_pk_bf16_f32 v51, v12, v13
v_cvt_pk_bf16_f32 v59, v14, v15
v_mul_f32 v8, v192, v160
v_mul_f32 v10, v208, v160
v_mfma_f32_32x32x16_bf16 v[16:31], v[48:51], v[128:131], v[16:31]
v_mul_f32 v9, v193, v161
v_mul_f32 v11, v209, v161
v_fma_f32 v8, -v208, v176, v8
v_fmac_f32 v10, v192, v176
v_fma_f32 v9, -v209, v177, v9
v_fmac_f32 v11, v193, v177
v_cvt_pk_bf16_f32 v52, v8, v9
v_cvt_pk_bf16_f32 v60, v10, v11
v_mul_f32 v12, v194, v162
v_mul_f32 v14, v210, v162
v_mfma_f32_32x32x16_bf16 v[32:47], v[56:59], v[128:131], v[32:47]
v_mul_f32 v13, v195, v163
v_mul_f32 v15, v211, v163
v_fma_f32 v12, -v210, v178, v12
v_fmac_f32 v14, v194, v178
v_fma_f32 v13, -v211, v179, v13
v_fmac_f32 v15, v195, v179
v_cvt_pk_bf16_f32 v53, v12, v13
v_cvt_pk_bf16_f32 v61, v14, v15
v_mul_f32 v8, v196, v164
v_mul_f32 v10, v212, v164
v_mfma_f32_32x32x16_bf16 v[16:31], v[56:59], v[144:147], v[16:31]
v_mul_f32 v9, v197, v165
v_mul_f32 v11, v213, v165
v_fma_f32 v8, -v212, v180, v8
v_fmac_f32 v10, v196, v180
v_fma_f32 v9, -v213, v181, v9
v_fmac_f32 v11, v197, v181
v_cvt_pk_bf16_f32 v54, v8, v9
v_cvt_pk_bf16_f32 v62, v10, v11
v_mul_f32 v12, v198, v166
v_mul_f32 v14, v214, v166
v_mfma_f32_32x32x16_bf16 v[32:47], v[48:51], v[136:139], v[32:47]
v_mul_f32 v13, v199, v167
v_mul_f32 v15, v215, v167
v_fma_f32 v12, -v214, v182, v12
v_fmac_f32 v14, v198, v182
v_fma_f32 v13, -v215, v183, v13
v_fmac_f32 v15, v199, v183
v_cvt_pk_bf16_f32 v55, v12, v13
v_cvt_pk_bf16_f32 v63, v14, v15
s_nop 0
v_mfma_f32_32x32x16_bf16 v[16:31], v[52:55], v[132:135], v[16:31]
v_mfma_f32_32x32x16_bf16 v[32:47], v[60:63], v[132:135], v[32:47]
v_mfma_f32_32x32x16_bf16 v[16:31], v[60:63], v[148:151], v[16:31]
v_mfma_f32_32x32x16_bf16 v[32:47], v[52:55], v[140:143], v[32:47]
s_nop 10
v_cvt_pk_bf16_f32 v64, v16, v17
v_cvt_pk_bf16_f32 v65, v18, v19
v_cvt_pk_bf16_f32 v66, v24, v25
v_cvt_pk_bf16_f32 v67, v26, v27
ds_write_b128 v216, v[64:67] offset:16896
v_cvt_pk_bf16_f32 v68, v20, v21
v_cvt_pk_bf16_f32 v69, v22, v23
v_cvt_pk_bf16_f32 v70, v28, v29
v_cvt_pk_bf16_f32 v71, v30, v31
ds_write_b128 v216, v[68:71] offset:17024
v_cvt_pk_bf16_f32 v72, v32, v33
v_cvt_pk_bf16_f32 v73, v34, v35
v_cvt_pk_bf16_f32 v74, v40, v41
v_cvt_pk_bf16_f32 v75, v42, v43
ds_write_b128 v216, v[72:75] offset:16928
v_cvt_pk_bf16_f32 v76, v36, v37
v_cvt_pk_bf16_f32 v77, v38, v39
v_cvt_pk_bf16_f32 v78, v44, v45
v_cvt_pk_bf16_f32 v79, v46, v47
ds_write_b128 v216, v[76:79] offset:17056
v_pk_mul_f32 v[8:9], v[16:17], v[16:17]
v_pk_mul_f32 v[10:11], v[32:33], v[32:33]
v_pk_fma_f32 v[8:9], v[18:19], v[18:19], v[8:9]
v_pk_fma_f32 v[10:11], v[34:35], v[34:35], v[10:11]
v_pk_fma_f32 v[8:9], v[20:21], v[20:21], v[8:9]
v_pk_fma_f32 v[10:11], v[36:37], v[36:37], v[10:11]
v_pk_fma_f32 v[8:9], v[22:23], v[22:23], v[8:9]
v_pk_fma_f32 v[10:11], v[38:39], v[38:39], v[10:11]
s_waitcnt lgkmcnt(0)
s_barrier
ds_read_b128 v[184:187], v217 offset:16896
ds_read_b128 v[188:191], v217 offset:21120
ds_read_b128 v[192:195], v217 offset:25344
ds_read_b128 v[196:199], v217 offset:29568
v_pk_fma_f32 v[8:9], v[24:25], v[24:25], v[8:9]
v_pk_fma_f32 v[10:11], v[40:41], v[40:41], v[10:11]
v_pk_fma_f32 v[8:9], v[26:27], v[26:27], v[8:9]
v_pk_fma_f32 v[10:11], v[42:43], v[42:43], v[10:11]
v_pk_fma_f32 v[8:9], v[28:29], v[28:29], v[8:9]
v_pk_fma_f32 v[10:11], v[44:45], v[44:45], v[10:11]
v_pk_fma_f32 v[8:9], v[30:31], v[30:31], v[8:9]
v_pk_fma_f32 v[10:11], v[46:47], v[46:47], v[10:11]
s_waitcnt lgkmcnt(3)
v_bfi_b32 v184, 1, s99, v184
buffer_store_dwordx4 v[184:187], v218, s[8:11], s36 offen sc1
s_waitcnt lgkmcnt(2)
buffer_store_dwordx4 v[188:191], v218, s[8:11], s37 offen sc1
s_waitcnt lgkmcnt(1)
buffer_store_dwordx4 v[192:195], v218, s[8:11], s38 offen sc1
s_waitcnt lgkmcnt(0)
buffer_store_dwordx4 v[196:199], v218, s[8:11], s39 offen sc1
v_add_f32 v8, v8, v9
v_add_f32 v9, v10, v11
v_add_f32 v16, s40, v16
v_add_f32 v17, s40, v17
v_add_f32 v18, s40, v18
v_add_f32 v19, s40, v19
v_add_f32 v20, s40, v20
v_add_f32 v21, s40, v21
v_add_f32 v22, s40, v22
v_add_f32 v23, s40, v23
v_add_f32 v24, s40, v24
v_add_f32 v25, s40, v25
v_add_f32 v26, s40, v26
v_add_f32 v27, s40, v27
v_add_f32 v28, s40, v28
v_add_f32 v29, s40, v29
v_add_f32 v30, s40, v30
v_add_f32 v31, s40, v31
v_add_f32 v32, s41, v32
v_add_f32 v33, s41, v33
v_add_f32 v34, s41, v34
v_add_f32 v35, s41, v35
v_add_f32 v36, s41, v36
v_add_f32 v37, s41, v37
v_add_f32 v38, s41, v38
v_add_f32 v39, s41, v39
v_add_f32 v40, s41, v40
v_add_f32 v41, s41, v41
v_add_f32 v42, s41, v42
v_add_f32 v43, s41, v43
v_add_f32 v44, s41, v44
v_add_f32 v45, s41, v45
v_add_f32 v46, s41, v46
v_add_f32 v47, s41, v47
v_permlane32_swap_b32 v8, v9
v_add_f32 v8, v8, v9
v_mov_b32 v9, v8
s_nop 1
v_permlane16_swap_b32 v8, v9
v_add_f32 v8, v8, v9
s_nop 1
v_add_f32_dpp v8, v8, v8 row_ror:8 row_mask:0xf bank_mask:0xf
s_nop 1
v_add_f32_dpp v8, v8, v8 row_ror:4 row_mask:0xf bank_mask:0xf
s_nop 1
v_add_f32_dpp v8, v8, v8 row_ror:2 row_mask:0xf bank_mask:0xf
s_nop 1
v_add_f32_dpp v8, v8, v8 row_ror:1 row_mask:0xf bank_mask:0xf
v_mov_b32 v10, 0x3727c5ac
v_fmac_f32 v10, 0x3a800000, v8
v_rcp_f32 v10, v10
v_cvt_pk_bf16_f32 v48, v16, v17
v_cvt_pk_bf16_f32 v49, v18, v19
v_cvt_pk_bf16_f32 v50, v20, v21
v_cvt_pk_bf16_f32 v51, v22, v23
v_cvt_pk_bf16_f32 v52, v24, v25
v_cvt_pk_bf16_f32 v53, v26, v27
v_cvt_pk_bf16_f32 v54, v28, v29
v_cvt_pk_bf16_f32 v55, v30, v31
ds_write_b128 v216, v[48:51] offset:0
ds_write_b128 v216, v[52:55] offset:128
v_cvt_pk_bf16_f32 v56, v32, v33
v_cvt_pk_bf16_f32 v57, v34, v35
v_cvt_pk_bf16_f32 v58, v36, v37
v_cvt_pk_bf16_f32 v59, v38, v39
v_cvt_pk_bf16_f32 v60, v40, v41
v_cvt_pk_bf16_f32 v61, v42, v43
v_cvt_pk_bf16_f32 v62, v44, v45
v_cvt_pk_bf16_f32 v63, v46, v47
ds_write_b128 v216, v[56:59] offset:32
ds_write_b128 v216, v[60:63] offset:160
s_mul_i32 s31, s32, 528
s_lshl_b32 s30, s33, 2
s_add_u32 s31, s31, s30
s_add_u32 s31, s31, 130560
v_lshl_add_u32 v11, v2, 3, s31
ds_write_b32 v11, v10
v_bfe_u32 v12, v1, 2, 1
v_mul_u32_u24 v12, 528, v12
v_and_b32 v13, 3, v1
v_lshl_add_u32 v12, v13, 2, v12
v_add_u32 v12, 130560, v12
v_lshlrev_b32 v1, 4, v223
s_lshl_b32 s97, s29, 17
v_add_u32 v224, s97, v1
v_add_u32 v225, 32768, v224
v_add_u32 v226, 65536, v224
v_add_u32 v227, 98304, v224
s_lshl_b32 s28, s94, 19
s_lshl_b32 s49, s95, 2
s_add_u32 s49, s49, s29
s_mul_i32 s49, s49, 1024
v_and_b32 v250, 31, v223
v_lshlrev_b32 v250, 2, v250
v_mov_b32 v254, s99
v_add_u32 v254, 1, v254
v_lshrrev_b32 v2, 5, v223
v_lshlrev_b32 v2, 4, v2
v_bfe_u32 v3, v223, 2, 3
v_add_u32 v2, v2, v3
v_mul_u32_u24 v2, 224, v2
v_and_b32 v4, 3, v223
v_lshl_add_u32 v235, v4, 3, v2
v_add_u32 v236, 57344, v235
v_mul_u32_u24 v2, 1056, v3
v_lshrrev_b32 v3, 5, v223
v_lshl_add_u32 v2, v3, 9, v2
v_lshl_add_u32 v2, v4, 3, v2
v_add_u32 v245, 113152, v2
v_add_u32 v246, 62464, v2
v_add_u32 v247, 11776, v2
s_add_u32 s16, s6, 20971520
s_addc_u32 s17, s7, 0
s_and_b32 s17, s17, 0xffff
s_mov_b32 s18, 14680064
s_mov_b32 s19, 0x20000
s_add_u32 s24, s6, 36700160
s_addc_u32 s25, s7, 0
s_and_b32 s25, s25, 0xffff
s_mov_b32 s26, 16908288
s_mov_b32 s27, 0x20000
s_lshr_b32 s97, s48, 3
s_and_b32 s98, s48, 7
s_mov_b32 s20, s54
s_and_b32 s21, s55, 0xffff
s_mov_b32 s22, 7340032
s_mov_b32 s23, 0x20000
s_mul_i32 s34, s94, 1835008
s_mul_i32 s53, s97, 28672
s_waitcnt vmcnt(0) lgkmcnt(0)
s_barrier
buffer_store_dword v254, v250, s[44:47], s49 offen offset:896 sc1
s_add_u32 s34, s34, s53
s_mul_i32 s53, s29, 458752
s_add_u32 s34, s34, s53
s_lshl_b32 s53, s98, 9
s_add_u32 s5, s34, s53
s_lshl_b32 s96, s94, 2
s_add_u32 s96, s96, s29
s_lshl_b32 s96, s96, 19
s_add_u32 s96, s96, s53
s_lshl_b32 s53, s97, 12
s_add_u32 s96, s96, s53
s_lshl_b32 s100, s95, 16
s_lshl_b32 s53, s29, 10
s_add_u32 s100, s100, s53
s_lshl_b32 s101, s94, 4
s_add_u32 s101, s101, s29
s_lshl_b32 s101, s101, 3
s_add_u32 s101, s101, s97
s_mul_i32 s101, s101, 1024
v_mov_b32 v237, v1
v_add_u32 v238, 114688, v1
v_add_u32 v239, 229376, v1
v_add_u32 v240, 344064, v1
v_bfe_u32 v2, v223, 4, 1
v_mul_u32_u24 v2, 114688, v2
v_lshl_add_u32 v2, v3, 8, v2
v_and_b32 v4, 15, v223
v_lshl_add_u32 v248, v4, 4, v2
v_add_u32 v249, 229376, v248
v_and_b32 v2, 31, v223
v_lshlrev_b32 v2, 4, v2
v_lshl_add_u32 v2, v3, 12, v2
v_accvgpr_write_b32 a243, v2
s_lshr_b32 s30, s98, 1
s_xor_b32 s53, s30, 0
s_lshl_b32 s53, s53, 10
s_add_u32 s36, s34, s53
s_xor_b32 s53, s30, 1
s_lshl_b32 s53, s53, 10
s_add_u32 s37, s34, s53
s_xor_b32 s53, s30, 2
s_lshl_b32 s53, s53, 10
s_add_u32 s38, s34, s53
s_xor_b32 s53, s30, 3
s_lshl_b32 s53, s53, 10
s_add_u32 s39, s34, s53
s_xor_b32 s31, s98, 1
s_lshl_b32 s53, s31, 9
s_add_u32 s57, s34, s53
s_xor_b32 s53, s97, 3
s_mul_i32 s53, s53, s99
s_lshl_b32 s53, s53, 2
v_xor_b32 v4, s53, v4
v_bfe_u32 v5, v223, 4, 1
s_and_b32 s4, s29, 1
s_lshl_b32 s53, s4, 14
v_lshl_add_u32 v6, v4, 4, s53
v_lshl_add_u32 v6, v5, 13, v6
v_mul_u32_u24 v2, 229376, v3
v_add_u32 v241, v2, v6
v_add_u32 v242, 992, v241
v_add_u32 v243, 1984, v241
v_add_u32 v244, 2976, v241
v_lshl_add_u32 v6, v3, 15, v6
v_accvgpr_write_b32 a242, v6
s_lshl_b32 s53, s4, 13
v_lshl_add_u32 v7, v4, 4, s53
v_lshl_add_u32 v7, v5, 15, v7
v_lshl_add_u32 v7, v3, 14, v7
v_accvgpr_write_b32 a240, v7
s_cmp_lt_u32 s29, 2
s_cselect_b64 vcc, -1, 0
v_cndmask_b32 v7, v6, v7, vcc
v_accvgpr_write_b32 a241, v7
s_mul_i32 s4, s29, 4224
s_mul_i32 s35, s97, 1835008
s_lshl_b32 s53, s98, 8
s_add_u32 s35, s35, s53
s_lshr_b32 s59, s29, 1
s_mul_i32 s53, s59, 3
s_xor_b32 s53, s53, 1
s_xor_b32 s53, s53, s30
s_mul_i32 s53, s53, 458752
s_add_u32 s40, s35, s53
s_mul_i32 s53, s59, 2
s_xor_b32 s53, s53, 3
s_xor_b32 s53, s53, s30
s_mul_i32 s53, s53, 458752
s_add_u32 s41, s35, s53
s_lshl_b32 s53, s59, 15
s_add_u32 s41, s41, s53
s_mul_i32 s53, s59, 1
s_xor_b32 s53, s53, 2
s_xor_b32 s53, s53, s30
s_mul_i32 s53, s53, 458752
s_add_u32 s42, s35, s53
s_mul_i32 s53, s59, 3
s_xor_b32 s53, s53, 3
s_xor_b32 s53, s53, s30
s_mul_i32 s53, s53, 458752
s_add_u32 s43, s35, s53
s_mul_i32 s53, s98, 229376
buffer_load_dwordx4 a[0:3], v224, s[8:11], s28 offen offset:0 sc1
buffer_load_dwordx4 a[8:11], v225, s[8:11], s28 offen offset:0 sc1
buffer_load_dwordx4 a[16:19], v226, s[8:11], s28 offen offset:0 sc1
buffer_load_dwordx4 a[24:27], v227, s[8:11], s28 offen offset:0 sc1
buffer_load_dwordx4 a[4:7], v224, s[8:11], s28 offen offset:1024 sc1
buffer_load_dwordx4 a[12:15], v225, s[8:11], s28 offen offset:1024 sc1
buffer_load_dwordx4 a[20:23], v226, s[8:11], s28 offen offset:1024 sc1
buffer_load_dwordx4 a[28:31], v227, s[8:11], s28 offen offset:1024 sc1
s_add_u32 s28, s28, 2048
ds_read2_b64 a[224:227], v219 offset0:0 offset1:32
ds_read2_b64 a[228:231], v219 offset0:66 offset1:98
ds_read2_b64 a[232:235], v219 offset0:132 offset1:164
ds_read2_b64 a[236:239], v219 offset0:198 offset1:230
ds_read_b32 a244, v12
s_add_u32 s54, s35, s53
s_mul_i32 s53, s31, 229376
s_add_u32 s56, s35, s53
s_add_u32 s53, s54, 131072
s_cmp_lt_u32 s29, 2
s_cselect_b32 s55, s53, s56
s_lshl_b32 s53, s59, 16
s_add_u32 s54, s54, s53
s_add_u32 s56, s56, s53
s_add_u32 s56, s56, 65536
s_mul_i32 s53, s98, 4096
s_sub_u32 s50, s49, s53
v_lshrrev_b32 v2, 3, v223
v_mul_u32_u24 v251, 4096, v2
s_cmp_eq_u32 s99, 0
s_cselect_b32 s30, 0x40000000, 0
s_add_u32 s61, s100, s30
s_lshl_b32 s62, s95, 2
s_add_u32 s62, s62, s29
s_lshl_b32 s62, s62, 7
s_add_u32 s62, s62, 16777216
s_add_u32 s62, s62, s30
s_lshl_b32 s60, s94, 2
s_add_u32 s60, s60, s29
s_lshl_b32 s60, s60, 5
s_lshr_b32 s53, s98, 1
s_add_u32 s60, s60, s53
s_mul_i32 s60, s60, 1024
s_mul_i32 s53, s97, 32768
s_sub_u32 s59, s49, s53
s_add_u32 s59, s59, s30
v_lshrrev_b32 v2, 2, v223
v_lshlrev_b32 v253, 7, v2
s_lshl_b32 s98, s2, 2
s_add_u32 s98, s98, s29
s_lshl_b32 s98, s98, 11
s_and_b32 s53, s29, 1
s_lshl_b32 s33, s2, 1
s_add_u32 s33, s33, s53
s_lshl_b32 s33, s33, 11
s_cmp_eq_u32 s58, 0
s_cselect_b32 s98, 0x40000000, s98
s_cselect_b32 s33, 0x40000000, s33
s_bfe_u32 s31, s2, 0x10003
s_lshl_b32 s53, s94, 2
s_add_u32 s53, s53, s29
s_mul_i32 s53, s53, 32768
s_lshr_b32 s30, s48, 3
s_mul_i32 s30, s30, 1024
s_add_u32 s53, s53, s30
v_mov_b32 v2, v251
s_mov_b32 s32, s53
ds_read_b64_tr_b16 a[128:129], v236 offset:28672
ds_read_b64_tr_b16 a[130:131], v236 offset:30464
ds_read_b64_tr_b16 a[132:133], v236 offset:35840
ds_read_b64_tr_b16 a[134:135], v236 offset:37632
ds_read_b64_tr_b16 a[136:137], v236 offset:43008
ds_read_b64_tr_b16 a[138:139], v236 offset:44800
ds_read_b64_tr_b16 a[140:141], v236 offset:50176
ds_read_b64_tr_b16 a[142:143], v236 offset:51968
s_waitcnt vmcnt(7)
v_accvgpr_read_b32 v1, a0
v_xor_b32 v1, s99, v1
s_waitcnt vmcnt(6)
v_accvgpr_read_b32 v2, a8
v_xor_b32 v2, s99, v2
v_or_b32 v1, v1, v2
s_waitcnt vmcnt(5)
v_accvgpr_read_b32 v2, a16
v_xor_b32 v2, s99, v2
v_or_b32 v1, v1, v2
s_waitcnt vmcnt(4)
v_accvgpr_read_b32 v2, a24
v_xor_b32 v2, s99, v2
v_or_b32 v1, v1, v2
s_waitcnt vmcnt(3)
v_accvgpr_read_b32 v2, a4
v_xor_b32 v2, s99, v2
v_or_b32 v1, v1, v2
s_waitcnt vmcnt(2)
v_accvgpr_read_b32 v2, a12
v_xor_b32 v2, s99, v2
v_or_b32 v1, v1, v2
s_waitcnt vmcnt(1)
v_accvgpr_read_b32 v2, a20
v_xor_b32 v2, s99, v2
v_or_b32 v1, v1, v2
s_waitcnt vmcnt(0)
v_accvgpr_read_b32 v2, a28
v_xor_b32 v2, s99, v2
v_or_b32 v1, v1, v2
v_and_b32 v1, 1, v1
v_cmp_ne_u32 vcc, 0, v1
s_nop 4
s_cbranch_vccnz L_f_a0c
L_f_a0ok:
s_waitcnt vmcnt(0) lgkmcnt(4)
v_mfma_f32_16x16x32_bf16 v[0:3], a[128:131], a[0:3], 0
ds_read_b64_tr_b16 a[144:145], v236 offset:28704
v_mfma_f32_16x16x32_bf16 v[0:3], a[132:135], a[4:7], v[0:3]
buffer_load_dwordx4 a[32:35], v224, s[8:11], s28 offen offset:0 sc1
v_mfma_f32_16x16x32_bf16 v[4:7], a[132:135], a[12:15], 0
ds_read_b64_tr_b16 a[146:147], v236 offset:30496
v_mfma_f32_16x16x32_bf16 v[4:7], a[128:131], a[8:11], v[4:7]
v_mfma_f32_16x16x32_bf16 v[8:11], a[128:131], a[16:19], 0
ds_read_b64_tr_b16 a[148:149], v236 offset:35872
v_mfma_f32_16x16x32_bf16 v[8:11], a[132:135], a[20:23], v[8:11]
buffer_load_dwordx4 a[40:43], v225, s[8:11], s28 offen offset:0 sc1
v_mfma_f32_16x16x32_bf16 v[12:15], a[132:135], a[28:31], 0
ds_read_b64_tr_b16 a[150:151], v236 offset:37664
v_mfma_f32_16x16x32_bf16 v[12:15], a[128:131], a[24:27], v[12:15]
s_waitcnt lgkmcnt(4)
v_mfma_f32_16x16x32_bf16 v[28:31], a[136:139], a[24:27], 0
ds_read_b64_tr_b16 a[152:153], v236 offset:43040
v_mfma_f32_16x16x32_bf16 v[28:31], a[140:143], a[28:31], v[28:31]
v_mfma_f32_16x16x32_bf16 v[24:27], a[140:143], a[20:23], 0
ds_read_b64_tr_b16 a[154:155], v236 offset:44832
v_mfma_f32_16x16x32_bf16 v[24:27], a[136:139], a[16:19], v[24:27]
buffer_load_dwordx4 a[48:51], v226, s[8:11], s28 offen offset:0 sc1
v_mfma_f32_16x16x32_bf16 v[20:23], a[136:139], a[8:11], 0
ds_read_b64_tr_b16 a[156:157], v236 offset:50208
v_mfma_f32_16x16x32_bf16 v[20:23], a[140:143], a[12:15], v[20:23]
v_mfma_f32_16x16x32_bf16 v[16:19], a[140:143], a[4:7], 0
ds_read_b64_tr_b16 a[158:159], v236 offset:52000
v_mfma_f32_16x16x32_bf16 v[16:19], a[136:139], a[0:3], v[16:19]
s_waitcnt lgkmcnt(4)
v_mfma_f32_16x16x32_bf16 v[32:35], a[144:147], a[0:3], 0
ds_read_b64_tr_b16 a[128:129], v236 offset:28736
v_mfma_f32_16x16x32_bf16 v[32:35], a[148:151], a[4:7], v[32:35]
buffer_load_dwordx4 a[56:59], v227, s[8:11], s28 offen offset:0 sc1
v_mfma_f32_16x16x32_bf16 v[36:39], a[148:151], a[12:15], 0
ds_read_b64_tr_b16 a[130:131], v236 offset:30528
v_mfma_f32_16x16x32_bf16 v[36:39], a[144:147], a[8:11], v[36:39]
v_mfma_f32_16x16x32_bf16 v[40:43], a[144:147], a[16:19], 0
ds_read_b64_tr_b16 a[132:133], v236 offset:35904
v_mfma_f32_16x16x32_bf16 v[40:43], a[148:151], a[20:23], v[40:43]
buffer_load_dwordx4 a[36:39], v224, s[8:11], s28 offen offset:1024 sc1
v_mfma_f32_16x16x32_bf16 v[44:47], a[148:151], a[28:31], 0
ds_read_b64_tr_b16 a[134:135], v236 offset:37696
v_mfma_f32_16x16x32_bf16 v[44:47], a[144:147], a[24:27], v[44:47]
s_waitcnt lgkmcnt(4)
v_mfma_f32_16x16x32_bf16 v[60:63], a[152:155], a[24:27], 0
ds_read_b64_tr_b16 a[136:137], v236 offset:43072
v_mfma_f32_16x16x32_bf16 v[60:63], a[156:159], a[28:31], v[60:63]
buffer_load_dwordx4 a[44:47], v225, s[8:11], s28 offen offset:1024 sc1
v_mfma_f32_16x16x32_bf16 v[56:59], a[156:159], a[20:23], 0
ds_read_b64_tr_b16 a[138:139], v236 offset:44864
v_mfma_f32_16x16x32_bf16 v[56:59], a[152:155], a[16:19], v[56:59]
v_mfma_f32_16x16x32_bf16 v[52:55], a[152:155], a[8:11], 0
ds_read_b64_tr_b16 a[140:141], v236 offset:50240
v_mfma_f32_16x16x32_bf16 v[52:55], a[156:159], a[12:15], v[52:55]
v_mfma_f32_16x16x32_bf16 v[48:51], a[156:159], a[4:7], 0
ds_read_b64_tr_b16 a[142:143], v236 offset:52032
v_mfma_f32_16x16x32_bf16 v[48:51], a[152:155], a[0:3], v[48:51]
s_waitcnt lgkmcnt(4)
v_mfma_f32_16x16x32_bf16 v[64:67], a[128:131], a[0:3], 0
ds_read_b64_tr_b16 a[144:145], v236 offset:28768
v_mfma_f32_16x16x32_bf16 v[64:67], a[132:135], a[4:7], v[64:67]
buffer_load_dwordx4 a[52:55], v226, s[8:11], s28 offen offset:1024 sc1
v_mfma_f32_16x16x32_bf16 v[68:71], a[132:135], a[12:15], 0
ds_read_b64_tr_b16 a[146:147], v236 offset:30560
buffer_load_dword v252, v251, s[44:47], s32 offen offset:896 sc1
v_mfma_f32_16x16x32_bf16 v[68:71], a[128:131], a[8:11], v[68:71]
buffer_load_dwordx4 a[60:63], v227, s[8:11], s28 offen offset:1024 sc1
v_mfma_f32_16x16x32_bf16 v[72:75], a[128:131], a[16:19], 0
ds_read_b64_tr_b16 a[148:149], v236 offset:35936
s_add_u32 s28, s28, 2048
v_mfma_f32_16x16x32_bf16 v[72:75], a[132:135], a[20:23], v[72:75]
v_mfma_f32_16x16x32_bf16 v[76:79], a[132:135], a[28:31], 0
ds_read_b64_tr_b16 a[150:151], v236 offset:37728
s_add_u32 m0, s3, 0
v_mfma_f32_16x16x32_bf16 v[76:79], a[128:131], a[24:27], v[76:79]
s_waitcnt lgkmcnt(4)
v_mfma_f32_16x16x32_bf16 v[92:95], a[136:139], a[24:27], 0
ds_read_b64_tr_b16 a[152:153], v236 offset:43104
v_mfma_f32_16x16x32_bf16 v[92:95], a[140:143], a[28:31], v[92:95]
buffer_load_dwordx4 v228, s[12:15], s52 offen offset:0  lds
v_mfma_f32_16x16x32_bf16 v[88:91], a[140:143], a[20:23], 0
ds_read_b64_tr_b16 a[154:155], v236 offset:44896
v_mfma_f32_16x16x32_bf16 v[88:91], a[136:139], a[16:19], v[88:91]
v_mfma_f32_16x16x32_bf16 v[84:87], a[136:139], a[8:11], 0
ds_read_b64_tr_b16 a[156:157], v236 offset:50272
v_mfma_f32_16x16x32_bf16 v[84:87], a[140:143], a[12:15], v[84:87]
buffer_load_dwordx4 v229, s[12:15], s52 offen offset:1024  lds
v_mfma_f32_16x16x32_bf16 v[80:83], a[140:143], a[4:7], 0
ds_read_b64_tr_b16 a[158:159], v236 offset:52064
v_mfma_f32_16x16x32_bf16 v[80:83], a[136:139], a[0:3], v[80:83]
s_waitcnt lgkmcnt(4)
v_mfma_f32_16x16x32_bf16 v[96:99], a[144:147], a[0:3], 0
ds_read_b64_tr_b16 a[128:129], v236 offset:28800
v_mfma_f32_16x16x32_bf16 v[96:99], a[148:151], a[4:7], v[96:99]
v_mfma_f32_16x16x32_bf16 v[100:103], a[148:151], a[12:15], 0
ds_read_b64_tr_b16 a[130:131], v236 offset:30592
v_mfma_f32_16x16x32_bf16 v[100:103], a[144:147], a[8:11], v[100:103]
buffer_load_dwordx4 v230, s[12:15], s52 offen offset:2048  lds
v_mfma_f32_16x16x32_bf16 v[104:107], a[144:147], a[16:19], 0
ds_read_b64_tr_b16 a[132:133], v236 offset:35968
v_mfma_f32_16x16x32_bf16 v[104:107], a[148:151], a[20:23], v[104:107]
v_mfma_f32_16x16x32_bf16 v[108:111], a[148:151], a[28:31], 0
ds_read_b64_tr_b16 a[134:135], v236 offset:37760
v_mfma_f32_16x16x32_bf16 v[108:111], a[144:147], a[24:27], v[108:111]
s_waitcnt lgkmcnt(4)
v_mfma_f32_16x16x32_bf16 v[124:127], a[152:155], a[24:27], 0
ds_read_b64_tr_b16 a[136:137], v236 offset:43136
v_mfma_f32_16x16x32_bf16 v[124:127], a[156:159], a[28:31], v[124:127]
buffer_load_dwordx4 v231, s[12:15], s52 offen offset:3072  lds
v_mfma_f32_16x16x32_bf16 v[120:123], a[156:159], a[20:23], 0
ds_read_b64_tr_b16 a[138:139], v236 offset:44928
s_add_u32 m0, s3, 4096
v_mfma_f32_16x16x32_bf16 v[120:123], a[152:155], a[16:19], v[120:123]
v_mfma_f32_16x16x32_bf16 v[116:119], a[152:155], a[8:11], 0
ds_read_b64_tr_b16 a[140:141], v236 offset:50304
v_mfma_f32_16x16x32_bf16 v[116:119], a[156:159], a[12:15], v[116:119]
v_mfma_f32_16x16x32_bf16 v[112:115], a[156:159], a[4:7], 0
ds_read_b64_tr_b16 a[142:143], v236 offset:52096
v_mfma_f32_16x16x32_bf16 v[112:115], a[152:155], a[0:3], v[112:115]
s_waitcnt lgkmcnt(4)
v_mfma_f32_16x16x32_bf16 v[128:131], a[128:131], a[0:3], 0
ds_read_b64_tr_b16 a[144:145], v236 offset:28832
v_mfma_f32_16x16x32_bf16 v[128:131], a[132:135], a[4:7], v[128:131]
buffer_load_dwordx4 v232, s[12:15], s52 offen offset:0  lds
v_mfma_f32_16x16x32_bf16 v[132:135], a[132:135], a[12:15], 0
ds_read_b64_tr_b16 a[146:147], v236 offset:30624
v_mfma_f32_16x16x32_bf16 v[132:135], a[128:131], a[8:11], v[132:135]
v_mfma_f32_16x16x32_bf16 v[136:139], a[128:131], a[16:19], 0
ds_read_b64_tr_b16 a[148:149], v236 offset:36000
v_mfma_f32_16x16x32_bf16 v[136:139], a[132:135], a[20:23], v[136:139]
v_mfma_f32_16x16x32_bf16 v[140:143], a[132:135], a[28:31], 0
ds_read_b64_tr_b16 a[150:151], v236 offset:37792
v_mfma_f32_16x16x32_bf16 v[140:143], a[128:131], a[24:27], v[140:143]
s_waitcnt lgkmcnt(4)
v_mfma_f32_16x16x32_bf16 v[156:159], a[136:139], a[24:27], 0
ds_read_b64_tr_b16 a[152:153], v236 offset:43168
v_mfma_f32_16x16x32_bf16 v[156:159], a[140:143], a[28:31], v[156:159]
buffer_load_dwordx4 v233, s[12:15], s52 offen offset:1024  lds
v_mfma_f32_16x16x32_bf16 v[152:155], a[140:143], a[20:23], 0
ds_read_b64_tr_b16 a[154:155], v236 offset:44960
v_mfma_f32_16x16x32_bf16 v[152:155], a[136:139], a[16:19], v[152:155]
v_mfma_f32_16x16x32_bf16 v[148:151], a[136:139], a[8:11], 0
ds_read_b64_tr_b16 a[156:157], v236 offset:50336
v_mfma_f32_16x16x32_bf16 v[148:151], a[140:143], a[12:15], v[148:151]
s_waitcnt vmcnt(7)
v_cmp_ne_u32 vcc, v254, v252
v_mfma_f32_16x16x32_bf16 v[144:147], a[140:143], a[4:7], 0
ds_read_b64_tr_b16 a[158:159], v236 offset:52128
buffer_load_dwordx4 v234, s[12:15], s52 offen offset:2048  lds
v_mfma_f32_16x16x32_bf16 v[144:147], a[136:139], a[0:3], v[144:147]
s_cbranch_vccnz L_f_slowx
L_f_contx:
s_waitcnt lgkmcnt(4)
v_mfma_f32_16x16x32_bf16 v[160:163], a[144:147], a[0:3], 0
ds_read_b64_tr_b16 a[128:129], v236 offset:28864
s_add_u32 s52, s52, 458752
v_mfma_f32_16x16x32_bf16 v[160:163], a[148:151], a[4:7], v[160:163]
s_waitcnt vmcnt(7)
v_mfma_f32_16x16x32_bf16 v[164:167], a[148:151], a[12:15], 0
ds_read_b64_tr_b16 a[130:131], v236 offset:30656
v_accvgpr_read_b32 v252, a32
v_mfma_f32_16x16x32_bf16 v[164:167], a[144:147], a[8:11], v[164:167]
v_xor_b32 v252, s99, v252
v_mfma_f32_16x16x32_bf16 v[168:171], a[144:147], a[16:19], 0
ds_read_b64_tr_b16 a[132:133], v236 offset:36032
v_accvgpr_read_b32 v255, a40
v_mfma_f32_16x16x32_bf16 v[168:171], a[148:151], a[20:23], v[168:171]
v_xor_b32 v255, s99, v255
buffer_load_dwordx4 a[64:67], v224, s[8:11], s28 offen offset:0 sc1
v_mfma_f32_16x16x32_bf16 v[172:175], a[148:151], a[28:31], 0
ds_read_b64_tr_b16 a[134:135], v236 offset:37824
v_or_b32 v252, v252, v255
v_mfma_f32_16x16x32_bf16 v[172:175], a[144:147], a[24:27], v[172:175]
v_accvgpr_read_b32 v255, a48
s_waitcnt lgkmcnt(4)
v_mfma_f32_16x16x32_bf16 v[188:191], a[152:155], a[24:27], 0
ds_read_b64_tr_b16 a[136:137], v236 offset:43200
v_xor_b32 v255, s99, v255
v_mfma_f32_16x16x32_bf16 v[188:191], a[156:159], a[28:31], v[188:191]
v_or_b32 v252, v252, v255
v_mfma_f32_16x16x32_bf16 v[184:187], a[156:159], a[20:23], 0
ds_read_b64_tr_b16 a[138:139], v236 offset:44992
v_accvgpr_read_b32 v255, a56
v_mfma_f32_16x16x32_bf16 v[184:187], a[152:155], a[16:19], v[184:187]
v_xor_b32 v255, s99, v255
buffer_load_dwordx4 a[72:75], v225, s[8:11], s28 offen offset:0 sc1
v_mfma_f32_16x16x32_bf16 v[180:183], a[152:155], a[8:11], 0
ds_read_b64_tr_b16 a[140:141], v236 offset:50368
v_or_b32 v252, v252, v255
v_mfma_f32_16x16x32_bf16 v[180:183], a[156:159], a[12:15], v[180:183]
s_waitcnt vmcnt(27)
s_barrier
v_mfma_f32_16x16x32_bf16 v[176:179], a[156:159], a[4:7], 0
ds_read_b64_tr_b16 a[142:143], v236 offset:52160
v_accvgpr_read_b32 v255, a36
v_mfma_f32_16x16x32_bf16 v[176:179], a[152:155], a[0:3], v[176:179]
v_xor_b32 v255, s99, v255
s_waitcnt lgkmcnt(4)
v_mfma_f32_16x16x32_bf16 v[192:195], a[128:131], a[0:3], 0
ds_read_b64_tr_b16 a[144:145], v236 offset:0
v_or_b32 v252, v252, v255
v_mfma_f32_16x16x32_bf16 v[192:195], a[132:135], a[4:7], v[192:195]
v_accvgpr_read_b32 v255, a44
buffer_load_dwordx4 a[80:83], v226, s[8:11], s28 offen offset:0 sc1
v_mfma_f32_16x16x32_bf16 v[196:199], a[132:135], a[12:15], 0
ds_read_b64_tr_b16 a[146:147], v236 offset:1792
v_xor_b32 v255, s99, v255
v_mfma_f32_16x16x32_bf16 v[196:199], a[128:131], a[8:11], v[196:199]
v_or_b32 v252, v252, v255
v_mfma_f32_16x16x32_bf16 v[200:203], a[128:131], a[16:19], 0
ds_read_b64_tr_b16 a[148:149], v236 offset:7168
v_accvgpr_read_b32 v255, a52
v_mfma_f32_16x16x32_bf16 v[200:203], a[132:135], a[20:23], v[200:203]
v_xor_b32 v255, s99, v255
v_mfma_f32_16x16x32_bf16 v[204:207], a[132:135], a[28:31], 0
ds_read_b64_tr_b16 a[150:151], v236 offset:8960
v_or_b32 v252, v252, v255
v_mfma_f32_16x16x32_bf16 v[204:207], a[128:131], a[24:27], v[204:207]
v_accvgpr_read_b32 v255, a60
s_waitcnt lgkmcnt(4)
v_mfma_f32_16x16x32_bf16 v[220:223], a[136:139], a[24:27], 0
ds_read_b64_tr_b16 a[152:153], v236 offset:14336
v_xor_b32 v255, s99, v255
v_mfma_f32_16x16x32_bf16 v[220:223], a[140:143], a[28:31], v[220:223]
v_or_b32 v252, v252, v255
buffer_load_dwordx4 a[88:91], v227, s[8:11], s28 offen offset:0 sc1
v_mfma_f32_16x16x32_bf16 v[216:219], a[140:143], a[20:23], 0
ds_read_b64_tr_b16 a[154:155], v236 offset:16128
v_and_b32 v252, 1, v252
v_mfma_f32_16x16x32_bf16 v[216:219], a[136:139], a[16:19], v[216:219]
v_cmp_ne_u32 vcc, 0, v252
v_mfma_f32_16x16x32_bf16 v[212:215], a[136:139], a[8:11], 0
ds_read_b64_tr_b16 a[156:157], v236 offset:21504
v_mfma_f32_16x16x32_bf16 v[212:215], a[140:143], a[12:15], v[212:215]
s_cbranch_vccnz L_f_slowa
L_f_conta:
v_mfma_f32_16x16x32_bf16 v[208:211], a[140:143], a[4:7], 0
ds_read_b64_tr_b16 a[158:159], v236 offset:23296
v_mfma_f32_16x16x32_bf16 v[208:211], a[136:139], a[0:3], v[208:211]
s_add_u32 s53, s33, 2097152
s_waitcnt vmcnt(11) lgkmcnt(4)
v_mfma_f32_16x16x32_bf16 v[0:3], a[144:147], a[32:35], v[0:3]
ds_read_b64_tr_b16 a[128:129], v236 offset:32
s_cmp_eq_u32 s31, 0
s_cselect_b32 s53, s53, 0x40000000
v_mfma_f32_16x16x32_bf16 v[0:3], a[148:151], a[36:39], v[0:3]
buffer_load_dwordx4 a[68:71], v224, s[8:11], s28 offen offset:1024 sc1
v_mfma_f32_16x16x32_bf16 v[4:7], a[148:151], a[44:47], v[4:7]
ds_read_b64_tr_b16 a[130:131], v236 offset:1824
v_mfma_f32_16x16x32_bf16 v[4:7], a[144:147], a[40:43], v[4:7]
v_mfma_f32_16x16x32_bf16 v[8:11], a[144:147], a[48:51], v[8:11]
ds_read_b64_tr_b16 a[132:133], v236 offset:7200
v_mfma_f32_16x16x32_bf16 v[8:11], a[148:151], a[52:55], v[8:11]
buffer_load_dwordx4 a[76:79], v225, s[8:11], s28 offen offset:1024 sc1
v_mfma_f32_16x16x32_bf16 v[12:15], a[148:151], a[60:63], v[12:15]
ds_read_b64_tr_b16 a[134:135], v236 offset:8992
buffer_load_dword v255, v253, s[12:15], s53 offen
v_mfma_f32_16x16x32_bf16 v[12:15], a[144:147], a[56:59], v[12:15]
s_waitcnt lgkmcnt(4)
v_mfma_f32_16x16x32_bf16 v[28:31], a[152:155], a[56:59], v[28:31]
ds_read_b64_tr_b16 a[136:137], v236 offset:14368
v_mfma_f32_16x16x32_bf16 v[28:31], a[156:159], a[60:63], v[28:31]
v_mfma_f32_16x16x32_bf16 v[24:27], a[156:159], a[52:55], v[24:27]
ds_read_b64_tr_b16 a[138:139], v236 offset:16160
v_mfma_f32_16x16x32_bf16 v[24:27], a[152:155], a[48:51], v[24:27]
buffer_load_dwordx4 a[84:87], v226, s[8:11], s28 offen offset:1024 sc1
v_mfma_f32_16x16x32_bf16 v[20:23], a[152:155], a[40:43], v[20:23]
ds_read_b64_tr_b16 a[140:141], v236 offset:21536
v_mfma_f32_16x16x32_bf16 v[20:23], a[156:159], a[44:47], v[20:23]
v_mfma_f32_16x16x32_bf16 v[16:19], a[156:159], a[36:39], v[16:19]
ds_read_b64_tr_b16 a[142:143], v236 offset:23328
v_mfma_f32_16x16x32_bf16 v[16:19], a[152:155], a[32:35], v[16:19]
s_waitcnt lgkmcnt(4)
v_mfma_f32_16x16x32_bf16 v[32:35], a[128:131], a[32:35], v[32:35]
ds_read_b64_tr_b16 a[144:145], v236 offset:64
v_mfma_f32_16x16x32_bf16 v[32:35], a[132:135], a[36:39], v[32:35]
v_mfma_f32_16x16x32_bf16 v[36:39], a[132:135], a[44:47], v[36:39]
ds_read_b64_tr_b16 a[146:147], v236 offset:1856
v_mfma_f32_16x16x32_bf16 v[36:39], a[128:131], a[40:43], v[36:39]
buffer_load_dwordx4 a[92:95], v227, s[8:11], s28 offen offset:1024 sc1
v_mfma_f32_16x16x32_bf16 v[40:43], a[128:131], a[48:51], v[40:43]
ds_read_b64_tr_b16 a[148:149], v236 offset:7232
s_add_u32 s28, s28, 2048
v_mfma_f32_16x16x32_bf16 v[40:43], a[132:135], a[52:55], v[40:43]
v_mfma_f32_16x16x32_bf16 v[44:47], a[132:135], a[60:63], v[44:47]
ds_read_b64_tr_b16 a[150:151], v236 offset:9024
v_mfma_f32_16x16x32_bf16 v[44:47], a[128:131], a[56:59], v[44:47]
s_waitcnt lgkmcnt(4)
v_mfma_f32_16x16x32_bf16 v[60:63], a[136:139], a[56:59], v[60:63]
ds_read_b64_tr_b16 a[152:153], v236 offset:14400
v_mfma_f32_16x16x32_bf16 v[60:63], a[140:143], a[60:63], v[60:63]
s_add_u32 m0, s3, 28672
v_mfma_f32_16x16x32_bf16 v[56:59], a[140:143], a[52:55], v[56:59]
ds_read_b64_tr_b16 a[154:155], v236 offset:16192
v_mfma_f32_16x16x32_bf16 v[56:59], a[136:139], a[48:51], v[56:59]
buffer_load_dwordx4 v228, s[12:15], s52 offen offset:0  lds
v_mfma_f32_16x16x32_bf16 v[52:55], a[136:139], a[40:43], v[52:55]
ds_read_b64_tr_b16 a[156:157], v236 offset:21568
v_mfma_f32_16x16x32_bf16 v[52:55], a[140:143], a[44:47], v[52:55]
v_mfma_f32_16x16x32_bf16 v[48:51], a[140:143], a[36:39], v[48:51]
ds_read_b64_tr_b16 a[158:159], v236 offset:23360
v_mfma_f32_16x16x32_bf16 v[48:51], a[136:139], a[32:35], v[48:51]
s_waitcnt lgkmcnt(4)
v_mfma_f32_16x16x32_bf16 v[64:67], a[144:147], a[32:35], v[64:67]
ds_read_b64_tr_b16 a[128:129], v236 offset:96
v_mfma_f32_16x16x32_bf16 v[64:67], a[148:151], a[36:39], v[64:67]
buffer_load_dwordx4 v229, s[12:15], s52 offen offset:1024  lds
v_mfma_f32_16x16x32_bf16 v[68:71], a[148:151], a[44:47], v[68:71]
ds_read_b64_tr_b16 a[130:131], v236 offset:1888
v_mfma_f32_16x16x32_bf16 v[68:71], a[144:147], a[40:43], v[68:71]
v_mfma_f32_16x16x32_bf16 v[72:75], a[144:147], a[48:51], v[72:75]
ds_read_b64_tr_b16 a[132:133], v236 offset:7264
v_mfma_f32_16x16x32_bf16 v[72:75], a[148:151], a[52:55], v[72:75]
v_mfma_f32_16x16x32_bf16 v[76:79], a[148:151], a[60:63], v[76:79]
ds_read_b64_tr_b16 a[134:135], v236 offset:9056
v_mfma_f32_16x16x32_bf16 v[76:79], a[144:147], a[56:59], v[76:79]
s_waitcnt lgkmcnt(4)
v_mfma_f32_16x16x32_bf16 v[92:95], a[152:155], a[56:59], v[92:95]
ds_read_b64_tr_b16 a[136:137], v236 offset:14432
v_mfma_f32_16x16x32_bf16 v[92:95], a[156:159], a[60:63], v[92:95]
buffer_load_dwordx4 v230, s[12:15], s52 offen offset:2048  lds
v_mfma_f32_16x16x32_bf16 v[88:91], a[156:159], a[52:55], v[88:91]
ds_read_b64_tr_b16 a[138:139], v236 offset:16224
v_mfma_f32_16x16x32_bf16 v[88:91], a[152:155], a[48:51], v[88:91]
v_mfma_f32_16x16x32_bf16 v[84:87], a[152:155], a[40:43], v[84:87]
ds_read_b64_tr_b16 a[140:141], v236 offset:21600
v_mfma_f32_16x16x32_bf16 v[84:87], a[156:159], a[44:47], v[84:87]
buffer_load_dwordx4 v231, s[12:15], s52 offen offset:3072  lds
v_mfma_f32_16x16x32_bf16 v[80:83], a[156:159], a[36:39], v[80:83]
ds_read_b64_tr_b16 a[142:143], v236 offset:23392
s_add_u32 m0, s3, 32768
v_mfma_f32_16x16x32_bf16 v[80:83], a[152:155], a[32:35], v[80:83]
s_waitcnt lgkmcnt(4)
v_mfma_f32_16x16x32_bf16 v[96:99], a[128:131], a[32:35], v[96:99]
ds_read_b64_tr_b16 a[144:145], v236 offset:128
v_mfma_f32_16x16x32_bf16 v[96:99], a[132:135], a[36:39], v[96:99]
v_mfma_f32_16x16x32_bf16 v[100:103], a[132:135], a[44:47], v[100:103]
ds_read_b64_tr_b16 a[146:147], v236 offset:1920
v_mfma_f32_16x16x32_bf16 v[100:103], a[128:131], a[40:43], v[100:103]
buffer_load_dwordx4 v232, s[12:15], s52 offen offset:0  lds
v_mfma_f32_16x16x32_bf16 v[104:107], a[128:131], a[48:51], v[104:107]
ds_read_b64_tr_b16 a[148:149], v236 offset:7296
v_mfma_f32_16x16x32_bf16 v[104:107], a[132:135], a[52:55], v[104:107]
v_mfma_f32_16x16x32_bf16 v[108:111], a[132:135], a[60:63], v[108:111]
ds_read_b64_tr_b16 a[150:151], v236 offset:9088
v_mfma_f32_16x16x32_bf16 v[108:111], a[128:131], a[56:59], v[108:111]
s_waitcnt lgkmcnt(4)
v_mfma_f32_16x16x32_bf16 v[124:127], a[136:139], a[56:59], v[124:127]
ds_read_b64_tr_b16 a[152:153], v236 offset:14464
v_mfma_f32_16x16x32_bf16 v[124:127], a[140:143], a[60:63], v[124:127]
v_mfma_f32_16x16x32_bf16 v[120:123], a[140:143], a[52:55], v[120:123]
ds_read_b64_tr_b16 a[154:155], v236 offset:16256
v_mfma_f32_16x16x32_bf16 v[120:123], a[136:139], a[48:51], v[120:123]
buffer_load_dwordx4 v233, s[12:15], s52 offen offset:1024  lds
v_mfma_f32_16x16x32_bf16 v[116:119], a[136:139], a[40:43], v[116:119]
ds_read_b64_tr_b16 a[156:157], v236 offset:21632
s_add_u32 s53, s33, 2097152
v_mfma_f32_16x16x32_bf16 v[116:119], a[140:143], a[44:47], v[116:119]
s_cmp_eq_u32 s31, 1
s_cselect_b32 s53, s53, 0x40000000
v_mfma_f32_16x16x32_bf16 v[112:115], a[140:143], a[36:39], v[112:115]
ds_read_b64_tr_b16 a[158:159], v236 offset:23424
v_mfma_f32_16x16x32_bf16 v[112:115], a[136:139], a[32:35], v[112:115]
s_waitcnt lgkmcnt(4)
v_mfma_f32_16x16x32_bf16 v[128:131], a[144:147], a[32:35], v[128:131]
ds_read_b64_tr_b16 a[128:129], v236 offset:160
v_mfma_f32_16x16x32_bf16 v[128:131], a[148:151], a[36:39], v[128:131]
buffer_load_dwordx4 v234, s[12:15], s52 offen offset:2048  lds
v_mfma_f32_16x16x32_bf16 v[132:135], a[148:151], a[44:47], v[132:135]
ds_read_b64_tr_b16 a[130:131], v236 offset:1952
s_add_u32 s52, s52, 458752
v_mfma_f32_16x16x32_bf16 v[132:135], a[144:147], a[40:43], v[132:135]
buffer_load_dword v255, v253, s[12:15], s53 offen
v_mfma_f32_16x16x32_bf16 v[136:139], a[144:147], a[48:51], v[136:139]
ds_read_b64_tr_b16 a[132:133], v236 offset:7328
v_mfma_f32_16x16x32_bf16 v[136:139], a[148:151], a[52:55], v[136:139]
v_mfma_f32_16x16x32_bf16 v[140:143], a[148:151], a[60:63], v[140:143]
ds_read_b64_tr_b16 a[134:135], v236 offset:9120
v_mfma_f32_16x16x32_bf16 v[140:143], a[144:147], a[56:59], v[140:143]
s_waitcnt lgkmcnt(4)
v_mfma_f32_16x16x32_bf16 v[156:159], a[152:155], a[56:59], v[156:159]
ds_read_b64_tr_b16 a[136:137], v236 offset:14496
v_mfma_f32_16x16x32_bf16 v[156:159], a[156:159], a[60:63], v[156:159]
buffer_load_dwordx4 a[96:99], v224, s[8:11], s28 offen offset:0 sc1
v_mfma_f32_16x16x32_bf16 v[152:155], a[156:159], a[52:55], v[152:155]
ds_read_b64_tr_b16 a[138:139], v236 offset:16288
v_mfma_f32_16x16x32_bf16 v[152:155], a[152:155], a[48:51], v[152:155]
v_mfma_f32_16x16x32_bf16 v[148:151], a[152:155], a[40:43], v[148:151]
ds_read_b64_tr_b16 a[140:141], v236 offset:21664
v_mfma_f32_16x16x32_bf16 v[148:151], a[156:159], a[44:47], v[148:151]
v_mfma_f32_16x16x32_bf16 v[144:147], a[156:159], a[36:39], v[144:147]
ds_read_b64_tr_b16 a[142:143], v236 offset:23456
v_mfma_f32_16x16x32_bf16 v[144:147], a[152:155], a[32:35], v[144:147]
s_waitcnt lgkmcnt(4)
v_mfma_f32_16x16x32_bf16 v[160:163], a[128:131], a[32:35], v[160:163]
ds_read_b64_tr_b16 a[144:145], v236 offset:192
v_mfma_f32_16x16x32_bf16 v[160:163], a[132:135], a[36:39], v[160:163]
buffer_load_dwordx4 a[104:107], v225, s[8:11], s28 offen offset:0 sc1
v_mfma_f32_16x16x32_bf16 v[164:167], a[132:135], a[44:47], v[164:167]
ds_read_b64_tr_b16 a[146:147], v236 offset:1984
v_mfma_f32_16x16x32_bf16 v[164:167], a[128:131], a[40:43], v[164:167]
v_mfma_f32_16x16x32_bf16 v[168:171], a[128:131], a[48:51], v[168:171]
ds_read_b64_tr_b16 a[148:149], v236 offset:7360
v_mfma_f32_16x16x32_bf16 v[168:171], a[132:135], a[52:55], v[168:171]
buffer_load_dwordx4 a[112:115], v226, s[8:11], s28 offen offset:0 sc1
v_mfma_f32_16x16x32_bf16 v[172:175], a[132:135], a[60:63], v[172:175]
ds_read_b64_tr_b16 a[150:151], v236 offset:9152
v_mfma_f32_16x16x32_bf16 v[172:175], a[128:131], a[56:59], v[172:175]
s_waitcnt lgkmcnt(4)
v_mfma_f32_16x16x32_bf16 v[188:191], a[136:139], a[56:59], v[188:191]
ds_read_b64_tr_b16 a[152:153], v236 offset:14528
v_mfma_f32_16x16x32_bf16 v[188:191], a[140:143], a[60:63], v[188:191]
v_mfma_f32_16x16x32_bf16 v[184:187], a[140:143], a[52:55], v[184:187]
ds_read_b64_tr_b16 a[154:155], v236 offset:16320
v_mfma_f32_16x16x32_bf16 v[184:187], a[136:139], a[48:51], v[184:187]
buffer_load_dwordx4 a[120:123], v227, s[8:11], s28 offen offset:0 sc1
v_mfma_f32_16x16x32_bf16 v[180:183], a[136:139], a[40:43], v[180:183]
ds_read_b64_tr_b16 a[156:157], v236 offset:21696
v_mfma_f32_16x16x32_bf16 v[180:183], a[140:143], a[44:47], v[180:183]
s_waitcnt vmcnt(21)
s_barrier
v_mfma_f32_16x16x32_bf16 v[176:179], a[140:143], a[36:39], v[176:179]
ds_read_b64_tr_b16 a[158:159], v236 offset:23488
v_mfma_f32_16x16x32_bf16 v[176:179], a[136:139], a[32:35], v[176:179]
s_waitcnt lgkmcnt(4)
v_mfma_f32_16x16x32_bf16 v[192:195], a[144:147], a[32:35], v[192:195]
ds_read_b64_tr_b16 a[128:129], v235 offset:0
v_mfma_f32_16x16x32_bf16 v[192:195], a[148:151], a[36:39], v[192:195]
buffer_load_dwordx4 a[100:103], v224, s[8:11], s28 offen offset:1024 sc1
v_mfma_f32_16x16x32_bf16 v[196:199], a[148:151], a[44:47], v[196:199]
ds_read_b64_tr_b16 a[130:131], v235 offset:1792
v_mfma_f32_16x16x32_bf16 v[196:199], a[144:147], a[40:43], v[196:199]
v_mfma_f32_16x16x32_bf16 v[200:203], a[144:147], a[48:51], v[200:203]
ds_read_b64_tr_b16 a[132:133], v235 offset:7168
v_mfma_f32_16x16x32_bf16 v[200:203], a[148:151], a[52:55], v[200:203]
v_mfma_f32_16x16x32_bf16 v[204:207], a[148:151], a[60:63], v[204:207]
ds_read_b64_tr_b16 a[134:135], v235 offset:8960
v_mfma_f32_16x16x32_bf16 v[204:207], a[144:147], a[56:59], v[204:207]
s_waitcnt lgkmcnt(4)
v_mfma_f32_16x16x32_bf16 v[220:223], a[152:155], a[56:59], v[220:223]
ds_read_b64_tr_b16 a[136:137], v235 offset:14336
v_mfma_f32_16x16x32_bf16 v[220:223], a[156:159], a[60:63], v[220:223]
buffer_load_dwordx4 a[108:111], v225, s[8:11], s28 offen offset:1024 sc1
v_mfma_f32_16x16x32_bf16 v[216:219], a[156:159], a[52:55], v[216:219]
ds_read_b64_tr_b16 a[138:139], v235 offset:16128
v_mfma_f32_16x16x32_bf16 v[216:219], a[152:155], a[48:51], v[216:219]
v_mfma_f32_16x16x32_bf16 v[212:215], a[152:155], a[40:43], v[212:215]
ds_read_b64_tr_b16 a[140:141], v235 offset:21504
v_mfma_f32_16x16x32_bf16 v[212:215], a[156:159], a[44:47], v[212:215]
v_mfma_f32_16x16x32_bf16 v[208:211], a[156:159], a[36:39], v[208:211]
ds_read_b64_tr_b16 a[142:143], v235 offset:23296
v_mfma_f32_16x16x32_bf16 v[208:211], a[152:155], a[32:35], v[208:211]
s_waitcnt vmcnt(14) lgkmcnt(4)
v_mfma_f32_16x16x32_bf16 v[0:3], a[128:131], a[64:67], v[0:3]
ds_read_b64_tr_b16 a[144:145], v235 offset:32
v_mfma_f32_16x16x32_bf16 v[0:3], a[132:135], a[68:71], v[0:3]
buffer_load_dwordx4 a[116:119], v226, s[8:11], s28 offen offset:1024 sc1
v_mfma_f32_16x16x32_bf16 v[4:7], a[132:135], a[76:79], v[4:7]
ds_read_b64_tr_b16 a[146:147], v235 offset:1824
v_mfma_f32_16x16x32_bf16 v[4:7], a[128:131], a[72:75], v[4:7]
v_mfma_f32_16x16x32_bf16 v[8:11], a[128:131], a[80:83], v[8:11]
ds_read_b64_tr_b16 a[148:149], v235 offset:7200
v_mfma_f32_16x16x32_bf16 v[8:11], a[132:135], a[84:87], v[8:11]
buffer_load_dwordx4 a[124:127], v227, s[8:11], s28 offen offset:1024 sc1
v_mfma_f32_16x16x32_bf16 v[12:15], a[132:135], a[92:95], v[12:15]
ds_read_b64_tr_b16 a[150:151], v235 offset:8992
s_add_u32 s28, s28, 2048
v_mfma_f32_16x16x32_bf16 v[12:15], a[128:131], a[88:91], v[12:15]
s_add_u32 s30, s61, 49152
s_waitcnt lgkmcnt(4)
v_mfma_f32_16x16x32_bf16 v[28:31], a[136:139], a[88:91], v[28:31]
ds_read_b64_tr_b16 a[152:153], v235 offset:14368
v_mfma_f32_16x16x32_bf16 v[28:31], a[140:143], a[92:95], v[28:31]
buffer_store_dwordx4 a[224:227], v237, s[24:27], s30 offen sc1
v_mfma_f32_16x16x32_bf16 v[24:27], a[140:143], a[84:87], v[24:27]
ds_read_b64_tr_b16 a[154:155], v235 offset:16160
v_mfma_f32_16x16x32_bf16 v[24:27], a[136:139], a[80:83], v[24:27]
v_mfma_f32_16x16x32_bf16 v[20:23], a[136:139], a[72:75], v[20:23]
ds_read_b64_tr_b16 a[156:157], v235 offset:21536
s_add_u32 m0, s3, 86016
v_mfma_f32_16x16x32_bf16 v[20:23], a[140:143], a[76:79], v[20:23]
buffer_load_dwordx4 v228, s[12:15], s52 offen offset:0  lds
v_mfma_f32_16x16x32_bf16 v[16:19], a[140:143], a[68:71], v[16:19]
ds_read_b64_tr_b16 a[158:159], v235 offset:23328
v_mfma_f32_16x16x32_bf16 v[16:19], a[136:139], a[64:67], v[16:19]
s_waitcnt lgkmcnt(4)
v_mfma_f32_16x16x32_bf16 v[32:35], a[144:147], a[64:67], v[32:35]
ds_read_b64_tr_b16 a[128:129], v235 offset:64
s_add_u32 s53, s33, 3145728
v_mfma_f32_16x16x32_bf16 v[32:35], a[148:151], a[68:71], v[32:35]
s_cmp_eq_u32 s31, 0
s_cselect_b32 s53, s53, 0x40000000
v_mfma_f32_16x16x32_bf16 v[36:39], a[148:151], a[76:79], v[36:39]
ds_read_b64_tr_b16 a[130:131], v235 offset:1856
v_mfma_f32_16x16x32_bf16 v[36:39], a[144:147], a[72:75], v[36:39]
buffer_load_dwordx4 v229, s[12:15], s52 offen offset:1024  lds
v_mfma_f32_16x16x32_bf16 v[40:43], a[144:147], a[80:83], v[40:43]
ds_read_b64_tr_b16 a[132:133], v235 offset:7232
v_mfma_f32_16x16x32_bf16 v[40:43], a[148:151], a[84:87], v[40:43]
v_mfma_f32_16x16x32_bf16 v[44:47], a[148:151], a[92:95], v[44:47]
ds_read_b64_tr_b16 a[134:135], v235 offset:9024
buffer_load_dword v255, v253, s[12:15], s53 offen
v_mfma_f32_16x16x32_bf16 v[44:47], a[144:147], a[88:91], v[44:47]
s_waitcnt lgkmcnt(4)
v_mfma_f32_16x16x32_bf16 v[60:63], a[152:155], a[88:91], v[60:63]
ds_read_b64_tr_b16 a[136:137], v235 offset:14400
v_mfma_f32_16x16x32_bf16 v[60:63], a[156:159], a[92:95], v[60:63]
buffer_load_dwordx4 v230, s[12:15], s52 offen offset:2048  lds
v_mfma_f32_16x16x32_bf16 v[56:59], a[156:159], a[84:87], v[56:59]
ds_read_b64_tr_b16 a[138:139], v235 offset:16192
v_mfma_f32_16x16x32_bf16 v[56:59], a[152:155], a[80:83], v[56:59]
v_mfma_f32_16x16x32_bf16 v[52:55], a[152:155], a[72:75], v[52:55]
ds_read_b64_tr_b16 a[140:141], v235 offset:21568
v_mfma_f32_16x16x32_bf16 v[52:55], a[156:159], a[76:79], v[52:55]
v_mfma_f32_16x16x32_bf16 v[48:51], a[156:159], a[68:71], v[48:51]
ds_read_b64_tr_b16 a[142:143], v235 offset:23360
v_mfma_f32_16x16x32_bf16 v[48:51], a[152:155], a[64:67], v[48:51]
s_waitcnt lgkmcnt(4)
v_mfma_f32_16x16x32_bf16 v[64:67], a[128:131], a[64:67], v[64:67]
ds_read_b64_tr_b16 a[144:145], v235 offset:96
v_mfma_f32_16x16x32_bf16 v[64:67], a[132:135], a[68:71], v[64:67]
buffer_load_dwordx4 v231, s[12:15], s52 offen offset:3072  lds
v_mfma_f32_16x16x32_bf16 v[68:71], a[132:135], a[76:79], v[68:71]
ds_read_b64_tr_b16 a[146:147], v235 offset:1888
s_add_u32 m0, s3, 90112
v_mfma_f32_16x16x32_bf16 v[68:71], a[128:131], a[72:75], v[68:71]
v_mfma_f32_16x16x32_bf16 v[72:75], a[128:131], a[80:83], v[72:75]
ds_read_b64_tr_b16 a[148:149], v235 offset:7264
v_mfma_f32_16x16x32_bf16 v[72:75], a[132:135], a[84:87], v[72:75]
v_mfma_f32_16x16x32_bf16 v[76:79], a[132:135], a[92:95], v[76:79]
ds_read_b64_tr_b16 a[150:151], v235 offset:9056
v_mfma_f32_16x16x32_bf16 v[76:79], a[128:131], a[88:91], v[76:79]
s_waitcnt lgkmcnt(4)
v_mfma_f32_16x16x32_bf16 v[92:95], a[136:139], a[88:91], v[92:95]
ds_read_b64_tr_b16 a[152:153], v235 offset:14432
v_mfma_f32_16x16x32_bf16 v[92:95], a[140:143], a[92:95], v[92:95]
buffer_load_dwordx4 v232, s[12:15], s52 offen offset:0  lds
v_mfma_f32_16x16x32_bf16 v[88:91], a[140:143], a[84:87], v[88:91]
ds_read_b64_tr_b16 a[154:155], v235 offset:16224
v_mfma_f32_16x16x32_bf16 v[88:91], a[136:139], a[80:83], v[88:91]
v_mfma_f32_16x16x32_bf16 v[84:87], a[136:139], a[72:75], v[84:87]
ds_read_b64_tr_b16 a[156:157], v235 offset:21600
v_mfma_f32_16x16x32_bf16 v[84:87], a[140:143], a[76:79], v[84:87]
buffer_load_dwordx4 v233, s[12:15], s52 offen offset:1024  lds
v_mfma_f32_16x16x32_bf16 v[80:83], a[140:143], a[68:71], v[80:83]
ds_read_b64_tr_b16 a[158:159], v235 offset:23392
v_mfma_f32_16x16x32_bf16 v[80:83], a[136:139], a[64:67], v[80:83]
s_waitcnt lgkmcnt(4)
v_mfma_f32_16x16x32_bf16 v[96:99], a[144:147], a[64:67], v[96:99]
ds_read_b64_tr_b16 a[128:129], v235 offset:128
v_mfma_f32_16x16x32_bf16 v[96:99], a[148:151], a[68:71], v[96:99]
s_add_u32 s30, s61, 53248
v_mfma_f32_16x16x32_bf16 v[100:103], a[148:151], a[76:79], v[100:103]
ds_read_b64_tr_b16 a[130:131], v235 offset:1920
v_mfma_f32_16x16x32_bf16 v[100:103], a[144:147], a[72:75], v[100:103]
buffer_load_dwordx4 v234, s[12:15], s52 offen offset:2048  lds
v_mfma_f32_16x16x32_bf16 v[104:107], a[144:147], a[80:83], v[104:107]
ds_read_b64_tr_b16 a[132:133], v235 offset:7296
s_add_u32 s52, s52, 458752
v_mfma_f32_16x16x32_bf16 v[104:107], a[148:151], a[84:87], v[104:107]
buffer_store_dwordx4 a[228:231], v237, s[24:27], s30 offen sc1
v_mfma_f32_16x16x32_bf16 v[108:111], a[148:151], a[92:95], v[108:111]
ds_read_b64_tr_b16 a[134:135], v235 offset:9088
v_mfma_f32_16x16x32_bf16 v[108:111], a[144:147], a[88:91], v[108:111]
s_waitcnt lgkmcnt(4)
v_mfma_f32_16x16x32_bf16 v[124:127], a[152:155], a[88:91], v[124:127]
ds_read_b64_tr_b16 a[136:137], v235 offset:14464
v_mfma_f32_16x16x32_bf16 v[124:127], a[156:159], a[92:95], v[124:127]
v_mfma_f32_16x16x32_bf16 v[120:123], a[156:159], a[84:87], v[120:123]
ds_read_b64_tr_b16 a[138:139], v235 offset:16256
v_mfma_f32_16x16x32_bf16 v[120:123], a[152:155], a[80:83], v[120:123]
buffer_load_dwordx4 a[0:3], v224, s[8:11], s28 offen offset:0 sc1
v_mfma_f32_16x16x32_bf16 v[116:119], a[152:155], a[72:75], v[116:119]
ds_read_b64_tr_b16 a[140:141], v235 offset:21632
v_mfma_f32_16x16x32_bf16 v[116:119], a[156:159], a[76:79], v[116:119]
v_mfma_f32_16x16x32_bf16 v[112:115], a[156:159], a[68:71], v[112:115]
ds_read_b64_tr_b16 a[142:143], v235 offset:23424
v_mfma_f32_16x16x32_bf16 v[112:115], a[152:155], a[64:67], v[112:115]
s_waitcnt lgkmcnt(4)
v_mfma_f32_16x16x32_bf16 v[128:131], a[128:131], a[64:67], v[128:131]
ds_read_b64_tr_b16 a[144:145], v235 offset:160
v_mfma_f32_16x16x32_bf16 v[128:131], a[132:135], a[68:71], v[128:131]
buffer_load_dwordx4 a[8:11], v225, s[8:11], s28 offen offset:0 sc1
v_mfma_f32_16x16x32_bf16 v[132:135], a[132:135], a[76:79], v[132:135]
ds_read_b64_tr_b16 a[146:147], v235 offset:1952
v_mfma_f32_16x16x32_bf16 v[132:135], a[128:131], a[72:75], v[132:135]
v_mfma_f32_16x16x32_bf16 v[136:139], a[128:131], a[80:83], v[136:139]
ds_read_b64_tr_b16 a[148:149], v235 offset:7328
v_mfma_f32_16x16x32_bf16 v[136:139], a[132:135], a[84:87], v[136:139]
v_mfma_f32_16x16x32_bf16 v[140:143], a[132:135], a[92:95], v[140:143]
ds_read_b64_tr_b16 a[150:151], v235 offset:9120
v_mfma_f32_16x16x32_bf16 v[140:143], a[128:131], a[88:91], v[140:143]
s_waitcnt lgkmcnt(4)
v_mfma_f32_16x16x32_bf16 v[156:159], a[136:139], a[88:91], v[156:159]
ds_read_b64_tr_b16 a[152:153], v235 offset:14496
v_mfma_f32_16x16x32_bf16 v[156:159], a[140:143], a[92:95], v[156:159]
buffer_load_dwordx4 a[16:19], v226, s[8:11], s28 offen offset:0 sc1
v_mfma_f32_16x16x32_bf16 v[152:155], a[140:143], a[84:87], v[152:155]
ds_read_b64_tr_b16 a[154:155], v235 offset:16288
v_mfma_f32_16x16x32_bf16 v[152:155], a[136:139], a[80:83], v[152:155]
v_mfma_f32_16x16x32_bf16 v[148:151], a[136:139], a[72:75], v[148:151]
ds_read_b64_tr_b16 a[156:157], v235 offset:21664
s_add_u32 s53, s33, 3145728
v_mfma_f32_16x16x32_bf16 v[148:151], a[140:143], a[76:79], v[148:151]
s_cmp_eq_u32 s31, 1
s_cselect_b32 s53, s53, 0x40000000
v_mfma_f32_16x16x32_bf16 v[144:147], a[140:143], a[68:71], v[144:147]
ds_read_b64_tr_b16 a[158:159], v235 offset:23456
v_mfma_f32_16x16x32_bf16 v[144:147], a[136:139], a[64:67], v[144:147]
s_waitcnt lgkmcnt(4)
v_mfma_f32_16x16x32_bf16 v[160:163], a[144:147], a[64:67], v[160:163]
ds_read_b64_tr_b16 a[128:129], v235 offset:192
v_mfma_f32_16x16x32_bf16 v[160:163], a[148:151], a[68:71], v[160:163]
buffer_load_dwordx4 a[24:27], v227, s[8:11], s28 offen offset:0 sc1
v_mfma_f32_16x16x32_bf16 v[164:167], a[148:151], a[76:79], v[164:167]
ds_read_b64_tr_b16 a[130:131], v235 offset:1984
v_mfma_f32_16x16x32_bf16 v[164:167], a[144:147], a[72:75], v[164:167]
buffer_load_dword v255, v253, s[12:15], s53 offen
v_mfma_f32_16x16x32_bf16 v[168:171], a[144:147], a[80:83], v[168:171]
ds_read_b64_tr_b16 a[132:133], v235 offset:7360
v_mfma_f32_16x16x32_bf16 v[168:171], a[148:151], a[84:87], v[168:171]
buffer_load_dwordx4 a[4:7], v224, s[8:11], s28 offen offset:1024 sc1
v_mfma_f32_16x16x32_bf16 v[172:175], a[148:151], a[92:95], v[172:175]
ds_read_b64_tr_b16 a[134:135], v235 offset:9152
v_mfma_f32_16x16x32_bf16 v[172:175], a[144:147], a[88:91], v[172:175]
s_waitcnt lgkmcnt(4)
v_mfma_f32_16x16x32_bf16 v[188:191], a[152:155], a[88:91], v[188:191]
ds_read_b64_tr_b16 a[136:137], v235 offset:14528
v_mfma_f32_16x16x32_bf16 v[188:191], a[156:159], a[92:95], v[188:191]
v_mfma_f32_16x16x32_bf16 v[184:187], a[156:159], a[84:87], v[184:187]
ds_read_b64_tr_b16 a[138:139], v235 offset:16320
v_mfma_f32_16x16x32_bf16 v[184:187], a[152:155], a[80:83], v[184:187]
buffer_load_dwordx4 a[12:15], v225, s[8:11], s28 offen offset:1024 sc1
v_mfma_f32_16x16x32_bf16 v[180:183], a[152:155], a[72:75], v[180:183]
ds_read_b64_tr_b16 a[140:141], v235 offset:21696
v_mfma_f32_16x16x32_bf16 v[180:183], a[156:159], a[76:79], v[180:183]
s_waitcnt vmcnt(26)
s_barrier
v_mfma_f32_16x16x32_bf16 v[176:179], a[156:159], a[68:71], v[176:179]
ds_read_b64_tr_b16 a[142:143], v235 offset:23488
s_add_u32 s30, s61, 57344
v_mfma_f32_16x16x32_bf16 v[176:179], a[152:155], a[64:67], v[176:179]
s_waitcnt lgkmcnt(4)
v_mfma_f32_16x16x32_bf16 v[192:195], a[128:131], a[64:67], v[192:195]
ds_read_b64_tr_b16 a[144:145], v235 offset:28672
v_mfma_f32_16x16x32_bf16 v[192:195], a[132:135], a[68:71], v[192:195]
buffer_store_dwordx4 a[232:235], v237, s[24:27], s30 offen sc1
v_mfma_f32_16x16x32_bf16 v[196:199], a[132:135], a[76:79], v[196:199]
ds_read_b64_tr_b16 a[146:147], v235 offset:30464
v_mfma_f32_16x16x32_bf16 v[196:199], a[128:131], a[72:75], v[196:199]
buffer_load_dwordx4 a[20:23], v226, s[8:11], s28 offen offset:1024 sc1
v_mfma_f32_16x16x32_bf16 v[200:203], a[128:131], a[80:83], v[200:203]
ds_read_b64_tr_b16 a[148:149], v235 offset:35840
v_mfma_f32_16x16x32_bf16 v[200:203], a[132:135], a[84:87], v[200:203]
v_mfma_f32_16x16x32_bf16 v[204:207], a[132:135], a[92:95], v[204:207]
ds_read_b64_tr_b16 a[150:151], v235 offset:37632
v_mfma_f32_16x16x32_bf16 v[204:207], a[128:131], a[88:91], v[204:207]
s_waitcnt lgkmcnt(4)
v_mfma_f32_16x16x32_bf16 v[220:223], a[136:139], a[88:91], v[220:223]
ds_read_b64_tr_b16 a[152:153], v235 offset:43008
v_mfma_f32_16x16x32_bf16 v[220:223], a[140:143], a[92:95], v[220:223]
buffer_load_dwordx4 a[28:31], v227, s[8:11], s28 offen offset:1024 sc1
v_mfma_f32_16x16x32_bf16 v[216:219], a[140:143], a[84:87], v[216:219]
ds_read_b64_tr_b16 a[154:155], v235 offset:44800
s_add_u32 s28, s28, 2048
v_mfma_f32_16x16x32_bf16 v[216:219], a[136:139], a[80:83], v[216:219]
v_mfma_f32_16x16x32_bf16 v[212:215], a[136:139], a[72:75], v[212:215]
ds_read_b64_tr_b16 a[156:157], v235 offset:50176
v_mfma_f32_16x16x32_bf16 v[212:215], a[140:143], a[76:79], v[212:215]
v_mfma_f32_16x16x32_bf16 v[208:211], a[140:143], a[68:71], v[208:211]
ds_read_b64_tr_b16 a[158:159], v235 offset:51968
v_mfma_f32_16x16x32_bf16 v[208:211], a[136:139], a[64:67], v[208:211]
s_add_u32 m0, s3, 57344
s_waitcnt vmcnt(20) lgkmcnt(4)
v_mfma_f32_16x16x32_bf16 v[0:3], a[144:147], a[96:99], v[0:3]
ds_read_b64_tr_b16 a[128:129], v235 offset:28704
v_mfma_f32_16x16x32_bf16 v[0:3], a[148:151], a[100:103], v[0:3]
buffer_load_dwordx4 v228, s[12:15], s52 offen offset:0  lds
v_mfma_f32_16x16x32_bf16 v[4:7], a[148:151], a[108:111], v[4:7]
ds_read_b64_tr_b16 a[130:131], v235 offset:30496
v_mfma_f32_16x16x32_bf16 v[4:7], a[144:147], a[104:107], v[4:7]
v_mfma_f32_16x16x32_bf16 v[8:11], a[144:147], a[112:115], v[8:11]
ds_read_b64_tr_b16 a[132:133], v235 offset:35872
v_mfma_f32_16x16x32_bf16 v[8:11], a[148:151], a[116:119], v[8:11]
v_mfma_f32_16x16x32_bf16 v[12:15], a[148:151], a[124:127], v[12:15]
ds_read_b64_tr_b16 a[134:135], v235 offset:37664
v_mfma_f32_16x16x32_bf16 v[12:15], a[144:147], a[120:123], v[12:15]
s_waitcnt lgkmcnt(4)
v_mfma_f32_16x16x32_bf16 v[28:31], a[152:155], a[120:123], v[28:31]
ds_read_b64_tr_b16 a[136:137], v235 offset:43040
v_mfma_f32_16x16x32_bf16 v[28:31], a[156:159], a[124:127], v[28:31]
buffer_load_dwordx4 v229, s[12:15], s52 offen offset:1024  lds
v_mfma_f32_16x16x32_bf16 v[24:27], a[156:159], a[116:119], v[24:27]
ds_read_b64_tr_b16 a[138:139], v235 offset:44832
v_mfma_f32_16x16x32_bf16 v[24:27], a[152:155], a[112:115], v[24:27]
v_mfma_f32_16x16x32_bf16 v[20:23], a[152:155], a[104:107], v[20:23]
ds_read_b64_tr_b16 a[140:141], v235 offset:50208
v_mfma_f32_16x16x32_bf16 v[20:23], a[156:159], a[108:111], v[20:23]
buffer_load_dwordx4 v230, s[12:15], s52 offen offset:2048  lds
v_mfma_f32_16x16x32_bf16 v[16:19], a[156:159], a[100:103], v[16:19]
ds_read_b64_tr_b16 a[142:143], v235 offset:52000
v_mfma_f32_16x16x32_bf16 v[16:19], a[152:155], a[96:99], v[16:19]
s_waitcnt lgkmcnt(4)
v_mfma_f32_16x16x32_bf16 v[32:35], a[128:131], a[96:99], v[32:35]
ds_read_b64_tr_b16 a[144:145], v235 offset:28736
v_mfma_f32_16x16x32_bf16 v[32:35], a[132:135], a[100:103], v[32:35]
v_mfma_f32_16x16x32_bf16 v[36:39], a[132:135], a[108:111], v[36:39]
ds_read_b64_tr_b16 a[146:147], v235 offset:30528
v_mfma_f32_16x16x32_bf16 v[36:39], a[128:131], a[104:107], v[36:39]
buffer_load_dwordx4 v231, s[12:15], s52 offen offset:3072  lds
v_mfma_f32_16x16x32_bf16 v[40:43], a[128:131], a[112:115], v[40:43]
ds_read_b64_tr_b16 a[148:149], v235 offset:35904
s_add_u32 m0, s3, 61440
v_mfma_f32_16x16x32_bf16 v[40:43], a[132:135], a[116:119], v[40:43]
v_mfma_f32_16x16x32_bf16 v[44:47], a[132:135], a[124:127], v[44:47]
ds_read_b64_tr_b16 a[150:151], v235 offset:37696
v_mfma_f32_16x16x32_bf16 v[44:47], a[128:131], a[120:123], v[44:47]
s_waitcnt lgkmcnt(4)
v_mfma_f32_16x16x32_bf16 v[60:63], a[136:139], a[120:123], v[60:63]
ds_read_b64_tr_b16 a[152:153], v235 offset:43072
v_mfma_f32_16x16x32_bf16 v[60:63], a[140:143], a[124:127], v[60:63]
buffer_load_dwordx4 v232, s[12:15], s52 offen offset:0  lds
v_mfma_f32_16x16x32_bf16 v[56:59], a[140:143], a[116:119], v[56:59]
ds_read_b64_tr_b16 a[154:155], v235 offset:44864
s_add_u32 s30, s61, 61440
v_mfma_f32_16x16x32_bf16 v[56:59], a[136:139], a[112:115], v[56:59]
buffer_store_dwordx4 a[236:239], v237, s[24:27], s30 offen sc1
v_mfma_f32_16x16x32_bf16 v[52:55], a[136:139], a[104:107], v[52:55]
ds_read_b64_tr_b16 a[156:157], v235 offset:50240
v_mfma_f32_16x16x32_bf16 v[52:55], a[140:143], a[108:111], v[52:55]
v_mfma_f32_16x16x32_bf16 v[48:51], a[140:143], a[100:103], v[48:51]
ds_read_b64_tr_b16 a[158:159], v235 offset:52032
v_mfma_f32_16x16x32_bf16 v[48:51], a[136:139], a[96:99], v[48:51]
s_waitcnt lgkmcnt(4)
v_mfma_f32_16x16x32_bf16 v[64:67], a[144:147], a[96:99], v[64:67]
ds_read_b64_tr_b16 a[128:129], v235 offset:28768
v_mfma_f32_16x16x32_bf16 v[64:67], a[148:151], a[100:103], v[64:67]
buffer_load_dwordx4 v233, s[12:15], s52 offen offset:1024  lds
v_mfma_f32_16x16x32_bf16 v[68:71], a[148:151], a[108:111], v[68:71]
ds_read_b64_tr_b16 a[130:131], v235 offset:30560
v_mfma_f32_16x16x32_bf16 v[68:71], a[144:147], a[104:107], v[68:71]
v_mfma_f32_16x16x32_bf16 v[72:75], a[144:147], a[112:115], v[72:75]
ds_read_b64_tr_b16 a[132:133], v235 offset:35936
v_mfma_f32_16x16x32_bf16 v[72:75], a[148:151], a[116:119], v[72:75]
v_mfma_f32_16x16x32_bf16 v[76:79], a[148:151], a[124:127], v[76:79]
ds_read_b64_tr_b16 a[134:135], v235 offset:37728
s_add_u32 s53, s33, 4194304
v_mfma_f32_16x16x32_bf16 v[76:79], a[144:147], a[120:123], v[76:79]
s_cmp_eq_u32 s31, 0
s_cselect_b32 s53, s53, 0x40000000
s_waitcnt lgkmcnt(4)
v_mfma_f32_16x16x32_bf16 v[92:95], a[152:155], a[120:123], v[92:95]
ds_read_b64_tr_b16 a[136:137], v235 offset:43104
v_mfma_f32_16x16x32_bf16 v[92:95], a[156:159], a[124:127], v[92:95]
buffer_load_dwordx4 v234, s[12:15], s52 offen offset:2048  lds
v_mfma_f32_16x16x32_bf16 v[88:91], a[156:159], a[116:119], v[88:91]
ds_read_b64_tr_b16 a[138:139], v235 offset:44896
s_add_u32 s52, s52, 458752
v_mfma_f32_16x16x32_bf16 v[88:91], a[152:155], a[112:115], v[88:91]
v_mfma_f32_16x16x32_bf16 v[84:87], a[152:155], a[104:107], v[84:87]
ds_read_b64_tr_b16 a[140:141], v235 offset:50272
buffer_load_dword v255, v253, s[12:15], s53 offen
v_mfma_f32_16x16x32_bf16 v[84:87], a[156:159], a[108:111], v[84:87]
buffer_load_dwordx4 a[32:35], v224, s[8:11], s28 offen offset:0 sc1
v_mfma_f32_16x16x32_bf16 v[80:83], a[156:159], a[100:103], v[80:83]
ds_read_b64_tr_b16 a[142:143], v235 offset:52064
v_mfma_f32_16x16x32_bf16 v[80:83], a[152:155], a[96:99], v[80:83]
s_waitcnt lgkmcnt(4)
v_mfma_f32_16x16x32_bf16 v[96:99], a[128:131], a[96:99], v[96:99]
ds_read_b64_tr_b16 a[144:145], v235 offset:28800
v_mfma_f32_16x16x32_bf16 v[96:99], a[132:135], a[100:103], v[96:99]
v_mfma_f32_16x16x32_bf16 v[100:103], a[132:135], a[108:111], v[100:103]
ds_read_b64_tr_b16 a[146:147], v235 offset:30592
v_mfma_f32_16x16x32_bf16 v[100:103], a[128:131], a[104:107], v[100:103]
v_mfma_f32_16x16x32_bf16 v[104:107], a[128:131], a[112:115], v[104:107]
ds_read_b64_tr_b16 a[148:149], v235 offset:35968
v_mfma_f32_16x16x32_bf16 v[104:107], a[132:135], a[116:119], v[104:107]
buffer_load_dwordx4 a[40:43], v225, s[8:11], s28 offen offset:0 sc1
v_mfma_f32_16x16x32_bf16 v[108:111], a[132:135], a[124:127], v[108:111]
ds_read_b64_tr_b16 a[150:151], v235 offset:37760
v_mfma_f32_16x16x32_bf16 v[108:111], a[128:131], a[120:123], v[108:111]
s_waitcnt lgkmcnt(4)
v_mfma_f32_16x16x32_bf16 v[124:127], a[136:139], a[120:123], v[124:127]
ds_read_b64_tr_b16 a[152:153], v235 offset:43136
v_mfma_f32_16x16x32_bf16 v[124:127], a[140:143], a[124:127], v[124:127]
v_mfma_f32_16x16x32_bf16 v[120:123], a[140:143], a[116:119], v[120:123]
ds_read_b64_tr_b16 a[154:155], v235 offset:44928
v_mfma_f32_16x16x32_bf16 v[120:123], a[136:139], a[112:115], v[120:123]
buffer_load_dwordx4 a[48:51], v226, s[8:11], s28 offen offset:0 sc1
v_mfma_f32_16x16x32_bf16 v[116:119], a[136:139], a[104:107], v[116:119]
ds_read_b64_tr_b16 a[156:157], v235 offset:50304
v_mfma_f32_16x16x32_bf16 v[116:119], a[140:143], a[108:111], v[116:119]
v_mfma_f32_16x16x32_bf16 v[112:115], a[140:143], a[100:103], v[112:115]
ds_read_b64_tr_b16 a[158:159], v235 offset:52096
v_mfma_f32_16x16x32_bf16 v[112:115], a[136:139], a[96:99], v[112:115]
s_waitcnt lgkmcnt(4)
v_mfma_f32_16x16x32_bf16 v[128:131], a[144:147], a[96:99], v[128:131]
ds_read_b64_tr_b16 a[128:129], v235 offset:28832
v_mfma_f32_16x16x32_bf16 v[128:131], a[148:151], a[100:103], v[128:131]
buffer_load_dwordx4 a[56:59], v227, s[8:11], s28 offen offset:0 sc1
v_mfma_f32_16x16x32_bf16 v[132:135], a[148:151], a[108:111], v[132:135]
ds_read_b64_tr_b16 a[130:131], v235 offset:30624
v_mfma_f32_16x16x32_bf16 v[132:135], a[144:147], a[104:107], v[132:135]
buffer_store_dword a244, v250, s[24:27], s62 offen sc1
v_mfma_f32_16x16x32_bf16 v[136:139], a[144:147], a[112:115], v[136:139]
ds_read_b64_tr_b16 a[132:133], v235 offset:36000
v_mfma_f32_16x16x32_bf16 v[136:139], a[148:151], a[116:119], v[136:139]
v_mfma_f32_16x16x32_bf16 v[140:143], a[148:151], a[124:127], v[140:143]
ds_read_b64_tr_b16 a[134:135], v235 offset:37792
v_mfma_f32_16x16x32_bf16 v[140:143], a[144:147], a[120:123], v[140:143]
s_waitcnt lgkmcnt(4)
v_mfma_f32_16x16x32_bf16 v[156:159], a[152:155], a[120:123], v[156:159]
ds_read_b64_tr_b16 a[136:137], v235 offset:43168
v_mfma_f32_16x16x32_bf16 v[156:159], a[156:159], a[124:127], v[156:159]
buffer_load_dwordx4 a[36:39], v224, s[8:11], s28 offen offset:1024 sc1
v_mfma_f32_16x16x32_bf16 v[152:155], a[156:159], a[116:119], v[152:155]
ds_read_b64_tr_b16 a[138:139], v235 offset:44960
v_mfma_f32_16x16x32_bf16 v[152:155], a[152:155], a[112:115], v[152:155]
v_mfma_f32_16x16x32_bf16 v[148:151], a[152:155], a[104:107], v[148:151]
ds_read_b64_tr_b16 a[140:141], v235 offset:50336
v_mfma_f32_16x16x32_bf16 v[148:151], a[156:159], a[108:111], v[148:151]
v_mfma_f32_16x16x32_bf16 v[144:147], a[156:159], a[100:103], v[144:147]
ds_read_b64_tr_b16 a[142:143], v235 offset:52128
v_mfma_f32_16x16x32_bf16 v[144:147], a[152:155], a[96:99], v[144:147]
s_waitcnt lgkmcnt(4)
v_mfma_f32_16x16x32_bf16 v[160:163], a[128:131], a[96:99], v[160:163]
ds_read_b64_tr_b16 a[144:145], v235 offset:28864
v_mfma_f32_16x16x32_bf16 v[160:163], a[132:135], a[100:103], v[160:163]
buffer_load_dwordx4 a[44:47], v225, s[8:11], s28 offen offset:1024 sc1
v_mfma_f32_16x16x32_bf16 v[164:167], a[132:135], a[108:111], v[164:167]
ds_read_b64_tr_b16 a[146:147], v235 offset:30656
v_mfma_f32_16x16x32_bf16 v[164:167], a[128:131], a[104:107], v[164:167]
v_mfma_f32_16x16x32_bf16 v[168:171], a[128:131], a[112:115], v[168:171]
ds_read_b64_tr_b16 a[148:149], v235 offset:36032
v_mfma_f32_16x16x32_bf16 v[168:171], a[132:135], a[116:119], v[168:171]
buffer_load_dwordx4 a[52:55], v226, s[8:11], s28 offen offset:1024 sc1
v_mfma_f32_16x16x32_bf16 v[172:175], a[132:135], a[124:127], v[172:175]
ds_read_b64_tr_b16 a[150:151], v235 offset:37824
v_mfma_f32_16x16x32_bf16 v[172:175], a[128:131], a[120:123], v[172:175]
s_waitcnt lgkmcnt(4)
v_mfma_f32_16x16x32_bf16 v[188:191], a[136:139], a[120:123], v[188:191]
ds_read_b64_tr_b16 a[152:153], v235 offset:43200
v_mfma_f32_16x16x32_bf16 v[188:191], a[140:143], a[124:127], v[188:191]
v_mfma_f32_16x16x32_bf16 v[184:187], a[140:143], a[116:119], v[184:187]
ds_read_b64_tr_b16 a[154:155], v235 offset:44992
v_mfma_f32_16x16x32_bf16 v[184:187], a[136:139], a[112:115], v[184:187]
buffer_load_dwordx4 a[60:63], v227, s[8:11], s28 offen offset:1024 sc1
v_mfma_f32_16x16x32_bf16 v[180:183], a[136:139], a[104:107], v[180:183]
ds_read_b64_tr_b16 a[156:157], v235 offset:50368
s_add_u32 s28, s28, 2048
v_mfma_f32_16x16x32_bf16 v[180:183], a[140:143], a[108:111], v[180:183]
s_waitcnt vmcnt(29)
s_barrier
v_mfma_f32_16x16x32_bf16 v[176:179], a[140:143], a[100:103], v[176:179]
ds_read_b64_tr_b16 a[158:159], v235 offset:52160
v_mfma_f32_16x16x32_bf16 v[176:179], a[136:139], a[96:99], v[176:179]
s_waitcnt lgkmcnt(4)
v_mfma_f32_16x16x32_bf16 v[192:195], a[144:147], a[96:99], v[192:195]
ds_read_b64_tr_b16 a[128:129], v236 offset:28672
v_mfma_f32_16x16x32_bf16 v[192:195], a[148:151], a[100:103], v[192:195]
v_mfma_f32_16x16x32_bf16 v[196:199], a[148:151], a[108:111], v[196:199]
ds_read_b64_tr_b16 a[130:131], v236 offset:30464
s_add_u32 m0, s3, 0
v_mfma_f32_16x16x32_bf16 v[196:199], a[144:147], a[104:107], v[196:199]
buffer_load_dwordx4 v228, s[12:15], s52 offen offset:0  lds
v_mfma_f32_16x16x32_bf16 v[200:203], a[144:147], a[112:115], v[200:203]
ds_read_b64_tr_b16 a[132:133], v236 offset:35840
s_add_u32 s53, s33, 4194304
v_mfma_f32_16x16x32_bf16 v[200:203], a[148:151], a[116:119], v[200:203]
s_cmp_eq_u32 s31, 1
s_cselect_b32 s53, s53, 0x40000000
v_mfma_f32_16x16x32_bf16 v[204:207], a[148:151], a[124:127], v[204:207]
ds_read_b64_tr_b16 a[134:135], v236 offset:37632
v_mfma_f32_16x16x32_bf16 v[204:207], a[144:147], a[120:123], v[204:207]
s_waitcnt lgkmcnt(4)
v_mfma_f32_16x16x32_bf16 v[220:223], a[152:155], a[120:123], v[220:223]
ds_read_b64_tr_b16 a[136:137], v236 offset:43008
v_mfma_f32_16x16x32_bf16 v[220:223], a[156:159], a[124:127], v[220:223]
buffer_load_dwordx4 v229, s[12:15], s52 offen offset:1024  lds
v_mfma_f32_16x16x32_bf16 v[216:219], a[156:159], a[116:119], v[216:219]
ds_read_b64_tr_b16 a[138:139], v236 offset:44800
v_mfma_f32_16x16x32_bf16 v[216:219], a[152:155], a[112:115], v[216:219]
buffer_load_dword v255, v253, s[12:15], s53 offen
v_mfma_f32_16x16x32_bf16 v[212:215], a[152:155], a[104:107], v[212:215]
ds_read_b64_tr_b16 a[140:141], v236 offset:50176
v_mfma_f32_16x16x32_bf16 v[212:215], a[156:159], a[108:111], v[212:215]
v_mfma_f32_16x16x32_bf16 v[208:211], a[156:159], a[100:103], v[208:211]
ds_read_b64_tr_b16 a[142:143], v236 offset:51968
v_mfma_f32_16x16x32_bf16 v[208:211], a[152:155], a[96:99], v[208:211]
s_waitcnt vmcnt(21) lgkmcnt(4)
v_mfma_f32_16x16x32_bf16 v[0:3], a[128:131], a[0:3], v[0:3]
ds_read_b64_tr_b16 a[144:145], v236 offset:28704
v_mfma_f32_16x16x32_bf16 v[0:3], a[132:135], a[4:7], v[0:3]
buffer_load_dwordx4 v230, s[12:15], s52 offen offset:2048  lds
v_mfma_f32_16x16x32_bf16 v[4:7], a[132:135], a[12:15], v[4:7]
ds_read_b64_tr_b16 a[146:147], v236 offset:30496
v_mfma_f32_16x16x32_bf16 v[4:7], a[128:131], a[8:11], v[4:7]
v_mfma_f32_16x16x32_bf16 v[8:11], a[128:131], a[16:19], v[8:11]
ds_read_b64_tr_b16 a[148:149], v236 offset:35872
v_mfma_f32_16x16x32_bf16 v[8:11], a[132:135], a[20:23], v[8:11]
v_mfma_f32_16x16x32_bf16 v[12:15], a[132:135], a[28:31], v[12:15]
ds_read_b64_tr_b16 a[150:151], v236 offset:37664
v_mfma_f32_16x16x32_bf16 v[12:15], a[128:131], a[24:27], v[12:15]
s_waitcnt lgkmcnt(4)
v_mfma_f32_16x16x32_bf16 v[28:31], a[136:139], a[24:27], v[28:31]
ds_read_b64_tr_b16 a[152:153], v236 offset:43040
v_mfma_f32_16x16x32_bf16 v[28:31], a[140:143], a[28:31], v[28:31]
buffer_load_dwordx4 v231, s[12:15], s52 offen offset:3072  lds
v_mfma_f32_16x16x32_bf16 v[24:27], a[140:143], a[20:23], v[24:27]
ds_read_b64_tr_b16 a[154:155], v236 offset:44832
s_add_u32 m0, s3, 4096
v_mfma_f32_16x16x32_bf16 v[24:27], a[136:139], a[16:19], v[24:27]
v_mfma_f32_16x16x32_bf16 v[20:23], a[136:139], a[8:11], v[20:23]
ds_read_b64_tr_b16 a[156:157], v236 offset:50208
v_mfma_f32_16x16x32_bf16 v[20:23], a[140:143], a[12:15], v[20:23]
buffer_load_dwordx4 v232, s[12:15], s52 offen offset:0  lds
v_mfma_f32_16x16x32_bf16 v[16:19], a[140:143], a[4:7], v[16:19]
ds_read_b64_tr_b16 a[158:159], v236 offset:52000
v_mfma_f32_16x16x32_bf16 v[16:19], a[136:139], a[0:3], v[16:19]
s_waitcnt lgkmcnt(4)
v_mfma_f32_16x16x32_bf16 v[32:35], a[144:147], a[0:3], v[32:35]
ds_read_b64_tr_b16 a[128:129], v236 offset:28736
v_mfma_f32_16x16x32_bf16 v[32:35], a[148:151], a[4:7], v[32:35]
v_mfma_f32_16x16x32_bf16 v[36:39], a[148:151], a[12:15], v[36:39]
ds_read_b64_tr_b16 a[130:131], v236 offset:30528
v_mfma_f32_16x16x32_bf16 v[36:39], a[144:147], a[8:11], v[36:39]
buffer_load_dwordx4 v233, s[12:15], s52 offen offset:1024  lds
v_mfma_f32_16x16x32_bf16 v[40:43], a[144:147], a[16:19], v[40:43]
ds_read_b64_tr_b16 a[132:133], v236 offset:35904
v_mfma_f32_16x16x32_bf16 v[40:43], a[148:151], a[20:23], v[40:43]
v_mfma_f32_16x16x32_bf16 v[44:47], a[148:151], a[28:31], v[44:47]
ds_read_b64_tr_b16 a[134:135], v236 offset:37696
v_mfma_f32_16x16x32_bf16 v[44:47], a[144:147], a[24:27], v[44:47]
s_waitcnt lgkmcnt(4)
v_mfma_f32_16x16x32_bf16 v[60:63], a[152:155], a[24:27], v[60:63]
ds_read_b64_tr_b16 a[136:137], v236 offset:43072
v_mfma_f32_16x16x32_bf16 v[60:63], a[156:159], a[28:31], v[60:63]
v_mfma_f32_16x16x32_bf16 v[56:59], a[156:159], a[20:23], v[56:59]
ds_read_b64_tr_b16 a[138:139], v236 offset:44864
v_mfma_f32_16x16x32_bf16 v[56:59], a[152:155], a[16:19], v[56:59]
buffer_load_dwordx4 v234, s[12:15], s52 offen offset:2048  lds
v_mfma_f32_16x16x32_bf16 v[52:55], a[152:155], a[8:11], v[52:55]
ds_read_b64_tr_b16 a[140:141], v236 offset:50240
s_add_u32 s52, s52, 458752
v_mfma_f32_16x16x32_bf16 v[52:55], a[156:159], a[12:15], v[52:55]
v_mfma_f32_16x16x32_bf16 v[48:51], a[156:159], a[4:7], v[48:51]
ds_read_b64_tr_b16 a[142:143], v236 offset:52032
v_mfma_f32_16x16x32_bf16 v[48:51], a[152:155], a[0:3], v[48:51]
s_waitcnt lgkmcnt(4)
v_mfma_f32_16x16x32_bf16 v[64:67], a[128:131], a[0:3], v[64:67]
ds_read_b64_tr_b16 a[144:145], v236 offset:28768
v_mfma_f32_16x16x32_bf16 v[64:67], a[132:135], a[4:7], v[64:67]
buffer_load_dwordx4 a[64:67], v224, s[8:11], s28 offen offset:0 sc1
v_mfma_f32_16x16x32_bf16 v[68:71], a[132:135], a[12:15], v[68:71]
ds_read_b64_tr_b16 a[146:147], v236 offset:30560
v_mfma_f32_16x16x32_bf16 v[68:71], a[128:131], a[8:11], v[68:71]
v_mfma_f32_16x16x32_bf16 v[72:75], a[128:131], a[16:19], v[72:75]
ds_read_b64_tr_b16 a[148:149], v236 offset:35936
v_mfma_f32_16x16x32_bf16 v[72:75], a[132:135], a[20:23], v[72:75]
v_mfma_f32_16x16x32_bf16 v[76:79], a[132:135], a[28:31], v[76:79]
ds_read_b64_tr_b16 a[150:151], v236 offset:37728
v_mfma_f32_16x16x32_bf16 v[76:79], a[128:131], a[24:27], v[76:79]
s_waitcnt lgkmcnt(4)
v_mfma_f32_16x16x32_bf16 v[92:95], a[136:139], a[24:27], v[92:95]
ds_read_b64_tr_b16 a[152:153], v236 offset:43104
v_mfma_f32_16x16x32_bf16 v[92:95], a[140:143], a[28:31], v[92:95]
buffer_load_dwordx4 a[72:75], v225, s[8:11], s28 offen offset:0 sc1
v_mfma_f32_16x16x32_bf16 v[88:91], a[140:143], a[20:23], v[88:91]
ds_read_b64_tr_b16 a[154:155], v236 offset:44896
v_mfma_f32_16x16x32_bf16 v[88:91], a[136:139], a[16:19], v[88:91]
v_mfma_f32_16x16x32_bf16 v[84:87], a[136:139], a[8:11], v[84:87]
ds_read_b64_tr_b16 a[156:157], v236 offset:50272
v_mfma_f32_16x16x32_bf16 v[84:87], a[140:143], a[12:15], v[84:87]
v_mfma_f32_16x16x32_bf16 v[80:83], a[140:143], a[4:7], v[80:83]
ds_read_b64_tr_b16 a[158:159], v236 offset:52064
v_mfma_f32_16x16x32_bf16 v[80:83], a[136:139], a[0:3], v[80:83]
s_waitcnt lgkmcnt(4)
v_mfma_f32_16x16x32_bf16 v[96:99], a[144:147], a[0:3], v[96:99]
ds_read_b64_tr_b16 a[128:129], v236 offset:28800
v_mfma_f32_16x16x32_bf16 v[96:99], a[148:151], a[4:7], v[96:99]
buffer_load_dwordx4 a[80:83], v226, s[8:11], s28 offen offset:0 sc1
v_mfma_f32_16x16x32_bf16 v[100:103], a[148:151], a[12:15], v[100:103]
ds_read_b64_tr_b16 a[130:131], v236 offset:30592
v_mfma_f32_16x16x32_bf16 v[100:103], a[144:147], a[8:11], v[100:103]
v_mfma_f32_16x16x32_bf16 v[104:107], a[144:147], a[16:19], v[104:107]
ds_read_b64_tr_b16 a[132:133], v236 offset:35968
v_mfma_f32_16x16x32_bf16 v[104:107], a[148:151], a[20:23], v[104:107]
buffer_load_dwordx4 a[88:91], v227, s[8:11], s28 offen offset:0 sc1
v_mfma_f32_16x16x32_bf16 v[108:111], a[148:151], a[28:31], v[108:111]
ds_read_b64_tr_b16 a[134:135], v236 offset:37760
v_mfma_f32_16x16x32_bf16 v[108:111], a[144:147], a[24:27], v[108:111]
s_waitcnt lgkmcnt(4)
v_mfma_f32_16x16x32_bf16 v[124:127], a[152:155], a[24:27], v[124:127]
ds_read_b64_tr_b16 a[136:137], v236 offset:43136
v_mfma_f32_16x16x32_bf16 v[124:127], a[156:159], a[28:31], v[124:127]
v_mfma_f32_16x16x32_bf16 v[120:123], a[156:159], a[20:23], v[120:123]
ds_read_b64_tr_b16 a[138:139], v236 offset:44928
v_mfma_f32_16x16x32_bf16 v[120:123], a[152:155], a[16:19], v[120:123]
buffer_load_dwordx4 a[68:71], v224, s[8:11], s28 offen offset:1024 sc1
v_mfma_f32_16x16x32_bf16 v[116:119], a[152:155], a[8:11], v[116:119]
ds_read_b64_tr_b16 a[140:141], v236 offset:50304
v_mfma_f32_16x16x32_bf16 v[116:119], a[156:159], a[12:15], v[116:119]
s_add_u32 s53, s33, 5242880
v_mfma_f32_16x16x32_bf16 v[112:115], a[156:159], a[4:7], v[112:115]
ds_read_b64_tr_b16 a[142:143], v236 offset:52096
s_cmp_eq_u32 s31, 0
s_cselect_b32 s53, s53, 0x40000000
v_mfma_f32_16x16x32_bf16 v[112:115], a[152:155], a[0:3], v[112:115]
s_waitcnt lgkmcnt(4)
v_mfma_f32_16x16x32_bf16 v[128:131], a[128:131], a[0:3], v[128:131]
ds_read_b64_tr_b16 a[144:145], v236 offset:28832
v_mfma_f32_16x16x32_bf16 v[128:131], a[132:135], a[4:7], v[128:131]
buffer_load_dwordx4 a[76:79], v225, s[8:11], s28 offen offset:1024 sc1
v_mfma_f32_16x16x32_bf16 v[132:135], a[132:135], a[12:15], v[132:135]
ds_read_b64_tr_b16 a[146:147], v236 offset:30624
v_mfma_f32_16x16x32_bf16 v[132:135], a[128:131], a[8:11], v[132:135]
buffer_load_dword v255, v253, s[12:15], s53 offen
v_mfma_f32_16x16x32_bf16 v[136:139], a[128:131], a[16:19], v[136:139]
ds_read_b64_tr_b16 a[148:149], v236 offset:36000
v_mfma_f32_16x16x32_bf16 v[136:139], a[132:135], a[20:23], v[136:139]
v_mfma_f32_16x16x32_bf16 v[140:143], a[132:135], a[28:31], v[140:143]
ds_read_b64_tr_b16 a[150:151], v236 offset:37792
v_mfma_f32_16x16x32_bf16 v[140:143], a[128:131], a[24:27], v[140:143]
s_waitcnt lgkmcnt(4)
v_mfma_f32_16x16x32_bf16 v[156:159], a[136:139], a[24:27], v[156:159]
ds_read_b64_tr_b16 a[152:153], v236 offset:43168
v_mfma_f32_16x16x32_bf16 v[156:159], a[140:143], a[28:31], v[156:159]
buffer_load_dwordx4 a[84:87], v226, s[8:11], s28 offen offset:1024 sc1
v_mfma_f32_16x16x32_bf16 v[152:155], a[140:143], a[20:23], v[152:155]
ds_read_b64_tr_b16 a[154:155], v236 offset:44960
v_mfma_f32_16x16x32_bf16 v[152:155], a[136:139], a[16:19], v[152:155]
v_mfma_f32_16x16x32_bf16 v[148:151], a[136:139], a[8:11], v[148:151]
ds_read_b64_tr_b16 a[156:157], v236 offset:50336
v_mfma_f32_16x16x32_bf16 v[148:151], a[140:143], a[12:15], v[148:151]
v_mfma_f32_16x16x32_bf16 v[144:147], a[140:143], a[4:7], v[144:147]
ds_read_b64_tr_b16 a[158:159], v236 offset:52128
v_mfma_f32_16x16x32_bf16 v[144:147], a[136:139], a[0:3], v[144:147]
s_waitcnt lgkmcnt(4)
v_mfma_f32_16x16x32_bf16 v[160:163], a[144:147], a[0:3], v[160:163]
ds_read_b64_tr_b16 a[128:129], v236 offset:28864
v_mfma_f32_16x16x32_bf16 v[160:163], a[148:151], a[4:7], v[160:163]
buffer_load_dwordx4 a[92:95], v227, s[8:11], s28 offen offset:1024 sc1
v_mfma_f32_16x16x32_bf16 v[164:167], a[148:151], a[12:15], v[164:167]
ds_read_b64_tr_b16 a[130:131], v236 offset:30656
s_add_u32 s28, s28, 2048
v_mfma_f32_16x16x32_bf16 v[164:167], a[144:147], a[8:11], v[164:167]
v_mfma_f32_16x16x32_bf16 v[168:171], a[144:147], a[16:19], v[168:171]
ds_read_b64_tr_b16 a[132:133], v236 offset:36032
v_mfma_f32_16x16x32_bf16 v[168:171], a[148:151], a[20:23], v[168:171]
v_mfma_f32_16x16x32_bf16 v[172:175], a[148:151], a[28:31], v[172:175]
ds_read_b64_tr_b16 a[134:135], v236 offset:37824
v_mfma_f32_16x16x32_bf16 v[172:175], a[144:147], a[24:27], v[172:175]
s_waitcnt lgkmcnt(4)
v_mfma_f32_16x16x32_bf16 v[188:191], a[152:155], a[24:27], v[188:191]
ds_read_b64_tr_b16 a[136:137], v236 offset:43200
v_mfma_f32_16x16x32_bf16 v[188:191], a[156:159], a[28:31], v[188:191]
v_mfma_f32_16x16x32_bf16 v[184:187], a[156:159], a[20:23], v[184:187]
ds_read_b64_tr_b16 a[138:139], v236 offset:44992
v_mfma_f32_16x16x32_bf16 v[184:187], a[152:155], a[16:19], v[184:187]
v_mfma_f32_16x16x32_bf16 v[180:183], a[152:155], a[8:11], v[180:183]
ds_read_b64_tr_b16 a[140:141], v236 offset:50368
v_mfma_f32_16x16x32_bf16 v[180:183], a[156:159], a[12:15], v[180:183]
s_waitcnt vmcnt(27)
s_barrier
v_mfma_f32_16x16x32_bf16 v[176:179], a[156:159], a[4:7], v[176:179]
ds_read_b64_tr_b16 a[142:143], v236 offset:52160
s_add_u32 m0, s3, 28672
v_mfma_f32_16x16x32_bf16 v[176:179], a[152:155], a[0:3], v[176:179]
s_waitcnt lgkmcnt(4)
v_mfma_f32_16x16x32_bf16 v[192:195], a[128:131], a[0:3], v[192:195]
ds_read_b64_tr_b16 a[144:145], v236 offset:0
v_mfma_f32_16x16x32_bf16 v[192:195], a[132:135], a[4:7], v[192:195]
buffer_load_dwordx4 v228, s[12:15], s52 offen offset:0  lds
v_mfma_f32_16x16x32_bf16 v[196:199], a[132:135], a[12:15], v[196:199]
ds_read_b64_tr_b16 a[146:147], v236 offset:1792
v_mfma_f32_16x16x32_bf16 v[196:199], a[128:131], a[8:11], v[196:199]
v_mfma_f32_16x16x32_bf16 v[200:203], a[128:131], a[16:19], v[200:203]
ds_read_b64_tr_b16 a[148:149], v236 offset:7168
v_mfma_f32_16x16x32_bf16 v[200:203], a[132:135], a[20:23], v[200:203]
buffer_load_dwordx4 v229, s[12:15], s52 offen offset:1024  lds
v_mfma_f32_16x16x32_bf16 v[204:207], a[132:135], a[28:31], v[204:207]
ds_read_b64_tr_b16 a[150:151], v236 offset:8960
v_mfma_f32_16x16x32_bf16 v[204:207], a[128:131], a[24:27], v[204:207]
s_waitcnt lgkmcnt(4)
v_mfma_f32_16x16x32_bf16 v[220:223], a[136:139], a[24:27], v[220:223]
ds_read_b64_tr_b16 a[152:153], v236 offset:14336
v_mfma_f32_16x16x32_bf16 v[220:223], a[140:143], a[28:31], v[220:223]
v_mfma_f32_16x16x32_bf16 v[216:219], a[140:143], a[20:23], v[216:219]
ds_read_b64_tr_b16 a[154:155], v236 offset:16128
v_mfma_f32_16x16x32_bf16 v[216:219], a[136:139], a[16:19], v[216:219]
buffer_load_dwordx4 v230, s[12:15], s52 offen offset:2048  lds
v_mfma_f32_16x16x32_bf16 v[212:215], a[136:139], a[8:11], v[212:215]
ds_read_b64_tr_b16 a[156:157], v236 offset:21504
v_mfma_f32_16x16x32_bf16 v[212:215], a[140:143], a[12:15], v[212:215]
v_mfma_f32_16x16x32_bf16 v[208:211], a[140:143], a[4:7], v[208:211]
ds_read_b64_tr_b16 a[158:159], v236 offset:23296
v_mfma_f32_16x16x32_bf16 v[208:211], a[136:139], a[0:3], v[208:211]
s_waitcnt vmcnt(20) lgkmcnt(4)
v_mfma_f32_16x16x32_bf16 v[0:3], a[144:147], a[32:35], v[0:3]
ds_read_b64_tr_b16 a[128:129], v236 offset:32
v_mfma_f32_16x16x32_bf16 v[0:3], a[148:151], a[36:39], v[0:3]
s_waitcnt vmcnt(12)
s_barrier
v_mfma_f32_16x16x32_bf16 v[4:7], a[148:151], a[44:47], v[4:7]
ds_read_b64_tr_b16 a[130:131], v236 offset:1824
v_mfma_f32_16x16x32_bf16 v[4:7], a[144:147], a[40:43], v[4:7]
buffer_load_dwordx4 v231, s[12:15], s52 offen offset:3072  lds
v_mfma_f32_16x16x32_bf16 v[8:11], a[144:147], a[48:51], v[8:11]
ds_read_b64_tr_b16 a[132:133], v236 offset:7200
s_add_u32 m0, s3, 32768
v_mfma_f32_16x16x32_bf16 v[8:11], a[148:151], a[52:55], v[8:11]
v_mfma_f32_16x16x32_bf16 v[12:15], a[148:151], a[60:63], v[12:15]
ds_read_b64_tr_b16 a[134:135], v236 offset:8992
v_mfma_f32_16x16x32_bf16 v[12:15], a[144:147], a[56:59], v[12:15]
s_waitcnt lgkmcnt(4)
v_mfma_f32_16x16x32_bf16 v[28:31], a[152:155], a[56:59], v[28:31]
ds_read_b64_tr_b16 a[136:137], v236 offset:14368
v_mfma_f32_16x16x32_bf16 v[28:31], a[156:159], a[60:63], v[28:31]
buffer_load_dwordx4 v232, s[12:15], s52 offen offset:0  lds
v_mfma_f32_16x16x32_bf16 v[24:27], a[156:159], a[52:55], v[24:27]
ds_read_b64_tr_b16 a[138:139], v236 offset:16160
s_add_u32 s53, s33, 5242880
v_mfma_f32_16x16x32_bf16 v[24:27], a[152:155], a[48:51], v[24:27]
s_cmp_eq_u32 s31, 1
s_cselect_b32 s53, s53, 0x40000000
v_mfma_f32_16x16x32_bf16 v[20:23], a[152:155], a[40:43], v[20:23]
ds_read_b64_tr_b16 a[140:141], v236 offset:21536
v_mfma_f32_16x16x32_bf16 v[20:23], a[156:159], a[44:47], v[20:23]
v_mfma_f32_16x16x32_bf16 v[16:19], a[156:159], a[36:39], v[16:19]
ds_read_b64_tr_b16 a[142:143], v236 offset:23328
v_mfma_f32_16x16x32_bf16 v[16:19], a[152:155], a[32:35], v[16:19]
buffer_load_dword v255, v253, s[12:15], s53 offen
s_waitcnt lgkmcnt(4)
v_mfma_f32_16x16x32_bf16 v[32:35], a[128:131], a[32:35], v[32:35]
ds_read_b64_tr_b16 a[144:145], v236 offset:64
v_mfma_f32_16x16x32_bf16 v[32:35], a[132:135], a[36:39], v[32:35]
buffer_load_dwordx4 v233, s[12:15], s52 offen offset:1024  lds
v_mfma_f32_16x16x32_bf16 v[36:39], a[132:135], a[44:47], v[36:39]
ds_read_b64_tr_b16 a[146:147], v236 offset:1856
v_mfma_f32_16x16x32_bf16 v[36:39], a[128:131], a[40:43], v[36:39]
v_mfma_f32_16x16x32_bf16 v[40:43], a[128:131], a[48:51], v[40:43]
ds_read_b64_tr_b16 a[148:149], v236 offset:7232
v_mfma_f32_16x16x32_bf16 v[40:43], a[132:135], a[52:55], v[40:43]
buffer_load_dwordx4 v234, s[12:15], s52 offen offset:2048  lds
v_mfma_f32_16x16x32_bf16 v[44:47], a[132:135], a[60:63], v[44:47]
ds_read_b64_tr_b16 a[150:151], v236 offset:9024
s_add_u32 s52, s52, 458752
v_mfma_f32_16x16x32_bf16 v[44:47], a[128:131], a[56:59], v[44:47]
s_waitcnt lgkmcnt(4)
v_mfma_f32_16x16x32_bf16 v[60:63], a[136:139], a[56:59], v[60:63]
ds_read_b64_tr_b16 a[152:153], v236 offset:14400
v_mfma_f32_16x16x32_bf16 v[60:63], a[140:143], a[60:63], v[60:63]
v_mfma_f32_16x16x32_bf16 v[56:59], a[140:143], a[52:55], v[56:59]
ds_read_b64_tr_b16 a[154:155], v236 offset:16192
v_mfma_f32_16x16x32_bf16 v[56:59], a[136:139], a[48:51], v[56:59]
buffer_load_dwordx4 a[96:99], v224, s[8:11], s28 offen offset:0 sc1
v_mfma_f32_16x16x32_bf16 v[52:55], a[136:139], a[40:43], v[52:55]
ds_read_b64_tr_b16 a[156:157], v236 offset:21568
v_mfma_f32_16x16x32_bf16 v[52:55], a[140:143], a[44:47], v[52:55]
v_mfma_f32_16x16x32_bf16 v[48:51], a[140:143], a[36:39], v[48:51]
ds_read_b64_tr_b16 a[158:159], v236 offset:23360
v_mfma_f32_16x16x32_bf16 v[48:51], a[136:139], a[32:35], v[48:51]
s_waitcnt lgkmcnt(4)
v_mfma_f32_16x16x32_bf16 v[64:67], a[144:147], a[32:35], v[64:67]
ds_read_b64_tr_b16 a[128:129], v236 offset:96
v_mfma_f32_16x16x32_bf16 v[64:67], a[148:151], a[36:39], v[64:67]
v_mfma_f32_16x16x32_bf16 v[68:71], a[148:151], a[44:47], v[68:71]
ds_read_b64_tr_b16 a[130:131], v236 offset:1888
v_mfma_f32_16x16x32_bf16 v[68:71], a[144:147], a[40:43], v[68:71]
buffer_load_dwordx4 a[104:107], v225, s[8:11], s28 offen offset:0 sc1
v_mfma_f32_16x16x32_bf16 v[72:75], a[144:147], a[48:51], v[72:75]
ds_read_b64_tr_b16 a[132:133], v236 offset:7264
v_mfma_f32_16x16x32_bf16 v[72:75], a[148:151], a[52:55], v[72:75]
v_mfma_f32_16x16x32_bf16 v[76:79], a[148:151], a[60:63], v[76:79]
ds_read_b64_tr_b16 a[134:135], v236 offset:9056
v_mfma_f32_16x16x32_bf16 v[76:79], a[144:147], a[56:59], v[76:79]
s_waitcnt lgkmcnt(4)
v_mfma_f32_16x16x32_bf16 v[92:95], a[152:155], a[56:59], v[92:95]
ds_read_b64_tr_b16 a[136:137], v236 offset:14432
v_mfma_f32_16x16x32_bf16 v[92:95], a[156:159], a[60:63], v[92:95]
buffer_load_dwordx4 a[112:115], v226, s[8:11], s28 offen offset:0 sc1
v_mfma_f32_16x16x32_bf16 v[88:91], a[156:159], a[52:55], v[88:91]
ds_read_b64_tr_b16 a[138:139], v236 offset:16224
v_mfma_f32_16x16x32_bf16 v[88:91], a[152:155], a[48:51], v[88:91]
v_mfma_f32_16x16x32_bf16 v[84:87], a[152:155], a[40:43], v[84:87]
ds_read_b64_tr_b16 a[140:141], v236 offset:21600
v_mfma_f32_16x16x32_bf16 v[84:87], a[156:159], a[44:47], v[84:87]
v_mfma_f32_16x16x32_bf16 v[80:83], a[156:159], a[36:39], v[80:83]
ds_read_b64_tr_b16 a[142:143], v236 offset:23392
v_mfma_f32_16x16x32_bf16 v[80:83], a[152:155], a[32:35], v[80:83]
s_waitcnt lgkmcnt(4)
v_mfma_f32_16x16x32_bf16 v[96:99], a[128:131], a[32:35], v[96:99]
ds_read_b64_tr_b16 a[144:145], v236 offset:128
v_mfma_f32_16x16x32_bf16 v[96:99], a[132:135], a[36:39], v[96:99]
buffer_load_dwordx4 a[120:123], v227, s[8:11], s28 offen offset:0 sc1
v_mfma_f32_16x16x32_bf16 v[100:103], a[132:135], a[44:47], v[100:103]
ds_read_b64_tr_b16 a[146:147], v236 offset:1920
v_mfma_f32_16x16x32_bf16 v[100:103], a[128:131], a[40:43], v[100:103]
v_mfma_f32_16x16x32_bf16 v[104:107], a[128:131], a[48:51], v[104:107]
ds_read_b64_tr_b16 a[148:149], v236 offset:7296
v_mfma_f32_16x16x32_bf16 v[104:107], a[132:135], a[52:55], v[104:107]
v_mfma_f32_16x16x32_bf16 v[108:111], a[132:135], a[60:63], v[108:111]
ds_read_b64_tr_b16 a[150:151], v236 offset:9088
v_mfma_f32_16x16x32_bf16 v[108:111], a[128:131], a[56:59], v[108:111]
s_waitcnt lgkmcnt(4)
v_mfma_f32_16x16x32_bf16 v[124:127], a[136:139], a[56:59], v[124:127]
ds_read_b64_tr_b16 a[152:153], v236 offset:14464
v_mfma_f32_16x16x32_bf16 v[124:127], a[140:143], a[60:63], v[124:127]
buffer_load_dwordx4 a[100:103], v224, s[8:11], s28 offen offset:1024 sc1
v_mfma_f32_16x16x32_bf16 v[120:123], a[140:143], a[52:55], v[120:123]
ds_read_b64_tr_b16 a[154:155], v236 offset:16256
v_mfma_f32_16x16x32_bf16 v[120:123], a[136:139], a[48:51], v[120:123]
v_mfma_f32_16x16x32_bf16 v[116:119], a[136:139], a[40:43], v[116:119]
ds_read_b64_tr_b16 a[156:157], v236 offset:21632
v_mfma_f32_16x16x32_bf16 v[116:119], a[140:143], a[44:47], v[116:119]
buffer_load_dwordx4 a[108:111], v225, s[8:11], s28 offen offset:1024 sc1
v_mfma_f32_16x16x32_bf16 v[112:115], a[140:143], a[36:39], v[112:115]
ds_read_b64_tr_b16 a[158:159], v236 offset:23424
v_mfma_f32_16x16x32_bf16 v[112:115], a[136:139], a[32:35], v[112:115]
s_waitcnt lgkmcnt(4)
v_mfma_f32_16x16x32_bf16 v[128:131], a[144:147], a[32:35], v[128:131]
ds_read_b64_tr_b16 a[128:129], v236 offset:160
v_mfma_f32_16x16x32_bf16 v[128:131], a[148:151], a[36:39], v[128:131]
v_mfma_f32_16x16x32_bf16 v[132:135], a[148:151], a[44:47], v[132:135]
ds_read_b64_tr_b16 a[130:131], v236 offset:1952
v_mfma_f32_16x16x32_bf16 v[132:135], a[144:147], a[40:43], v[132:135]
buffer_load_dwordx4 a[116:119], v226, s[8:11], s28 offen offset:1024 sc1
v_mfma_f32_16x16x32_bf16 v[136:139], a[144:147], a[48:51], v[136:139]
ds_read_b64_tr_b16 a[132:133], v236 offset:7328
v_mfma_f32_16x16x32_bf16 v[136:139], a[148:151], a[52:55], v[136:139]
v_mfma_f32_16x16x32_bf16 v[140:143], a[148:151], a[60:63], v[140:143]
ds_read_b64_tr_b16 a[134:135], v236 offset:9120
v_mfma_f32_16x16x32_bf16 v[140:143], a[144:147], a[56:59], v[140:143]
s_waitcnt lgkmcnt(4)
v_mfma_f32_16x16x32_bf16 v[156:159], a[152:155], a[56:59], v[156:159]
ds_read_b64_tr_b16 a[136:137], v236 offset:14496
v_mfma_f32_16x16x32_bf16 v[156:159], a[156:159], a[60:63], v[156:159]
buffer_load_dwordx4 a[124:127], v227, s[8:11], s28 offen offset:1024 sc1
v_mfma_f32_16x16x32_bf16 v[152:155], a[156:159], a[52:55], v[152:155]
ds_read_b64_tr_b16 a[138:139], v236 offset:16288
s_add_u32 s28, s28, 2048
v_mfma_f32_16x16x32_bf16 v[152:155], a[152:155], a[48:51], v[152:155]
v_mfma_f32_16x16x32_bf16 v[148:151], a[152:155], a[40:43], v[148:151]
ds_read_b64_tr_b16 a[140:141], v236 offset:21664
v_mfma_f32_16x16x32_bf16 v[148:151], a[156:159], a[44:47], v[148:151]
v_mfma_f32_16x16x32_bf16 v[144:147], a[156:159], a[36:39], v[144:147]
ds_read_b64_tr_b16 a[142:143], v236 offset:23456
v_mfma_f32_16x16x32_bf16 v[144:147], a[152:155], a[32:35], v[144:147]
s_waitcnt lgkmcnt(4)
v_mfma_f32_16x16x32_bf16 v[160:163], a[128:131], a[32:35], v[160:163]
ds_read_b64_tr_b16 a[144:145], v236 offset:192
s_add_u32 m0, s3, 86016
v_mfma_f32_16x16x32_bf16 v[160:163], a[132:135], a[36:39], v[160:163]
buffer_load_dwordx4 v228, s[12:15], s52 offen offset:0  lds
v_mfma_f32_16x16x32_bf16 v[164:167], a[132:135], a[44:47], v[164:167]
ds_read_b64_tr_b16 a[146:147], v236 offset:1984
v_mfma_f32_16x16x32_bf16 v[164:167], a[128:131], a[40:43], v[164:167]
s_add_u32 s53, s33, 6291456
v_mfma_f32_16x16x32_bf16 v[168:171], a[128:131], a[48:51], v[168:171]
ds_read_b64_tr_b16 a[148:149], v236 offset:7360
s_cmp_eq_u32 s31, 0
s_cselect_b32 s53, s53, 0x40000000
v_mfma_f32_16x16x32_bf16 v[168:171], a[132:135], a[52:55], v[168:171]
v_mfma_f32_16x16x32_bf16 v[172:175], a[132:135], a[60:63], v[172:175]
ds_read_b64_tr_b16 a[150:151], v236 offset:9152
v_mfma_f32_16x16x32_bf16 v[172:175], a[128:131], a[56:59], v[172:175]
s_waitcnt lgkmcnt(4)
v_mfma_f32_16x16x32_bf16 v[188:191], a[136:139], a[56:59], v[188:191]
ds_read_b64_tr_b16 a[152:153], v236 offset:14528
v_mfma_f32_16x16x32_bf16 v[188:191], a[140:143], a[60:63], v[188:191]
buffer_load_dwordx4 v229, s[12:15], s52 offen offset:1024  lds
v_mfma_f32_16x16x32_bf16 v[184:187], a[140:143], a[52:55], v[184:187]
ds_read_b64_tr_b16 a[154:155], v236 offset:16320
v_mfma_f32_16x16x32_bf16 v[184:187], a[136:139], a[48:51], v[184:187]
buffer_load_dword v255, v253, s[12:15], s53 offen
v_mfma_f32_16x16x32_bf16 v[180:183], a[136:139], a[40:43], v[180:183]
ds_read_b64_tr_b16 a[156:157], v236 offset:21696
v_mfma_f32_16x16x32_bf16 v[180:183], a[140:143], a[44:47], v[180:183]
buffer_load_dwordx4 v230, s[12:15], s52 offen offset:2048  lds
v_mfma_f32_16x16x32_bf16 v[176:179], a[140:143], a[36:39], v[176:179]
ds_read_b64_tr_b16 a[158:159], v236 offset:23488
v_mfma_f32_16x16x32_bf16 v[176:179], a[136:139], a[32:35], v[176:179]
s_waitcnt lgkmcnt(4)
v_mfma_f32_16x16x32_bf16 v[192:195], a[144:147], a[32:35], v[192:195]
ds_read_b64_tr_b16 a[128:129], v235 offset:0
v_mfma_f32_16x16x32_bf16 v[192:195], a[148:151], a[36:39], v[192:195]
v_mfma_f32_16x16x32_bf16 v[196:199], a[148:151], a[44:47], v[196:199]
ds_read_b64_tr_b16 a[130:131], v235 offset:1792
v_mfma_f32_16x16x32_bf16 v[196:199], a[144:147], a[40:43], v[196:199]
buffer_load_dwordx4 v231, s[12:15], s52 offen offset:3072  lds
v_mfma_f32_16x16x32_bf16 v[200:203], a[144:147], a[48:51], v[200:203]
ds_read_b64_tr_b16 a[132:133], v235 offset:7168
s_add_u32 m0, s3, 90112
v_mfma_f32_16x16x32_bf16 v[200:203], a[148:151], a[52:55], v[200:203]
v_mfma_f32_16x16x32_bf16 v[204:207], a[148:151], a[60:63], v[204:207]
ds_read_b64_tr_b16 a[134:135], v235 offset:8960
v_mfma_f32_16x16x32_bf16 v[204:207], a[144:147], a[56:59], v[204:207]
s_waitcnt lgkmcnt(4)
v_mfma_f32_16x16x32_bf16 v[220:223], a[152:155], a[56:59], v[220:223]
ds_read_b64_tr_b16 a[136:137], v235 offset:14336
v_mfma_f32_16x16x32_bf16 v[220:223], a[156:159], a[60:63], v[220:223]
v_mfma_f32_16x16x32_bf16 v[216:219], a[156:159], a[52:55], v[216:219]
ds_read_b64_tr_b16 a[138:139], v235 offset:16128
v_mfma_f32_16x16x32_bf16 v[216:219], a[152:155], a[48:51], v[216:219]
buffer_load_dwordx4 v232, s[12:15], s52 offen offset:0  lds
v_mfma_f32_16x16x32_bf16 v[212:215], a[152:155], a[40:43], v[212:215]
ds_read_b64_tr_b16 a[140:141], v235 offset:21504
v_mfma_f32_16x16x32_bf16 v[212:215], a[156:159], a[44:47], v[212:215]
v_mfma_f32_16x16x32_bf16 v[208:211], a[156:159], a[36:39], v[208:211]
ds_read_b64_tr_b16 a[142:143], v235 offset:23296
v_mfma_f32_16x16x32_bf16 v[208:211], a[152:155], a[32:35], v[208:211]
s_waitcnt vmcnt(22) lgkmcnt(4)
v_mfma_f32_16x16x32_bf16 v[0:3], a[128:131], a[64:67], v[0:3]
ds_read_b64_tr_b16 a[144:145], v235 offset:32
v_mfma_f32_16x16x32_bf16 v[0:3], a[132:135], a[68:71], v[0:3]
s_waitcnt vmcnt(14)
s_barrier
v_mfma_f32_16x16x32_bf16 v[4:7], a[132:135], a[76:79], v[4:7]
ds_read_b64_tr_b16 a[146:147], v235 offset:1824
v_mfma_f32_16x16x32_bf16 v[4:7], a[128:131], a[72:75], v[4:7]
buffer_load_dwordx4 v233, s[12:15], s52 offen offset:1024  lds
v_mfma_f32_16x16x32_bf16 v[8:11], a[128:131], a[80:83], v[8:11]
ds_read_b64_tr_b16 a[148:149], v235 offset:7200
v_mfma_f32_16x16x32_bf16 v[8:11], a[132:135], a[84:87], v[8:11]
v_mfma_f32_16x16x32_bf16 v[12:15], a[132:135], a[92:95], v[12:15]
ds_read_b64_tr_b16 a[150:151], v235 offset:8992
v_mfma_f32_16x16x32_bf16 v[12:15], a[128:131], a[88:91], v[12:15]
s_waitcnt lgkmcnt(4)
v_mfma_f32_16x16x32_bf16 v[28:31], a[136:139], a[88:91], v[28:31]
ds_read_b64_tr_b16 a[152:153], v235 offset:14368
v_mfma_f32_16x16x32_bf16 v[28:31], a[140:143], a[92:95], v[28:31]
buffer_load_dwordx4 v234, s[12:15], s52 offen offset:2048  lds
v_mfma_f32_16x16x32_bf16 v[24:27], a[140:143], a[84:87], v[24:27]
ds_read_b64_tr_b16 a[154:155], v235 offset:16160
s_add_u32 s52, s52, 458752
v_mfma_f32_16x16x32_bf16 v[24:27], a[136:139], a[80:83], v[24:27]
v_mfma_f32_16x16x32_bf16 v[20:23], a[136:139], a[72:75], v[20:23]
ds_read_b64_tr_b16 a[156:157], v235 offset:21536
v_mfma_f32_16x16x32_bf16 v[20:23], a[140:143], a[76:79], v[20:23]
v_mfma_f32_16x16x32_bf16 v[16:19], a[140:143], a[68:71], v[16:19]
ds_read_b64_tr_b16 a[158:159], v235 offset:23328
v_mfma_f32_16x16x32_bf16 v[16:19], a[136:139], a[64:67], v[16:19]
s_waitcnt lgkmcnt(4)
v_mfma_f32_16x16x32_bf16 v[32:35], a[144:147], a[64:67], v[32:35]
ds_read_b64_tr_b16 a[128:129], v235 offset:64
v_mfma_f32_16x16x32_bf16 v[32:35], a[148:151], a[68:71], v[32:35]
buffer_load_dwordx4 a[0:3], v224, s[8:11], s28 offen offset:0 sc1
v_mfma_f32_16x16x32_bf16 v[36:39], a[148:151], a[76:79], v[36:39]
ds_read_b64_tr_b16 a[130:131], v235 offset:1856
v_mfma_f32_16x16x32_bf16 v[36:39], a[144:147], a[72:75], v[36:39]
v_mfma_f32_16x16x32_bf16 v[40:43], a[144:147], a[80:83], v[40:43]
ds_read_b64_tr_b16 a[132:133], v235 offset:7232
v_mfma_f32_16x16x32_bf16 v[40:43], a[148:151], a[84:87], v[40:43]
buffer_load_dwordx4 a[8:11], v225, s[8:11], s28 offen offset:0 sc1
v_mfma_f32_16x16x32_bf16 v[44:47], a[148:151], a[92:95], v[44:47]
ds_read_b64_tr_b16 a[134:135], v235 offset:9024
v_mfma_f32_16x16x32_bf16 v[44:47], a[144:147], a[88:91], v[44:47]
s_waitcnt lgkmcnt(4)
v_mfma_f32_16x16x32_bf16 v[60:63], a[152:155], a[88:91], v[60:63]
ds_read_b64_tr_b16 a[136:137], v235 offset:14400
v_mfma_f32_16x16x32_bf16 v[60:63], a[156:159], a[92:95], v[60:63]
v_mfma_f32_16x16x32_bf16 v[56:59], a[156:159], a[84:87], v[56:59]
ds_read_b64_tr_b16 a[138:139], v235 offset:16192
v_mfma_f32_16x16x32_bf16 v[56:59], a[152:155], a[80:83], v[56:59]
buffer_load_dwordx4 a[16:19], v226, s[8:11], s28 offen offset:0 sc1
v_mfma_f32_16x16x32_bf16 v[52:55], a[152:155], a[72:75], v[52:55]
ds_read_b64_tr_b16 a[140:141], v235 offset:21568
v_mfma_f32_16x16x32_bf16 v[52:55], a[156:159], a[76:79], v[52:55]
v_mfma_f32_16x16x32_bf16 v[48:51], a[156:159], a[68:71], v[48:51]
ds_read_b64_tr_b16 a[142:143], v235 offset:23360
v_mfma_f32_16x16x32_bf16 v[48:51], a[152:155], a[64:67], v[48:51]
s_add_u32 s53, s33, 6291456
s_waitcnt lgkmcnt(4)
v_mfma_f32_16x16x32_bf16 v[64:67], a[128:131], a[64:67], v[64:67]
ds_read_b64_tr_b16 a[144:145], v235 offset:96
s_cmp_eq_u32 s31, 1
s_cselect_b32 s53, s53, 0x40000000
v_mfma_f32_16x16x32_bf16 v[64:67], a[132:135], a[68:71], v[64:67]
buffer_load_dwordx4 a[24:27], v227, s[8:11], s28 offen offset:0 sc1
v_mfma_f32_16x16x32_bf16 v[68:71], a[132:135], a[76:79], v[68:71]
ds_read_b64_tr_b16 a[146:147], v235 offset:1888
v_mfma_f32_16x16x32_bf16 v[68:71], a[128:131], a[72:75], v[68:71]
v_mfma_f32_16x16x32_bf16 v[72:75], a[128:131], a[80:83], v[72:75]
ds_read_b64_tr_b16 a[148:149], v235 offset:7264
v_mfma_f32_16x16x32_bf16 v[72:75], a[132:135], a[84:87], v[72:75]
buffer_load_dword v255, v253, s[12:15], s53 offen
v_mfma_f32_16x16x32_bf16 v[76:79], a[132:135], a[92:95], v[76:79]
ds_read_b64_tr_b16 a[150:151], v235 offset:9056
v_mfma_f32_16x16x32_bf16 v[76:79], a[128:131], a[88:91], v[76:79]
s_waitcnt lgkmcnt(4)
v_mfma_f32_16x16x32_bf16 v[92:95], a[136:139], a[88:91], v[92:95]
ds_read_b64_tr_b16 a[152:153], v235 offset:14432
v_mfma_f32_16x16x32_bf16 v[92:95], a[140:143], a[92:95], v[92:95]
buffer_load_dwordx4 a[4:7], v224, s[8:11], s28 offen offset:1024 sc1
v_mfma_f32_16x16x32_bf16 v[88:91], a[140:143], a[84:87], v[88:91]
ds_read_b64_tr_b16 a[154:155], v235 offset:16224
v_mfma_f32_16x16x32_bf16 v[88:91], a[136:139], a[80:83], v[88:91]
v_mfma_f32_16x16x32_bf16 v[84:87], a[136:139], a[72:75], v[84:87]
ds_read_b64_tr_b16 a[156:157], v235 offset:21600
v_mfma_f32_16x16x32_bf16 v[84:87], a[140:143], a[76:79], v[84:87]
v_mfma_f32_16x16x32_bf16 v[80:83], a[140:143], a[68:71], v[80:83]
ds_read_b64_tr_b16 a[158:159], v235 offset:23392
v_mfma_f32_16x16x32_bf16 v[80:83], a[136:139], a[64:67], v[80:83]
s_waitcnt lgkmcnt(4)
v_mfma_f32_16x16x32_bf16 v[96:99], a[144:147], a[64:67], v[96:99]
ds_read_b64_tr_b16 a[128:129], v235 offset:128
v_mfma_f32_16x16x32_bf16 v[96:99], a[148:151], a[68:71], v[96:99]
buffer_load_dwordx4 a[12:15], v225, s[8:11], s28 offen offset:1024 sc1
v_mfma_f32_16x16x32_bf16 v[100:103], a[148:151], a[76:79], v[100:103]
ds_read_b64_tr_b16 a[130:131], v235 offset:1920
v_mfma_f32_16x16x32_bf16 v[100:103], a[144:147], a[72:75], v[100:103]
v_mfma_f32_16x16x32_bf16 v[104:107], a[144:147], a[80:83], v[104:107]
ds_read_b64_tr_b16 a[132:133], v235 offset:7296
v_mfma_f32_16x16x32_bf16 v[104:107], a[148:151], a[84:87], v[104:107]
buffer_load_dwordx4 a[20:23], v226, s[8:11], s28 offen offset:1024 sc1
v_mfma_f32_16x16x32_bf16 v[108:111], a[148:151], a[92:95], v[108:111]
ds_read_b64_tr_b16 a[134:135], v235 offset:9088
v_mfma_f32_16x16x32_bf16 v[108:111], a[144:147], a[88:91], v[108:111]
s_waitcnt lgkmcnt(4)
v_mfma_f32_16x16x32_bf16 v[124:127], a[152:155], a[88:91], v[124:127]
ds_read_b64_tr_b16 a[136:137], v235 offset:14464
v_mfma_f32_16x16x32_bf16 v[124:127], a[156:159], a[92:95], v[124:127]
v_mfma_f32_16x16x32_bf16 v[120:123], a[156:159], a[84:87], v[120:123]
ds_read_b64_tr_b16 a[138:139], v235 offset:16256
v_mfma_f32_16x16x32_bf16 v[120:123], a[152:155], a[80:83], v[120:123]
buffer_load_dwordx4 a[28:31], v227, s[8:11], s28 offen offset:1024 sc1
v_mfma_f32_16x16x32_bf16 v[116:119], a[152:155], a[72:75], v[116:119]
ds_read_b64_tr_b16 a[140:141], v235 offset:21632
s_add_u32 s28, s28, 2048
v_mfma_f32_16x16x32_bf16 v[116:119], a[156:159], a[76:79], v[116:119]
v_mfma_f32_16x16x32_bf16 v[112:115], a[156:159], a[68:71], v[112:115]
ds_read_b64_tr_b16 a[142:143], v235 offset:23424
v_mfma_f32_16x16x32_bf16 v[112:115], a[152:155], a[64:67], v[112:115]
s_waitcnt lgkmcnt(4)
v_mfma_f32_16x16x32_bf16 v[128:131], a[128:131], a[64:67], v[128:131]
ds_read_b64_tr_b16 a[144:145], v235 offset:160
v_mfma_f32_16x16x32_bf16 v[128:131], a[132:135], a[68:71], v[128:131]
v_mfma_f32_16x16x32_bf16 v[132:135], a[132:135], a[76:79], v[132:135]
ds_read_b64_tr_b16 a[146:147], v235 offset:1952
s_add_u32 m0, s3, 57344
v_mfma_f32_16x16x32_bf16 v[132:135], a[128:131], a[72:75], v[132:135]
buffer_load_dwordx4 v228, s[12:15], s52 offen offset:0  lds
v_mfma_f32_16x16x32_bf16 v[136:139], a[128:131], a[80:83], v[136:139]
ds_read_b64_tr_b16 a[148:149], v235 offset:7328
v_mfma_f32_16x16x32_bf16 v[136:139], a[132:135], a[84:87], v[136:139]
v_mfma_f32_16x16x32_bf16 v[140:143], a[132:135], a[92:95], v[140:143]
ds_read_b64_tr_b16 a[150:151], v235 offset:9120
v_mfma_f32_16x16x32_bf16 v[140:143], a[128:131], a[88:91], v[140:143]
s_waitcnt lgkmcnt(4)
v_mfma_f32_16x16x32_bf16 v[156:159], a[136:139], a[88:91], v[156:159]
ds_read_b64_tr_b16 a[152:153], v235 offset:14496
v_mfma_f32_16x16x32_bf16 v[156:159], a[140:143], a[92:95], v[156:159]
buffer_load_dwordx4 v229, s[12:15], s52 offen offset:1024  lds
v_mfma_f32_16x16x32_bf16 v[152:155], a[140:143], a[84:87], v[152:155]
ds_read_b64_tr_b16 a[154:155], v235 offset:16288
v_mfma_f32_16x16x32_bf16 v[152:155], a[136:139], a[80:83], v[152:155]
v_mfma_f32_16x16x32_bf16 v[148:151], a[136:139], a[72:75], v[148:151]
ds_read_b64_tr_b16 a[156:157], v235 offset:21664
v_mfma_f32_16x16x32_bf16 v[148:151], a[140:143], a[76:79], v[148:151]
v_mfma_f32_16x16x32_bf16 v[144:147], a[140:143], a[68:71], v[144:147]
ds_read_b64_tr_b16 a[158:159], v235 offset:23456
v_mfma_f32_16x16x32_bf16 v[144:147], a[136:139], a[64:67], v[144:147]
s_waitcnt lgkmcnt(4)
v_mfma_f32_16x16x32_bf16 v[160:163], a[144:147], a[64:67], v[160:163]
ds_read_b64_tr_b16 a[128:129], v235 offset:192
v_mfma_f32_16x16x32_bf16 v[160:163], a[148:151], a[68:71], v[160:163]
buffer_load_dwordx4 v230, s[12:15], s52 offen offset:2048  lds
v_mfma_f32_16x16x32_bf16 v[164:167], a[148:151], a[76:79], v[164:167]
ds_read_b64_tr_b16 a[130:131], v235 offset:1984
v_mfma_f32_16x16x32_bf16 v[164:167], a[144:147], a[72:75], v[164:167]
v_mfma_f32_16x16x32_bf16 v[168:171], a[144:147], a[80:83], v[168:171]
ds_read_b64_tr_b16 a[132:133], v235 offset:7360
v_mfma_f32_16x16x32_bf16 v[168:171], a[148:151], a[84:87], v[168:171]
v_mfma_f32_16x16x32_bf16 v[172:175], a[148:151], a[92:95], v[172:175]
ds_read_b64_tr_b16 a[134:135], v235 offset:9152
v_mfma_f32_16x16x32_bf16 v[172:175], a[144:147], a[88:91], v[172:175]
s_waitcnt lgkmcnt(4)
v_mfma_f32_16x16x32_bf16 v[188:191], a[152:155], a[88:91], v[188:191]
ds_read_b64_tr_b16 a[136:137], v235 offset:14528
v_mfma_f32_16x16x32_bf16 v[188:191], a[156:159], a[92:95], v[188:191]
buffer_load_dwordx4 v231, s[12:15], s52 offen offset:3072  lds
v_mfma_f32_16x16x32_bf16 v[184:187], a[156:159], a[84:87], v[184:187]
ds_read_b64_tr_b16 a[138:139], v235 offset:16320
s_add_u32 m0, s3, 61440
v_mfma_f32_16x16x32_bf16 v[184:187], a[152:155], a[80:83], v[184:187]
v_mfma_f32_16x16x32_bf16 v[180:183], a[152:155], a[72:75], v[180:183]
ds_read_b64_tr_b16 a[140:141], v235 offset:21696
v_mfma_f32_16x16x32_bf16 v[180:183], a[156:159], a[76:79], v[180:183]
buffer_load_dwordx4 v232, s[12:15], s52 offen offset:0  lds
v_mfma_f32_16x16x32_bf16 v[176:179], a[156:159], a[68:71], v[176:179]
ds_read_b64_tr_b16 a[142:143], v235 offset:23488
v_mfma_f32_16x16x32_bf16 v[176:179], a[152:155], a[64:67], v[176:179]
s_waitcnt lgkmcnt(4)
v_mfma_f32_16x16x32_bf16 v[192:195], a[128:131], a[64:67], v[192:195]
ds_read_b64_tr_b16 a[144:145], v235 offset:28672
v_mfma_f32_16x16x32_bf16 v[192:195], a[132:135], a[68:71], v[192:195]
v_mfma_f32_16x16x32_bf16 v[196:199], a[132:135], a[76:79], v[196:199]
ds_read_b64_tr_b16 a[146:147], v235 offset:30464
v_mfma_f32_16x16x32_bf16 v[196:199], a[128:131], a[72:75], v[196:199]
buffer_load_dwordx4 v233, s[12:15], s52 offen offset:1024  lds
v_mfma_f32_16x16x32_bf16 v[200:203], a[128:131], a[80:83], v[200:203]
ds_read_b64_tr_b16 a[148:149], v235 offset:35840
v_mfma_f32_16x16x32_bf16 v[200:203], a[132:135], a[84:87], v[200:203]
v_mfma_f32_16x16x32_bf16 v[204:207], a[132:135], a[92:95], v[204:207]
ds_read_b64_tr_b16 a[150:151], v235 offset:37632
v_mfma_f32_16x16x32_bf16 v[204:207], a[128:131], a[88:91], v[204:207]
s_waitcnt lgkmcnt(4)
v_mfma_f32_16x16x32_bf16 v[220:223], a[136:139], a[88:91], v[220:223]
ds_read_b64_tr_b16 a[152:153], v235 offset:43008
v_mfma_f32_16x16x32_bf16 v[220:223], a[140:143], a[92:95], v[220:223]
buffer_load_dwordx4 v234, s[12:15], s52 offen offset:2048  lds
v_mfma_f32_16x16x32_bf16 v[216:219], a[140:143], a[84:87], v[216:219]
ds_read_b64_tr_b16 a[154:155], v235 offset:44800
s_add_u32 s52, s52, 458752
v_mfma_f32_16x16x32_bf16 v[216:219], a[136:139], a[80:83], v[216:219]
s_add_u32 s53, s98, 0
v_mfma_f32_16x16x32_bf16 v[212:215], a[136:139], a[72:75], v[212:215]
ds_read_b64_tr_b16 a[156:157], v235 offset:50176
s_cmp_eq_u32 s31, 0
s_cselect_b32 s53, s53, 0x40000000
v_mfma_f32_16x16x32_bf16 v[212:215], a[140:143], a[76:79], v[212:215]
v_mfma_f32_16x16x32_bf16 v[208:211], a[140:143], a[68:71], v[208:211]
ds_read_b64_tr_b16 a[158:159], v235 offset:51968
v_mfma_f32_16x16x32_bf16 v[208:211], a[136:139], a[64:67], v[208:211]
s_waitcnt vmcnt(24) lgkmcnt(4)
v_mfma_f32_16x16x32_bf16 v[0:3], a[144:147], a[96:99], v[0:3]
ds_read_b64_tr_b16 a[128:129], v235 offset:28704
buffer_load_dword v255, v253, s[20:23], s53 offen
v_mfma_f32_16x16x32_bf16 v[0:3], a[148:151], a[100:103], v[0:3]
s_waitcnt vmcnt(17)
s_barrier
v_mfma_f32_16x16x32_bf16 v[4:7], a[148:151], a[108:111], v[4:7]
ds_read_b64_tr_b16 a[130:131], v235 offset:30496
v_mfma_f32_16x16x32_bf16 v[4:7], a[144:147], a[104:107], v[4:7]
buffer_load_dwordx4 a[32:35], v224, s[8:11], s28 offen offset:0 sc1
v_mfma_f32_16x16x32_bf16 v[8:11], a[144:147], a[112:115], v[8:11]
ds_read_b64_tr_b16 a[132:133], v235 offset:35872
v_mfma_f32_16x16x32_bf16 v[8:11], a[148:151], a[116:119], v[8:11]
v_mfma_f32_16x16x32_bf16 v[12:15], a[148:151], a[124:127], v[12:15]
ds_read_b64_tr_b16 a[134:135], v235 offset:37664
v_mfma_f32_16x16x32_bf16 v[12:15], a[144:147], a[120:123], v[12:15]
s_waitcnt lgkmcnt(4)
v_mfma_f32_16x16x32_bf16 v[28:31], a[152:155], a[120:123], v[28:31]
ds_read_b64_tr_b16 a[136:137], v235 offset:43040
v_mfma_f32_16x16x32_bf16 v[28:31], a[156:159], a[124:127], v[28:31]
buffer_load_dwordx4 a[40:43], v225, s[8:11], s28 offen offset:0 sc1
v_mfma_f32_16x16x32_bf16 v[24:27], a[156:159], a[116:119], v[24:27]
ds_read_b64_tr_b16 a[138:139], v235 offset:44832
v_mfma_f32_16x16x32_bf16 v[24:27], a[152:155], a[112:115], v[24:27]
v_mfma_f32_16x16x32_bf16 v[20:23], a[152:155], a[104:107], v[20:23]
ds_read_b64_tr_b16 a[140:141], v235 offset:50208
v_mfma_f32_16x16x32_bf16 v[20:23], a[156:159], a[108:111], v[20:23]
buffer_load_dwordx4 a[48:51], v226, s[8:11], s28 offen offset:0 sc1
v_mfma_f32_16x16x32_bf16 v[16:19], a[156:159], a[100:103], v[16:19]
ds_read_b64_tr_b16 a[142:143], v235 offset:52000
v_mfma_f32_16x16x32_bf16 v[16:19], a[152:155], a[96:99], v[16:19]
s_waitcnt lgkmcnt(4)
v_mfma_f32_16x16x32_bf16 v[32:35], a[128:131], a[96:99], v[32:35]
ds_read_b64_tr_b16 a[144:145], v235 offset:28736
v_mfma_f32_16x16x32_bf16 v[32:35], a[132:135], a[100:103], v[32:35]
v_mfma_f32_16x16x32_bf16 v[36:39], a[132:135], a[108:111], v[36:39]
ds_read_b64_tr_b16 a[146:147], v235 offset:30528
v_mfma_f32_16x16x32_bf16 v[36:39], a[128:131], a[104:107], v[36:39]
buffer_load_dwordx4 a[56:59], v227, s[8:11], s28 offen offset:0 sc1
v_mfma_f32_16x16x32_bf16 v[40:43], a[128:131], a[112:115], v[40:43]
ds_read_b64_tr_b16 a[148:149], v235 offset:35904
v_mfma_f32_16x16x32_bf16 v[40:43], a[132:135], a[116:119], v[40:43]
v_mfma_f32_16x16x32_bf16 v[44:47], a[132:135], a[124:127], v[44:47]
ds_read_b64_tr_b16 a[150:151], v235 offset:37696
v_mfma_f32_16x16x32_bf16 v[44:47], a[128:131], a[120:123], v[44:47]
s_waitcnt lgkmcnt(4)
v_mfma_f32_16x16x32_bf16 v[60:63], a[136:139], a[120:123], v[60:63]
ds_read_b64_tr_b16 a[152:153], v235 offset:43072
v_mfma_f32_16x16x32_bf16 v[60:63], a[140:143], a[124:127], v[60:63]
v_mfma_f32_16x16x32_bf16 v[56:59], a[140:143], a[116:119], v[56:59]
ds_read_b64_tr_b16 a[154:155], v235 offset:44864
v_mfma_f32_16x16x32_bf16 v[56:59], a[136:139], a[112:115], v[56:59]
buffer_load_dwordx4 a[36:39], v224, s[8:11], s28 offen offset:1024 sc1
v_mfma_f32_16x16x32_bf16 v[52:55], a[136:139], a[104:107], v[52:55]
ds_read_b64_tr_b16 a[156:157], v235 offset:50240
v_mfma_f32_16x16x32_bf16 v[52:55], a[140:143], a[108:111], v[52:55]
v_mfma_f32_16x16x32_bf16 v[48:51], a[140:143], a[100:103], v[48:51]
ds_read_b64_tr_b16 a[158:159], v235 offset:52032
v_mfma_f32_16x16x32_bf16 v[48:51], a[136:139], a[96:99], v[48:51]
s_waitcnt lgkmcnt(4)
v_mfma_f32_16x16x32_bf16 v[64:67], a[144:147], a[96:99], v[64:67]
ds_read_b64_tr_b16 a[128:129], v235 offset:28768
v_mfma_f32_16x16x32_bf16 v[64:67], a[148:151], a[100:103], v[64:67]
buffer_load_dwordx4 a[44:47], v225, s[8:11], s28 offen offset:1024 sc1
v_mfma_f32_16x16x32_bf16 v[68:71], a[148:151], a[108:111], v[68:71]
ds_read_b64_tr_b16 a[130:131], v235 offset:30560
v_mfma_f32_16x16x32_bf16 v[68:71], a[144:147], a[104:107], v[68:71]
v_mfma_f32_16x16x32_bf16 v[72:75], a[144:147], a[112:115], v[72:75]
ds_read_b64_tr_b16 a[132:133], v235 offset:35936
v_mfma_f32_16x16x32_bf16 v[72:75], a[148:151], a[116:119], v[72:75]
v_mfma_f32_16x16x32_bf16 v[76:79], a[148:151], a[124:127], v[76:79]
ds_read_b64_tr_b16 a[134:135], v235 offset:37728
v_mfma_f32_16x16x32_bf16 v[76:79], a[144:147], a[120:123], v[76:79]
s_waitcnt lgkmcnt(4)
v_mfma_f32_16x16x32_bf16 v[92:95], a[152:155], a[120:123], v[92:95]
ds_read_b64_tr_b16 a[136:137], v235 offset:43104
v_mfma_f32_16x16x32_bf16 v[92:95], a[156:159], a[124:127], v[92:95]
buffer_load_dwordx4 a[52:55], v226, s[8:11], s28 offen offset:1024 sc1
v_mfma_f32_16x16x32_bf16 v[88:91], a[156:159], a[116:119], v[88:91]
ds_read_b64_tr_b16 a[138:139], v235 offset:44896
v_mfma_f32_16x16x32_bf16 v[88:91], a[152:155], a[112:115], v[88:91]
v_mfma_f32_16x16x32_bf16 v[84:87], a[152:155], a[104:107], v[84:87]
ds_read_b64_tr_b16 a[140:141], v235 offset:50272
v_mfma_f32_16x16x32_bf16 v[84:87], a[156:159], a[108:111], v[84:87]
v_mfma_f32_16x16x32_bf16 v[80:83], a[156:159], a[100:103], v[80:83]
ds_read_b64_tr_b16 a[142:143], v235 offset:52064
v_mfma_f32_16x16x32_bf16 v[80:83], a[152:155], a[96:99], v[80:83]
s_waitcnt lgkmcnt(4)
v_mfma_f32_16x16x32_bf16 v[96:99], a[128:131], a[96:99], v[96:99]
ds_read_b64_tr_b16 a[144:145], v235 offset:28800
v_mfma_f32_16x16x32_bf16 v[96:99], a[132:135], a[100:103], v[96:99]
buffer_load_dwordx4 a[60:63], v227, s[8:11], s28 offen offset:1024 sc1
v_mfma_f32_16x16x32_bf16 v[100:103], a[132:135], a[108:111], v[100:103]
ds_read_b64_tr_b16 a[146:147], v235 offset:30592
s_add_u32 s28, s28, 2048
v_mfma_f32_16x16x32_bf16 v[100:103], a[128:131], a[104:107], v[100:103]
v_mfma_f32_16x16x32_bf16 v[104:107], a[128:131], a[112:115], v[104:107]
ds_read_b64_tr_b16 a[148:149], v235 offset:35968
s_add_u32 m0, s3, 0
v_mfma_f32_16x16x32_bf16 v[104:107], a[132:135], a[116:119], v[104:107]
buffer_load_dwordx4 v228, s[12:15], s52 offen offset:0  lds
v_mfma_f32_16x16x32_bf16 v[108:111], a[132:135], a[124:127], v[108:111]
ds_read_b64_tr_b16 a[150:151], v235 offset:37760
s_add_u32 s53, s98, 0
v_mfma_f32_16x16x32_bf16 v[108:111], a[128:131], a[120:123], v[108:111]
s_cmp_eq_u32 s31, 1
s_cselect_b32 s53, s53, 0x40000000
s_waitcnt lgkmcnt(4)
v_mfma_f32_16x16x32_bf16 v[124:127], a[136:139], a[120:123], v[124:127]
ds_read_b64_tr_b16 a[152:153], v235 offset:43136
v_mfma_f32_16x16x32_bf16 v[124:127], a[140:143], a[124:127], v[124:127]
v_mfma_f32_16x16x32_bf16 v[120:123], a[140:143], a[116:119], v[120:123]
ds_read_b64_tr_b16 a[154:155], v235 offset:44928
v_mfma_f32_16x16x32_bf16 v[120:123], a[136:139], a[112:115], v[120:123]
buffer_load_dwordx4 v229, s[12:15], s52 offen offset:1024  lds
v_mfma_f32_16x16x32_bf16 v[116:119], a[136:139], a[104:107], v[116:119]
ds_read_b64_tr_b16 a[156:157], v235 offset:50304
v_mfma_f32_16x16x32_bf16 v[116:119], a[140:143], a[108:111], v[116:119]
buffer_load_dword v255, v253, s[20:23], s53 offen
v_mfma_f32_16x16x32_bf16 v[112:115], a[140:143], a[100:103], v[112:115]
ds_read_b64_tr_b16 a[158:159], v235 offset:52096
v_mfma_f32_16x16x32_bf16 v[112:115], a[136:139], a[96:99], v[112:115]
s_waitcnt lgkmcnt(4)
v_mfma_f32_16x16x32_bf16 v[128:131], a[144:147], a[96:99], v[128:131]
ds_read_b64_tr_b16 a[128:129], v235 offset:28832
v_mfma_f32_16x16x32_bf16 v[128:131], a[148:151], a[100:103], v[128:131]
buffer_load_dwordx4 v230, s[12:15], s52 offen offset:2048  lds
v_mfma_f32_16x16x32_bf16 v[132:135], a[148:151], a[108:111], v[132:135]
ds_read_b64_tr_b16 a[130:131], v235 offset:30624
v_mfma_f32_16x16x32_bf16 v[132:135], a[144:147], a[104:107], v[132:135]
v_mfma_f32_16x16x32_bf16 v[136:139], a[144:147], a[112:115], v[136:139]
ds_read_b64_tr_b16 a[132:133], v235 offset:36000
v_mfma_f32_16x16x32_bf16 v[136:139], a[148:151], a[116:119], v[136:139]
v_mfma_f32_16x16x32_bf16 v[140:143], a[148:151], a[124:127], v[140:143]
ds_read_b64_tr_b16 a[134:135], v235 offset:37792
v_mfma_f32_16x16x32_bf16 v[140:143], a[144:147], a[120:123], v[140:143]
s_waitcnt lgkmcnt(4)
v_mfma_f32_16x16x32_bf16 v[156:159], a[152:155], a[120:123], v[156:159]
ds_read_b64_tr_b16 a[136:137], v235 offset:43168
v_mfma_f32_16x16x32_bf16 v[156:159], a[156:159], a[124:127], v[156:159]
buffer_load_dwordx4 v231, s[12:15], s52 offen offset:3072  lds
v_mfma_f32_16x16x32_bf16 v[152:155], a[156:159], a[116:119], v[152:155]
ds_read_b64_tr_b16 a[138:139], v235 offset:44960
s_add_u32 m0, s3, 4096
v_mfma_f32_16x16x32_bf16 v[152:155], a[152:155], a[112:115], v[152:155]
v_mfma_f32_16x16x32_bf16 v[148:151], a[152:155], a[104:107], v[148:151]
ds_read_b64_tr_b16 a[140:141], v235 offset:50336
v_mfma_f32_16x16x32_bf16 v[148:151], a[156:159], a[108:111], v[148:151]
v_mfma_f32_16x16x32_bf16 v[144:147], a[156:159], a[100:103], v[144:147]
ds_read_b64_tr_b16 a[142:143], v235 offset:52128
v_mfma_f32_16x16x32_bf16 v[144:147], a[152:155], a[96:99], v[144:147]
s_waitcnt lgkmcnt(4)
v_mfma_f32_16x16x32_bf16 v[160:163], a[128:131], a[96:99], v[160:163]
ds_read_b64_tr_b16 a[144:145], v235 offset:28864
v_mfma_f32_16x16x32_bf16 v[160:163], a[132:135], a[100:103], v[160:163]
buffer_load_dwordx4 v232, s[12:15], s52 offen offset:0  lds
v_mfma_f32_16x16x32_bf16 v[164:167], a[132:135], a[108:111], v[164:167]
ds_read_b64_tr_b16 a[146:147], v235 offset:30656
v_mfma_f32_16x16x32_bf16 v[164:167], a[128:131], a[104:107], v[164:167]
v_mfma_f32_16x16x32_bf16 v[168:171], a[128:131], a[112:115], v[168:171]
ds_read_b64_tr_b16 a[148:149], v235 offset:36032
v_mfma_f32_16x16x32_bf16 v[168:171], a[132:135], a[116:119], v[168:171]
buffer_load_dwordx4 v233, s[12:15], s52 offen offset:1024  lds
v_mfma_f32_16x16x32_bf16 v[172:175], a[132:135], a[124:127], v[172:175]
ds_read_b64_tr_b16 a[150:151], v235 offset:37824
v_mfma_f32_16x16x32_bf16 v[172:175], a[128:131], a[120:123], v[172:175]
s_waitcnt lgkmcnt(4)
v_mfma_f32_16x16x32_bf16 v[188:191], a[136:139], a[120:123], v[188:191]
ds_read_b64_tr_b16 a[152:153], v235 offset:43200
v_mfma_f32_16x16x32_bf16 v[188:191], a[140:143], a[124:127], v[188:191]
v_mfma_f32_16x16x32_bf16 v[184:187], a[140:143], a[116:119], v[184:187]
ds_read_b64_tr_b16 a[154:155], v235 offset:44992
v_mfma_f32_16x16x32_bf16 v[184:187], a[136:139], a[112:115], v[184:187]
buffer_load_dwordx4 v234, s[12:15], s52 offen offset:2048  lds
v_mfma_f32_16x16x32_bf16 v[180:183], a[136:139], a[104:107], v[180:183]
ds_read_b64_tr_b16 a[156:157], v235 offset:50368
s_add_u32 s52, s52, 458752
v_mfma_f32_16x16x32_bf16 v[180:183], a[140:143], a[108:111], v[180:183]
v_mfma_f32_16x16x32_bf16 v[176:179], a[140:143], a[100:103], v[176:179]
ds_read_b64_tr_b16 a[158:159], v235 offset:52160
v_mfma_f32_16x16x32_bf16 v[176:179], a[136:139], a[96:99], v[176:179]
s_waitcnt lgkmcnt(4)
v_mfma_f32_16x16x32_bf16 v[192:195], a[144:147], a[96:99], v[192:195]
ds_read_b64_tr_b16 a[128:129], v236 offset:28672
v_mfma_f32_16x16x32_bf16 v[192:195], a[148:151], a[100:103], v[192:195]
v_mfma_f32_16x16x32_bf16 v[196:199], a[148:151], a[108:111], v[196:199]
ds_read_b64_tr_b16 a[130:131], v236 offset:30464
v_mfma_f32_16x16x32_bf16 v[196:199], a[144:147], a[104:107], v[196:199]
buffer_load_dwordx4 a[64:67], v224, s[8:11], s28 offen offset:0 sc1
v_mfma_f32_16x16x32_bf16 v[200:203], a[144:147], a[112:115], v[200:203]
ds_read_b64_tr_b16 a[132:133], v236 offset:35840
v_mfma_f32_16x16x32_bf16 v[200:203], a[148:151], a[116:119], v[200:203]
v_mfma_f32_16x16x32_bf16 v[204:207], a[148:151], a[124:127], v[204:207]
ds_read_b64_tr_b16 a[134:135], v236 offset:37632
v_mfma_f32_16x16x32_bf16 v[204:207], a[144:147], a[120:123], v[204:207]
s_waitcnt lgkmcnt(4)
v_mfma_f32_16x16x32_bf16 v[220:223], a[152:155], a[120:123], v[220:223]
ds_read_b64_tr_b16 a[136:137], v236 offset:43008
v_mfma_f32_16x16x32_bf16 v[220:223], a[156:159], a[124:127], v[220:223]
buffer_load_dwordx4 a[72:75], v225, s[8:11], s28 offen offset:0 sc1
v_mfma_f32_16x16x32_bf16 v[216:219], a[156:159], a[116:119], v[216:219]
ds_read_b64_tr_b16 a[138:139], v236 offset:44800
v_mfma_f32_16x16x32_bf16 v[216:219], a[152:155], a[112:115], v[216:219]
v_mfma_f32_16x16x32_bf16 v[212:215], a[152:155], a[104:107], v[212:215]
ds_read_b64_tr_b16 a[140:141], v236 offset:50176
v_mfma_f32_16x16x32_bf16 v[212:215], a[156:159], a[108:111], v[212:215]
v_mfma_f32_16x16x32_bf16 v[208:211], a[156:159], a[100:103], v[208:211]
ds_read_b64_tr_b16 a[142:143], v236 offset:51968
v_mfma_f32_16x16x32_bf16 v[208:211], a[152:155], a[96:99], v[208:211]
buffer_load_dwordx4 a[80:83], v226, s[8:11], s28 offen offset:0 sc1
s_waitcnt vmcnt(27) lgkmcnt(4)
v_mfma_f32_16x16x32_bf16 v[0:3], a[128:131], a[0:3], v[0:3]
ds_read_b64_tr_b16 a[144:145], v236 offset:28704
v_mfma_f32_16x16x32_bf16 v[0:3], a[132:135], a[4:7], v[0:3]
s_waitcnt vmcnt(20)
s_barrier
v_mfma_f32_16x16x32_bf16 v[4:7], a[132:135], a[12:15], v[4:7]
ds_read_b64_tr_b16 a[146:147], v236 offset:30496
v_mfma_f32_16x16x32_bf16 v[4:7], a[128:131], a[8:11], v[4:7]
v_mfma_f32_16x16x32_bf16 v[8:11], a[128:131], a[16:19], v[8:11]
ds_read_b64_tr_b16 a[148:149], v236 offset:35872
v_mfma_f32_16x16x32_bf16 v[8:11], a[132:135], a[20:23], v[8:11]
v_mfma_f32_16x16x32_bf16 v[12:15], a[132:135], a[28:31], v[12:15]
ds_read_b64_tr_b16 a[150:151], v236 offset:37664
v_mfma_f32_16x16x32_bf16 v[12:15], a[128:131], a[24:27], v[12:15]
s_waitcnt lgkmcnt(4)
v_mfma_f32_16x16x32_bf16 v[28:31], a[136:139], a[24:27], v[28:31]
ds_read_b64_tr_b16 a[152:153], v236 offset:43040
v_mfma_f32_16x16x32_bf16 v[28:31], a[140:143], a[28:31], v[28:31]
buffer_load_dwordx4 a[88:91], v227, s[8:11], s28 offen offset:0 sc1
v_mfma_f32_16x16x32_bf16 v[24:27], a[140:143], a[20:23], v[24:27]
ds_read_b64_tr_b16 a[154:155], v236 offset:44832
v_mfma_f32_16x16x32_bf16 v[24:27], a[136:139], a[16:19], v[24:27]
v_mfma_f32_16x16x32_bf16 v[20:23], a[136:139], a[8:11], v[20:23]
ds_read_b64_tr_b16 a[156:157], v236 offset:50208
v_mfma_f32_16x16x32_bf16 v[20:23], a[140:143], a[12:15], v[20:23]
buffer_load_dwordx4 a[68:71], v224, s[8:11], s28 offen offset:1024 sc1
v_mfma_f32_16x16x32_bf16 v[16:19], a[140:143], a[4:7], v[16:19]
ds_read_b64_tr_b16 a[158:159], v236 offset:52000
v_mfma_f32_16x16x32_bf16 v[16:19], a[136:139], a[0:3], v[16:19]
s_waitcnt lgkmcnt(4)
v_mfma_f32_16x16x32_bf16 v[32:35], a[144:147], a[0:3], v[32:35]
ds_read_b64_tr_b16 a[128:129], v236 offset:28736
v_mfma_f32_16x16x32_bf16 v[32:35], a[148:151], a[4:7], v[32:35]
v_mfma_f32_16x16x32_bf16 v[36:39], a[148:151], a[12:15], v[36:39]
ds_read_b64_tr_b16 a[130:131], v236 offset:30528
v_mfma_f32_16x16x32_bf16 v[36:39], a[144:147], a[8:11], v[36:39]
buffer_load_dwordx4 a[76:79], v225, s[8:11], s28 offen offset:1024 sc1
v_mfma_f32_16x16x32_bf16 v[40:43], a[144:147], a[16:19], v[40:43]
ds_read_b64_tr_b16 a[132:133], v236 offset:35904
v_mfma_f32_16x16x32_bf16 v[40:43], a[148:151], a[20:23], v[40:43]
v_mfma_f32_16x16x32_bf16 v[44:47], a[148:151], a[28:31], v[44:47]
ds_read_b64_tr_b16 a[134:135], v236 offset:37696
v_mfma_f32_16x16x32_bf16 v[44:47], a[144:147], a[24:27], v[44:47]
s_waitcnt lgkmcnt(4)
v_mfma_f32_16x16x32_bf16 v[60:63], a[152:155], a[24:27], v[60:63]
ds_read_b64_tr_b16 a[136:137], v236 offset:43072
v_mfma_f32_16x16x32_bf16 v[60:63], a[156:159], a[28:31], v[60:63]
buffer_load_dwordx4 a[84:87], v226, s[8:11], s28 offen offset:1024 sc1
v_mfma_f32_16x16x32_bf16 v[56:59], a[156:159], a[20:23], v[56:59]
ds_read_b64_tr_b16 a[138:139], v236 offset:44864
v_mfma_f32_16x16x32_bf16 v[56:59], a[152:155], a[16:19], v[56:59]
v_mfma_f32_16x16x32_bf16 v[52:55], a[152:155], a[8:11], v[52:55]
ds_read_b64_tr_b16 a[140:141], v236 offset:50240
v_mfma_f32_16x16x32_bf16 v[52:55], a[156:159], a[12:15], v[52:55]
v_mfma_f32_16x16x32_bf16 v[48:51], a[156:159], a[4:7], v[48:51]
ds_read_b64_tr_b16 a[142:143], v236 offset:52032
v_mfma_f32_16x16x32_bf16 v[48:51], a[152:155], a[0:3], v[48:51]
s_waitcnt lgkmcnt(4)
v_mfma_f32_16x16x32_bf16 v[64:67], a[128:131], a[0:3], v[64:67]
ds_read_b64_tr_b16 a[144:145], v236 offset:28768
v_mfma_f32_16x16x32_bf16 v[64:67], a[132:135], a[4:7], v[64:67]
buffer_load_dwordx4 a[92:95], v227, s[8:11], s28 offen offset:1024 sc1
v_mfma_f32_16x16x32_bf16 v[68:71], a[132:135], a[12:15], v[68:71]
ds_read_b64_tr_b16 a[146:147], v236 offset:30560
s_add_u32 s28, s28, 2048
v_mfma_f32_16x16x32_bf16 v[68:71], a[128:131], a[8:11], v[68:71]
v_mfma_f32_16x16x32_bf16 v[72:75], a[128:131], a[16:19], v[72:75]
ds_read_b64_tr_b16 a[148:149], v236 offset:35936
v_mfma_f32_16x16x32_bf16 v[72:75], a[132:135], a[20:23], v[72:75]
v_mfma_f32_16x16x32_bf16 v[76:79], a[132:135], a[28:31], v[76:79]
ds_read_b64_tr_b16 a[150:151], v236 offset:37728
s_add_u32 m0, s3, 28672
v_mfma_f32_16x16x32_bf16 v[76:79], a[128:131], a[24:27], v[76:79]
s_waitcnt lgkmcnt(4)
v_mfma_f32_16x16x32_bf16 v[92:95], a[136:139], a[24:27], v[92:95]
ds_read_b64_tr_b16 a[152:153], v236 offset:43104
v_mfma_f32_16x16x32_bf16 v[92:95], a[140:143], a[28:31], v[92:95]
buffer_load_dwordx4 v228, s[12:15], s52 offen offset:0  lds
v_mfma_f32_16x16x32_bf16 v[88:91], a[140:143], a[20:23], v[88:91]
ds_read_b64_tr_b16 a[154:155], v236 offset:44896
v_mfma_f32_16x16x32_bf16 v[88:91], a[136:139], a[16:19], v[88:91]
v_mfma_f32_16x16x32_bf16 v[84:87], a[136:139], a[8:11], v[84:87]
ds_read_b64_tr_b16 a[156:157], v236 offset:50272
v_mfma_f32_16x16x32_bf16 v[84:87], a[140:143], a[12:15], v[84:87]
buffer_load_dwordx4 v229, s[12:15], s52 offen offset:1024  lds
v_mfma_f32_16x16x32_bf16 v[80:83], a[140:143], a[4:7], v[80:83]
ds_read_b64_tr_b16 a[158:159], v236 offset:52064
v_mfma_f32_16x16x32_bf16 v[80:83], a[136:139], a[0:3], v[80:83]
s_waitcnt lgkmcnt(4)
v_mfma_f32_16x16x32_bf16 v[96:99], a[144:147], a[0:3], v[96:99]
ds_read_b64_tr_b16 a[128:129], v236 offset:28800
v_mfma_f32_16x16x32_bf16 v[96:99], a[148:151], a[4:7], v[96:99]
v_mfma_f32_16x16x32_bf16 v[100:103], a[148:151], a[12:15], v[100:103]
ds_read_b64_tr_b16 a[130:131], v236 offset:30592
s_add_u32 s53, s98, 2097152
v_mfma_f32_16x16x32_bf16 v[100:103], a[144:147], a[8:11], v[100:103]
buffer_load_dwordx4 v230, s[12:15], s52 offen offset:2048  lds
v_mfma_f32_16x16x32_bf16 v[104:107], a[144:147], a[16:19], v[104:107]
ds_read_b64_tr_b16 a[132:133], v236 offset:35968
s_cmp_eq_u32 s31, 0
s_cselect_b32 s53, s53, 0x40000000
v_mfma_f32_16x16x32_bf16 v[104:107], a[148:151], a[20:23], v[104:107]
v_mfma_f32_16x16x32_bf16 v[108:111], a[148:151], a[28:31], v[108:111]
ds_read_b64_tr_b16 a[134:135], v236 offset:37760
v_mfma_f32_16x16x32_bf16 v[108:111], a[144:147], a[24:27], v[108:111]
s_waitcnt lgkmcnt(4)
v_mfma_f32_16x16x32_bf16 v[124:127], a[152:155], a[24:27], v[124:127]
ds_read_b64_tr_b16 a[136:137], v236 offset:43136
v_mfma_f32_16x16x32_bf16 v[124:127], a[156:159], a[28:31], v[124:127]
buffer_load_dword v255, v253, s[20:23], s53 offen
v_mfma_f32_16x16x32_bf16 v[120:123], a[156:159], a[20:23], v[120:123]
ds_read_b64_tr_b16 a[138:139], v236 offset:44928
v_mfma_f32_16x16x32_bf16 v[120:123], a[152:155], a[16:19], v[120:123]
buffer_load_dwordx4 v231, s[12:15], s52 offen offset:3072  lds
v_mfma_f32_16x16x32_bf16 v[116:119], a[152:155], a[8:11], v[116:119]
ds_read_b64_tr_b16 a[140:141], v236 offset:50304
s_add_u32 m0, s3, 32768
v_mfma_f32_16x16x32_bf16 v[116:119], a[156:159], a[12:15], v[116:119]
v_mfma_f32_16x16x32_bf16 v[112:115], a[156:159], a[4:7], v[112:115]
ds_read_b64_tr_b16 a[142:143], v236 offset:52096
v_mfma_f32_16x16x32_bf16 v[112:115], a[152:155], a[0:3], v[112:115]
s_waitcnt lgkmcnt(4)
v_mfma_f32_16x16x32_bf16 v[128:131], a[128:131], a[0:3], v[128:131]
ds_read_b64_tr_b16 a[144:145], v236 offset:28832
v_mfma_f32_16x16x32_bf16 v[128:131], a[132:135], a[4:7], v[128:131]
buffer_load_dwordx4 v232, s[12:15], s52 offen offset:0  lds
v_mfma_f32_16x16x32_bf16 v[132:135], a[132:135], a[12:15], v[132:135]
ds_read_b64_tr_b16 a[146:147], v236 offset:30624
v_mfma_f32_16x16x32_bf16 v[132:135], a[128:131], a[8:11], v[132:135]
v_mfma_f32_16x16x32_bf16 v[136:139], a[128:131], a[16:19], v[136:139]
ds_read_b64_tr_b16 a[148:149], v236 offset:36000
v_mfma_f32_16x16x32_bf16 v[136:139], a[132:135], a[20:23], v[136:139]
v_mfma_f32_16x16x32_bf16 v[140:143], a[132:135], a[28:31], v[140:143]
ds_read_b64_tr_b16 a[150:151], v236 offset:37792
v_mfma_f32_16x16x32_bf16 v[140:143], a[128:131], a[24:27], v[140:143]
s_waitcnt lgkmcnt(4)
v_mfma_f32_16x16x32_bf16 v[156:159], a[136:139], a[24:27], v[156:159]
ds_read_b64_tr_b16 a[152:153], v236 offset:43168
v_mfma_f32_16x16x32_bf16 v[156:159], a[140:143], a[28:31], v[156:159]
buffer_load_dwordx4 v233, s[12:15], s52 offen offset:1024  lds
v_mfma_f32_16x16x32_bf16 v[152:155], a[140:143], a[20:23], v[152:155]
ds_read_b64_tr_b16 a[154:155], v236 offset:44960
v_mfma_f32_16x16x32_bf16 v[152:155], a[136:139], a[16:19], v[152:155]
v_mfma_f32_16x16x32_bf16 v[148:151], a[136:139], a[8:11], v[148:151]
ds_read_b64_tr_b16 a[156:157], v236 offset:50336
v_mfma_f32_16x16x32_bf16 v[148:151], a[140:143], a[12:15], v[148:151]
v_mfma_f32_16x16x32_bf16 v[144:147], a[140:143], a[4:7], v[144:147]
ds_read_b64_tr_b16 a[158:159], v236 offset:52128
v_mfma_f32_16x16x32_bf16 v[144:147], a[136:139], a[0:3], v[144:147]
s_waitcnt lgkmcnt(4)
v_mfma_f32_16x16x32_bf16 v[160:163], a[144:147], a[0:3], v[160:163]
ds_read_b64_tr_b16 a[128:129], v236 offset:28864
v_mfma_f32_16x16x32_bf16 v[160:163], a[148:151], a[4:7], v[160:163]
buffer_load_dwordx4 v234, s[12:15], s52 offen offset:2048  lds
v_mfma_f32_16x16x32_bf16 v[164:167], a[148:151], a[12:15], v[164:167]
ds_read_b64_tr_b16 a[130:131], v236 offset:30656
s_add_u32 s52, s52, 458752
v_mfma_f32_16x16x32_bf16 v[164:167], a[144:147], a[8:11], v[164:167]
v_mfma_f32_16x16x32_bf16 v[168:171], a[144:147], a[16:19], v[168:171]
ds_read_b64_tr_b16 a[132:133], v236 offset:36032
v_mfma_f32_16x16x32_bf16 v[168:171], a[148:151], a[20:23], v[168:171]
buffer_load_dwordx4 a[96:99], v224, s[8:11], s28 offen offset:0 sc1
v_mfma_f32_16x16x32_bf16 v[172:175], a[148:151], a[28:31], v[172:175]
ds_read_b64_tr_b16 a[134:135], v236 offset:37824
v_mfma_f32_16x16x32_bf16 v[172:175], a[144:147], a[24:27], v[172:175]
s_waitcnt lgkmcnt(4)
v_mfma_f32_16x16x32_bf16 v[188:191], a[152:155], a[24:27], v[188:191]
ds_read_b64_tr_b16 a[136:137], v236 offset:43200
v_mfma_f32_16x16x32_bf16 v[188:191], a[156:159], a[28:31], v[188:191]
v_mfma_f32_16x16x32_bf16 v[184:187], a[156:159], a[20:23], v[184:187]
ds_read_b64_tr_b16 a[138:139], v236 offset:44992
v_mfma_f32_16x16x32_bf16 v[184:187], a[152:155], a[16:19], v[184:187]
buffer_load_dwordx4 a[104:107], v225, s[8:11], s28 offen offset:0 sc1
v_mfma_f32_16x16x32_bf16 v[180:183], a[152:155], a[8:11], v[180:183]
ds_read_b64_tr_b16 a[140:141], v236 offset:50368
v_mfma_f32_16x16x32_bf16 v[180:183], a[156:159], a[12:15], v[180:183]
v_mfma_f32_16x16x32_bf16 v[176:179], a[156:159], a[4:7], v[176:179]
ds_read_b64_tr_b16 a[142:143], v236 offset:52160
v_mfma_f32_16x16x32_bf16 v[176:179], a[152:155], a[0:3], v[176:179]
s_waitcnt lgkmcnt(4)
v_mfma_f32_16x16x32_bf16 v[192:195], a[128:131], a[0:3], v[192:195]
ds_read_b64_tr_b16 a[144:145], v236 offset:0
v_mfma_f32_16x16x32_bf16 v[192:195], a[132:135], a[4:7], v[192:195]
buffer_load_dwordx4 a[112:115], v226, s[8:11], s28 offen offset:0 sc1
v_mfma_f32_16x16x32_bf16 v[196:199], a[132:135], a[12:15], v[196:199]
ds_read_b64_tr_b16 a[146:147], v236 offset:1792
v_mfma_f32_16x16x32_bf16 v[196:199], a[128:131], a[8:11], v[196:199]
v_mfma_f32_16x16x32_bf16 v[200:203], a[128:131], a[16:19], v[200:203]
ds_read_b64_tr_b16 a[148:149], v236 offset:7168
v_mfma_f32_16x16x32_bf16 v[200:203], a[132:135], a[20:23], v[200:203]
v_mfma_f32_16x16x32_bf16 v[204:207], a[132:135], a[28:31], v[204:207]
ds_read_b64_tr_b16 a[150:151], v236 offset:8960
v_mfma_f32_16x16x32_bf16 v[204:207], a[128:131], a[24:27], v[204:207]
s_waitcnt lgkmcnt(4)
v_mfma_f32_16x16x32_bf16 v[220:223], a[136:139], a[24:27], v[220:223]
ds_read_b64_tr_b16 a[152:153], v236 offset:14336
v_mfma_f32_16x16x32_bf16 v[220:223], a[140:143], a[28:31], v[220:223]
buffer_load_dwordx4 a[120:123], v227, s[8:11], s28 offen offset:0 sc1
v_mfma_f32_16x16x32_bf16 v[216:219], a[140:143], a[20:23], v[216:219]
ds_read_b64_tr_b16 a[154:155], v236 offset:16128
v_mfma_f32_16x16x32_bf16 v[216:219], a[136:139], a[16:19], v[216:219]
v_mfma_f32_16x16x32_bf16 v[212:215], a[136:139], a[8:11], v[212:215]
ds_read_b64_tr_b16 a[156:157], v236 offset:21504
v_mfma_f32_16x16x32_bf16 v[212:215], a[140:143], a[12:15], v[212:215]
v_mfma_f32_16x16x32_bf16 v[208:211], a[140:143], a[4:7], v[208:211]
ds_read_b64_tr_b16 a[158:159], v236 offset:23296
buffer_load_dwordx4 a[100:103], v224, s[8:11], s28 offen offset:1024 sc1
v_mfma_f32_16x16x32_bf16 v[208:211], a[136:139], a[0:3], v[208:211]
s_add_u32 s53, s98, 2097152
s_waitcnt vmcnt(29) lgkmcnt(4)
v_mfma_f32_16x16x32_bf16 v[0:3], a[144:147], a[32:35], v[0:3]
ds_read_b64_tr_b16 a[128:129], v236 offset:32
s_cmp_eq_u32 s31, 1
s_cselect_b32 s53, s53, 0x40000000
v_mfma_f32_16x16x32_bf16 v[0:3], a[148:151], a[36:39], v[0:3]
s_waitcnt vmcnt(21)
s_barrier
v_mfma_f32_16x16x32_bf16 v[4:7], a[148:151], a[44:47], v[4:7]
ds_read_b64_tr_b16 a[130:131], v236 offset:1824
v_mfma_f32_16x16x32_bf16 v[4:7], a[144:147], a[40:43], v[4:7]
v_mfma_f32_16x16x32_bf16 v[8:11], a[144:147], a[48:51], v[8:11]
ds_read_b64_tr_b16 a[132:133], v236 offset:7200
buffer_load_dword v255, v253, s[20:23], s53 offen
v_mfma_f32_16x16x32_bf16 v[8:11], a[148:151], a[52:55], v[8:11]
buffer_load_dwordx4 a[108:111], v225, s[8:11], s28 offen offset:1024 sc1
v_mfma_f32_16x16x32_bf16 v[12:15], a[148:151], a[60:63], v[12:15]
ds_read_b64_tr_b16 a[134:135], v236 offset:8992
v_mfma_f32_16x16x32_bf16 v[12:15], a[144:147], a[56:59], v[12:15]
s_waitcnt lgkmcnt(4)
v_mfma_f32_16x16x32_bf16 v[28:31], a[152:155], a[56:59], v[28:31]
ds_read_b64_tr_b16 a[136:137], v236 offset:14368
v_mfma_f32_16x16x32_bf16 v[28:31], a[156:159], a[60:63], v[28:31]
v_mfma_f32_16x16x32_bf16 v[24:27], a[156:159], a[52:55], v[24:27]
ds_read_b64_tr_b16 a[138:139], v236 offset:16160
v_mfma_f32_16x16x32_bf16 v[24:27], a[152:155], a[48:51], v[24:27]
v_mfma_f32_16x16x32_bf16 v[20:23], a[152:155], a[40:43], v[20:23]
ds_read_b64_tr_b16 a[140:141], v236 offset:21536
v_mfma_f32_16x16x32_bf16 v[20:23], a[156:159], a[44:47], v[20:23]
buffer_load_dwordx4 a[116:119], v226, s[8:11], s28 offen offset:1024 sc1
v_mfma_f32_16x16x32_bf16 v[16:19], a[156:159], a[36:39], v[16:19]
ds_read_b64_tr_b16 a[142:143], v236 offset:23328
v_mfma_f32_16x16x32_bf16 v[16:19], a[152:155], a[32:35], v[16:19]
s_waitcnt lgkmcnt(4)
v_mfma_f32_16x16x32_bf16 v[32:35], a[128:131], a[32:35], v[32:35]
ds_read_b64_tr_b16 a[144:145], v236 offset:64
v_mfma_f32_16x16x32_bf16 v[32:35], a[132:135], a[36:39], v[32:35]
v_mfma_f32_16x16x32_bf16 v[36:39], a[132:135], a[44:47], v[36:39]
ds_read_b64_tr_b16 a[146:147], v236 offset:1856
v_mfma_f32_16x16x32_bf16 v[36:39], a[128:131], a[40:43], v[36:39]
buffer_load_dwordx4 a[124:127], v227, s[8:11], s28 offen offset:1024 sc1
v_mfma_f32_16x16x32_bf16 v[40:43], a[128:131], a[48:51], v[40:43]
ds_read_b64_tr_b16 a[148:149], v236 offset:7232
s_add_u32 s28, s28, 2048
v_mfma_f32_16x16x32_bf16 v[40:43], a[132:135], a[52:55], v[40:43]
v_mfma_f32_16x16x32_bf16 v[44:47], a[132:135], a[60:63], v[44:47]
ds_read_b64_tr_b16 a[150:151], v236 offset:9024
v_mfma_f32_16x16x32_bf16 v[44:47], a[128:131], a[56:59], v[44:47]
s_waitcnt lgkmcnt(4)
v_mfma_f32_16x16x32_bf16 v[60:63], a[136:139], a[56:59], v[60:63]
ds_read_b64_tr_b16 a[152:153], v236 offset:14400
v_mfma_f32_16x16x32_bf16 v[60:63], a[140:143], a[60:63], v[60:63]
s_add_u32 m0, s3, 86016
v_mfma_f32_16x16x32_bf16 v[56:59], a[140:143], a[52:55], v[56:59]
ds_read_b64_tr_b16 a[154:155], v236 offset:16192
v_mfma_f32_16x16x32_bf16 v[56:59], a[136:139], a[48:51], v[56:59]
buffer_load_dwordx4 v228, s[12:15], s52 offen offset:0  lds
v_mfma_f32_16x16x32_bf16 v[52:55], a[136:139], a[40:43], v[52:55]
ds_read_b64_tr_b16 a[156:157], v236 offset:21568
v_mfma_f32_16x16x32_bf16 v[52:55], a[140:143], a[44:47], v[52:55]
v_mfma_f32_16x16x32_bf16 v[48:51], a[140:143], a[36:39], v[48:51]
ds_read_b64_tr_b16 a[158:159], v236 offset:23360
v_mfma_f32_16x16x32_bf16 v[48:51], a[136:139], a[32:35], v[48:51]
s_waitcnt lgkmcnt(4)
v_mfma_f32_16x16x32_bf16 v[64:67], a[144:147], a[32:35], v[64:67]
ds_read_b64_tr_b16 a[128:129], v236 offset:96
v_mfma_f32_16x16x32_bf16 v[64:67], a[148:151], a[36:39], v[64:67]
buffer_load_dwordx4 v229, s[12:15], s52 offen offset:1024  lds
v_mfma_f32_16x16x32_bf16 v[68:71], a[148:151], a[44:47], v[68:71]
ds_read_b64_tr_b16 a[130:131], v236 offset:1888
v_mfma_f32_16x16x32_bf16 v[68:71], a[144:147], a[40:43], v[68:71]
v_mfma_f32_16x16x32_bf16 v[72:75], a[144:147], a[48:51], v[72:75]
ds_read_b64_tr_b16 a[132:133], v236 offset:7264
v_mfma_f32_16x16x32_bf16 v[72:75], a[148:151], a[52:55], v[72:75]
v_mfma_f32_16x16x32_bf16 v[76:79], a[148:151], a[60:63], v[76:79]
ds_read_b64_tr_b16 a[134:135], v236 offset:9056
v_mfma_f32_16x16x32_bf16 v[76:79], a[144:147], a[56:59], v[76:79]
s_waitcnt lgkmcnt(4)
v_mfma_f32_16x16x32_bf16 v[92:95], a[152:155], a[56:59], v[92:95]
ds_read_b64_tr_b16 a[136:137], v236 offset:14432
v_mfma_f32_16x16x32_bf16 v[92:95], a[156:159], a[60:63], v[92:95]
buffer_load_dwordx4 v230, s[12:15], s52 offen offset:2048  lds
v_mfma_f32_16x16x32_bf16 v[88:91], a[156:159], a[52:55], v[88:91]
ds_read_b64_tr_b16 a[138:139], v236 offset:16224
v_mfma_f32_16x16x32_bf16 v[88:91], a[152:155], a[48:51], v[88:91]
v_mfma_f32_16x16x32_bf16 v[84:87], a[152:155], a[40:43], v[84:87]
ds_read_b64_tr_b16 a[140:141], v236 offset:21600
v_mfma_f32_16x16x32_bf16 v[84:87], a[156:159], a[44:47], v[84:87]
buffer_load_dwordx4 v231, s[12:15], s52 offen offset:3072  lds
v_mfma_f32_16x16x32_bf16 v[80:83], a[156:159], a[36:39], v[80:83]
ds_read_b64_tr_b16 a[142:143], v236 offset:23392
s_add_u32 m0, s3, 90112
v_mfma_f32_16x16x32_bf16 v[80:83], a[152:155], a[32:35], v[80:83]
s_waitcnt lgkmcnt(4)
v_mfma_f32_16x16x32_bf16 v[96:99], a[128:131], a[32:35], v[96:99]
ds_read_b64_tr_b16 a[144:145], v236 offset:128
v_mfma_f32_16x16x32_bf16 v[96:99], a[132:135], a[36:39], v[96:99]
v_mfma_f32_16x16x32_bf16 v[100:103], a[132:135], a[44:47], v[100:103]
ds_read_b64_tr_b16 a[146:147], v236 offset:1920
v_mfma_f32_16x16x32_bf16 v[100:103], a[128:131], a[40:43], v[100:103]
buffer_load_dwordx4 v232, s[12:15], s52 offen offset:0  lds
v_mfma_f32_16x16x32_bf16 v[104:107], a[128:131], a[48:51], v[104:107]
ds_read_b64_tr_b16 a[148:149], v236 offset:7296
v_mfma_f32_16x16x32_bf16 v[104:107], a[132:135], a[52:55], v[104:107]
v_mfma_f32_16x16x32_bf16 v[108:111], a[132:135], a[60:63], v[108:111]
ds_read_b64_tr_b16 a[150:151], v236 offset:9088
v_mfma_f32_16x16x32_bf16 v[108:111], a[128:131], a[56:59], v[108:111]
s_waitcnt lgkmcnt(4)
v_mfma_f32_16x16x32_bf16 v[124:127], a[136:139], a[56:59], v[124:127]
ds_read_b64_tr_b16 a[152:153], v236 offset:14464
v_mfma_f32_16x16x32_bf16 v[124:127], a[140:143], a[60:63], v[124:127]
buffer_load_dwordx4 v233, s[12:15], s52 offen offset:1024  lds
v_mfma_f32_16x16x32_bf16 v[120:123], a[140:143], a[52:55], v[120:123]
ds_read_b64_tr_b16 a[154:155], v236 offset:16256
v_mfma_f32_16x16x32_bf16 v[120:123], a[136:139], a[48:51], v[120:123]
v_mfma_f32_16x16x32_bf16 v[116:119], a[136:139], a[40:43], v[116:119]
ds_read_b64_tr_b16 a[156:157], v236 offset:21632
v_mfma_f32_16x16x32_bf16 v[116:119], a[140:143], a[44:47], v[116:119]
v_mfma_f32_16x16x32_bf16 v[112:115], a[140:143], a[36:39], v[112:115]
ds_read_b64_tr_b16 a[158:159], v236 offset:23424
v_mfma_f32_16x16x32_bf16 v[112:115], a[136:139], a[32:35], v[112:115]
s_waitcnt lgkmcnt(4)
v_mfma_f32_16x16x32_bf16 v[128:131], a[144:147], a[32:35], v[128:131]
ds_read_b64_tr_b16 a[128:129], v236 offset:160
v_mfma_f32_16x16x32_bf16 v[128:131], a[148:151], a[36:39], v[128:131]
buffer_load_dwordx4 v234, s[12:15], s52 offen offset:2048  lds
v_mfma_f32_16x16x32_bf16 v[132:135], a[148:151], a[44:47], v[132:135]
ds_read_b64_tr_b16 a[130:131], v236 offset:1952
s_add_u32 s52, s52, 458752
v_mfma_f32_16x16x32_bf16 v[132:135], a[144:147], a[40:43], v[132:135]
v_mfma_f32_16x16x32_bf16 v[136:139], a[144:147], a[48:51], v[136:139]
ds_read_b64_tr_b16 a[132:133], v236 offset:7328
v_mfma_f32_16x16x32_bf16 v[136:139], a[148:151], a[52:55], v[136:139]
v_mfma_f32_16x16x32_bf16 v[140:143], a[148:151], a[60:63], v[140:143]
ds_read_b64_tr_b16 a[134:135], v236 offset:9120
v_mfma_f32_16x16x32_bf16 v[140:143], a[144:147], a[56:59], v[140:143]
s_waitcnt lgkmcnt(4)
v_mfma_f32_16x16x32_bf16 v[156:159], a[152:155], a[56:59], v[156:159]
ds_read_b64_tr_b16 a[136:137], v236 offset:14496
v_mfma_f32_16x16x32_bf16 v[156:159], a[156:159], a[60:63], v[156:159]
buffer_load_dwordx4 a[0:3], v224, s[8:11], s28 offen offset:0 sc1
v_mfma_f32_16x16x32_bf16 v[152:155], a[156:159], a[52:55], v[152:155]
ds_read_b64_tr_b16 a[138:139], v236 offset:16288
v_mfma_f32_16x16x32_bf16 v[152:155], a[152:155], a[48:51], v[152:155]
v_mfma_f32_16x16x32_bf16 v[148:151], a[152:155], a[40:43], v[148:151]
ds_read_b64_tr_b16 a[140:141], v236 offset:21664
v_mfma_f32_16x16x32_bf16 v[148:151], a[156:159], a[44:47], v[148:151]
buffer_load_dwordx4 a[8:11], v225, s[8:11], s28 offen offset:0 sc1
v_mfma_f32_16x16x32_bf16 v[144:147], a[156:159], a[36:39], v[144:147]
ds_read_b64_tr_b16 a[142:143], v236 offset:23456
v_mfma_f32_16x16x32_bf16 v[144:147], a[152:155], a[32:35], v[144:147]
s_waitcnt lgkmcnt(4)
v_mfma_f32_16x16x32_bf16 v[160:163], a[128:131], a[32:35], v[160:163]
ds_read_b64_tr_b16 a[144:145], v236 offset:192
v_mfma_f32_16x16x32_bf16 v[160:163], a[132:135], a[36:39], v[160:163]
v_mfma_f32_16x16x32_bf16 v[164:167], a[132:135], a[44:47], v[164:167]
ds_read_b64_tr_b16 a[146:147], v236 offset:1984
v_mfma_f32_16x16x32_bf16 v[164:167], a[128:131], a[40:43], v[164:167]
v_mfma_f32_16x16x32_bf16 v[168:171], a[128:131], a[48:51], v[168:171]
ds_read_b64_tr_b16 a[148:149], v236 offset:7360
v_mfma_f32_16x16x32_bf16 v[168:171], a[132:135], a[52:55], v[168:171]
buffer_load_dwordx4 a[16:19], v226, s[8:11], s28 offen offset:0 sc1
v_mfma_f32_16x16x32_bf16 v[172:175], a[132:135], a[60:63], v[172:175]
ds_read_b64_tr_b16 a[150:151], v236 offset:9152
v_mfma_f32_16x16x32_bf16 v[172:175], a[128:131], a[56:59], v[172:175]
s_waitcnt lgkmcnt(4)
v_mfma_f32_16x16x32_bf16 v[188:191], a[136:139], a[56:59], v[188:191]
ds_read_b64_tr_b16 a[152:153], v236 offset:14528
v_mfma_f32_16x16x32_bf16 v[188:191], a[140:143], a[60:63], v[188:191]
v_mfma_f32_16x16x32_bf16 v[184:187], a[140:143], a[52:55], v[184:187]
ds_read_b64_tr_b16 a[154:155], v236 offset:16320
v_mfma_f32_16x16x32_bf16 v[184:187], a[136:139], a[48:51], v[184:187]
buffer_load_dwordx4 a[24:27], v227, s[8:11], s28 offen offset:0 sc1
v_mfma_f32_16x16x32_bf16 v[180:183], a[136:139], a[40:43], v[180:183]
ds_read_b64_tr_b16 a[156:157], v236 offset:21696
v_mfma_f32_16x16x32_bf16 v[180:183], a[140:143], a[44:47], v[180:183]
v_mfma_f32_16x16x32_bf16 v[176:179], a[140:143], a[36:39], v[176:179]
ds_read_b64_tr_b16 a[158:159], v236 offset:23488
v_mfma_f32_16x16x32_bf16 v[176:179], a[136:139], a[32:35], v[176:179]
s_waitcnt lgkmcnt(4)
v_mfma_f32_16x16x32_bf16 v[192:195], a[144:147], a[32:35], v[192:195]
ds_read_b64_tr_b16 a[128:129], v235 offset:0
v_mfma_f32_16x16x32_bf16 v[192:195], a[148:151], a[36:39], v[192:195]
buffer_load_dwordx4 a[4:7], v224, s[8:11], s28 offen offset:1024 sc1
v_mfma_f32_16x16x32_bf16 v[196:199], a[148:151], a[44:47], v[196:199]
ds_read_b64_tr_b16 a[130:131], v235 offset:1792
v_mfma_f32_16x16x32_bf16 v[196:199], a[144:147], a[40:43], v[196:199]
v_mfma_f32_16x16x32_bf16 v[200:203], a[144:147], a[48:51], v[200:203]
ds_read_b64_tr_b16 a[132:133], v235 offset:7168
v_mfma_f32_16x16x32_bf16 v[200:203], a[148:151], a[52:55], v[200:203]
v_mfma_f32_16x16x32_bf16 v[204:207], a[148:151], a[60:63], v[204:207]
ds_read_b64_tr_b16 a[134:135], v235 offset:8960
v_mfma_f32_16x16x32_bf16 v[204:207], a[144:147], a[56:59], v[204:207]
s_waitcnt lgkmcnt(4)
v_mfma_f32_16x16x32_bf16 v[220:223], a[152:155], a[56:59], v[220:223]
ds_read_b64_tr_b16 a[136:137], v235 offset:14336
v_mfma_f32_16x16x32_bf16 v[220:223], a[156:159], a[60:63], v[220:223]
buffer_load_dwordx4 a[12:15], v225, s[8:11], s28 offen offset:1024 sc1
v_mfma_f32_16x16x32_bf16 v[216:219], a[156:159], a[52:55], v[216:219]
ds_read_b64_tr_b16 a[138:139], v235 offset:16128
v_mfma_f32_16x16x32_bf16 v[216:219], a[152:155], a[48:51], v[216:219]
v_mfma_f32_16x16x32_bf16 v[212:215], a[152:155], a[40:43], v[212:215]
ds_read_b64_tr_b16 a[140:141], v235 offset:21504
v_mfma_f32_16x16x32_bf16 v[212:215], a[156:159], a[44:47], v[212:215]
v_mfma_f32_16x16x32_bf16 v[208:211], a[156:159], a[36:39], v[208:211]
ds_read_b64_tr_b16 a[142:143], v235 offset:23296
buffer_load_dwordx4 a[20:23], v226, s[8:11], s28 offen offset:1024 sc1
v_mfma_f32_16x16x32_bf16 v[208:211], a[152:155], a[32:35], v[208:211]
s_waitcnt vmcnt(31) lgkmcnt(4)
v_mfma_f32_16x16x32_bf16 v[0:3], a[128:131], a[64:67], v[0:3]
ds_read_b64_tr_b16 a[144:145], v235 offset:32
v_mfma_f32_16x16x32_bf16 v[0:3], a[132:135], a[68:71], v[0:3]
s_waitcnt vmcnt(23)
s_barrier
v_mfma_f32_16x16x32_bf16 v[4:7], a[132:135], a[76:79], v[4:7]
ds_read_b64_tr_b16 a[146:147], v235 offset:1824
v_mfma_f32_16x16x32_bf16 v[4:7], a[128:131], a[72:75], v[4:7]
v_mfma_f32_16x16x32_bf16 v[8:11], a[128:131], a[80:83], v[8:11]
ds_read_b64_tr_b16 a[148:149], v235 offset:7200
v_mfma_f32_16x16x32_bf16 v[8:11], a[132:135], a[84:87], v[8:11]
buffer_load_dwordx4 a[28:31], v227, s[8:11], s28 offen offset:1024 sc1
v_mfma_f32_16x16x32_bf16 v[12:15], a[132:135], a[92:95], v[12:15]
ds_read_b64_tr_b16 a[150:151], v235 offset:8992
s_add_u32 s28, s28, 2048
v_mfma_f32_16x16x32_bf16 v[12:15], a[128:131], a[88:91], v[12:15]
s_waitcnt lgkmcnt(4)
v_mfma_f32_16x16x32_bf16 v[28:31], a[136:139], a[88:91], v[28:31]
ds_read_b64_tr_b16 a[152:153], v235 offset:14368
v_mfma_f32_16x16x32_bf16 v[28:31], a[140:143], a[92:95], v[28:31]
v_mfma_f32_16x16x32_bf16 v[24:27], a[140:143], a[84:87], v[24:27]
ds_read_b64_tr_b16 a[154:155], v235 offset:16160
v_mfma_f32_16x16x32_bf16 v[24:27], a[136:139], a[80:83], v[24:27]
s_add_u32 m0, s3, 57344
v_mfma_f32_16x16x32_bf16 v[20:23], a[136:139], a[72:75], v[20:23]
ds_read_b64_tr_b16 a[156:157], v235 offset:21536
v_mfma_f32_16x16x32_bf16 v[20:23], a[140:143], a[76:79], v[20:23]
buffer_load_dwordx4 v228, s[12:15], s52 offen offset:0  lds
v_mfma_f32_16x16x32_bf16 v[16:19], a[140:143], a[68:71], v[16:19]
ds_read_b64_tr_b16 a[158:159], v235 offset:23328
v_mfma_f32_16x16x32_bf16 v[16:19], a[136:139], a[64:67], v[16:19]
s_waitcnt lgkmcnt(4)
v_mfma_f32_16x16x32_bf16 v[32:35], a[144:147], a[64:67], v[32:35]
ds_read_b64_tr_b16 a[128:129], v235 offset:64
v_mfma_f32_16x16x32_bf16 v[32:35], a[148:151], a[68:71], v[32:35]
buffer_load_dwordx4 v229, s[12:15], s52 offen offset:1024  lds
v_mfma_f32_16x16x32_bf16 v[36:39], a[148:151], a[76:79], v[36:39]
ds_read_b64_tr_b16 a[130:131], v235 offset:1856
v_mfma_f32_16x16x32_bf16 v[36:39], a[144:147], a[72:75], v[36:39]
v_mfma_f32_16x16x32_bf16 v[40:43], a[144:147], a[80:83], v[40:43]
ds_read_b64_tr_b16 a[132:133], v235 offset:7232
v_mfma_f32_16x16x32_bf16 v[40:43], a[148:151], a[84:87], v[40:43]
v_mfma_f32_16x16x32_bf16 v[44:47], a[148:151], a[92:95], v[44:47]
ds_read_b64_tr_b16 a[134:135], v235 offset:9024
v_mfma_f32_16x16x32_bf16 v[44:47], a[144:147], a[88:91], v[44:47]
s_waitcnt lgkmcnt(4)
v_mfma_f32_16x16x32_bf16 v[60:63], a[152:155], a[88:91], v[60:63]
ds_read_b64_tr_b16 a[136:137], v235 offset:14400
v_mfma_f32_16x16x32_bf16 v[60:63], a[156:159], a[92:95], v[60:63]
buffer_load_dwordx4 v230, s[12:15], s52 offen offset:2048  lds
v_mfma_f32_16x16x32_bf16 v[56:59], a[156:159], a[84:87], v[56:59]
ds_read_b64_tr_b16 a[138:139], v235 offset:16192
v_mfma_f32_16x16x32_bf16 v[56:59], a[152:155], a[80:83], v[56:59]
v_mfma_f32_16x16x32_bf16 v[52:55], a[152:155], a[72:75], v[52:55]
ds_read_b64_tr_b16 a[140:141], v235 offset:21568
v_mfma_f32_16x16x32_bf16 v[52:55], a[156:159], a[76:79], v[52:55]
v_mfma_f32_16x16x32_bf16 v[48:51], a[156:159], a[68:71], v[48:51]
ds_read_b64_tr_b16 a[142:143], v235 offset:23360
v_mfma_f32_16x16x32_bf16 v[48:51], a[152:155], a[64:67], v[48:51]
s_waitcnt lgkmcnt(4)
v_mfma_f32_16x16x32_bf16 v[64:67], a[128:131], a[64:67], v[64:67]
ds_read_b64_tr_b16 a[144:145], v235 offset:96
v_mfma_f32_16x16x32_bf16 v[64:67], a[132:135], a[68:71], v[64:67]
buffer_load_dwordx4 v231, s[12:15], s52 offen offset:3072  lds
v_mfma_f32_16x16x32_bf16 v[68:71], a[132:135], a[76:79], v[68:71]
ds_read_b64_tr_b16 a[146:147], v235 offset:1888
s_add_u32 m0, s3, 61440
v_mfma_f32_16x16x32_bf16 v[68:71], a[128:131], a[72:75], v[68:71]
v_mfma_f32_16x16x32_bf16 v[72:75], a[128:131], a[80:83], v[72:75]
ds_read_b64_tr_b16 a[148:149], v235 offset:7264
v_mfma_f32_16x16x32_bf16 v[72:75], a[132:135], a[84:87], v[72:75]
buffer_load_dwordx4 v232, s[12:15], s52 offen offset:0  lds
v_mfma_f32_16x16x32_bf16 v[76:79], a[132:135], a[92:95], v[76:79]
ds_read_b64_tr_b16 a[150:151], v235 offset:9056
v_mfma_f32_16x16x32_bf16 v[76:79], a[128:131], a[88:91], v[76:79]
s_waitcnt lgkmcnt(4)
v_mfma_f32_16x16x32_bf16 v[92:95], a[136:139], a[88:91], v[92:95]
ds_read_b64_tr_b16 a[152:153], v235 offset:14432
v_mfma_f32_16x16x32_bf16 v[92:95], a[140:143], a[92:95], v[92:95]
v_mfma_f32_16x16x32_bf16 v[88:91], a[140:143], a[84:87], v[88:91]
ds_read_b64_tr_b16 a[154:155], v235 offset:16224
v_mfma_f32_16x16x32_bf16 v[88:91], a[136:139], a[80:83], v[88:91]
v_mfma_f32_16x16x32_bf16 v[84:87], a[136:139], a[72:75], v[84:87]
ds_read_b64_tr_b16 a[156:157], v235 offset:21600
v_mfma_f32_16x16x32_bf16 v[84:87], a[140:143], a[76:79], v[84:87]
buffer_load_dwordx4 v233, s[12:15], s52 offen offset:1024  lds
v_mfma_f32_16x16x32_bf16 v[80:83], a[140:143], a[68:71], v[80:83]
ds_read_b64_tr_b16 a[158:159], v235 offset:23392
v_mfma_f32_16x16x32_bf16 v[80:83], a[136:139], a[64:67], v[80:83]
s_waitcnt lgkmcnt(4)
v_mfma_f32_16x16x32_bf16 v[96:99], a[144:147], a[64:67], v[96:99]
ds_read_b64_tr_b16 a[128:129], v235 offset:128
v_mfma_f32_16x16x32_bf16 v[96:99], a[148:151], a[68:71], v[96:99]
v_mfma_f32_16x16x32_bf16 v[100:103], a[148:151], a[76:79], v[100:103]
ds_read_b64_tr_b16 a[130:131], v235 offset:1920
v_mfma_f32_16x16x32_bf16 v[100:103], a[144:147], a[72:75], v[100:103]
buffer_load_dwordx4 v234, s[12:15], s52 offen offset:2048  lds
v_mfma_f32_16x16x32_bf16 v[104:107], a[144:147], a[80:83], v[104:107]
ds_read_b64_tr_b16 a[132:133], v235 offset:7296
s_add_u32 s52, s52, 458752
v_mfma_f32_16x16x32_bf16 v[104:107], a[148:151], a[84:87], v[104:107]
v_mfma_f32_16x16x32_bf16 v[108:111], a[148:151], a[92:95], v[108:111]
ds_read_b64_tr_b16 a[134:135], v235 offset:9088
v_mfma_f32_16x16x32_bf16 v[108:111], a[144:147], a[88:91], v[108:111]
s_waitcnt lgkmcnt(4)
v_mfma_f32_16x16x32_bf16 v[124:127], a[152:155], a[88:91], v[124:127]
ds_read_b64_tr_b16 a[136:137], v235 offset:14464
v_mfma_f32_16x16x32_bf16 v[124:127], a[156:159], a[92:95], v[124:127]
buffer_load_dwordx4 a[32:35], v224, s[8:11], s28 offen offset:0 sc1
v_mfma_f32_16x16x32_bf16 v[120:123], a[156:159], a[84:87], v[120:123]
ds_read_b64_tr_b16 a[138:139], v235 offset:16256
v_mfma_f32_16x16x32_bf16 v[120:123], a[152:155], a[80:83], v[120:123]
v_mfma_f32_16x16x32_bf16 v[116:119], a[152:155], a[72:75], v[116:119]
ds_read_b64_tr_b16 a[140:141], v235 offset:21632
v_mfma_f32_16x16x32_bf16 v[116:119], a[156:159], a[76:79], v[116:119]
v_mfma_f32_16x16x32_bf16 v[112:115], a[156:159], a[68:71], v[112:115]
ds_read_b64_tr_b16 a[142:143], v235 offset:23424
v_mfma_f32_16x16x32_bf16 v[112:115], a[152:155], a[64:67], v[112:115]
s_waitcnt lgkmcnt(4)
v_mfma_f32_16x16x32_bf16 v[128:131], a[128:131], a[64:67], v[128:131]
ds_read_b64_tr_b16 a[144:145], v235 offset:160
v_mfma_f32_16x16x32_bf16 v[128:131], a[132:135], a[68:71], v[128:131]
buffer_load_dwordx4 a[40:43], v225, s[8:11], s28 offen offset:0 sc1
v_mfma_f32_16x16x32_bf16 v[132:135], a[132:135], a[76:79], v[132:135]
ds_read_b64_tr_b16 a[146:147], v235 offset:1952
v_mfma_f32_16x16x32_bf16 v[132:135], a[128:131], a[72:75], v[132:135]
v_mfma_f32_16x16x32_bf16 v[136:139], a[128:131], a[80:83], v[136:139]
ds_read_b64_tr_b16 a[148:149], v235 offset:7328
v_mfma_f32_16x16x32_bf16 v[136:139], a[132:135], a[84:87], v[136:139]
v_mfma_f32_16x16x32_bf16 v[140:143], a[132:135], a[92:95], v[140:143]
ds_read_b64_tr_b16 a[150:151], v235 offset:9120
v_mfma_f32_16x16x32_bf16 v[140:143], a[128:131], a[88:91], v[140:143]
s_waitcnt lgkmcnt(4)
v_mfma_f32_16x16x32_bf16 v[156:159], a[136:139], a[88:91], v[156:159]
ds_read_b64_tr_b16 a[152:153], v235 offset:14496
v_mfma_f32_16x16x32_bf16 v[156:159], a[140:143], a[92:95], v[156:159]
buffer_load_dwordx4 a[48:51], v226, s[8:11], s28 offen offset:0 sc1
v_mfma_f32_16x16x32_bf16 v[152:155], a[140:143], a[84:87], v[152:155]
ds_read_b64_tr_b16 a[154:155], v235 offset:16288
v_mfma_f32_16x16x32_bf16 v[152:155], a[136:139], a[80:83], v[152:155]
v_mfma_f32_16x16x32_bf16 v[148:151], a[136:139], a[72:75], v[148:151]
ds_read_b64_tr_b16 a[156:157], v235 offset:21664
v_mfma_f32_16x16x32_bf16 v[148:151], a[140:143], a[76:79], v[148:151]
buffer_load_dwordx4 a[56:59], v227, s[8:11], s28 offen offset:0 sc1
v_mfma_f32_16x16x32_bf16 v[144:147], a[140:143], a[68:71], v[144:147]
ds_read_b64_tr_b16 a[158:159], v235 offset:23456
v_mfma_f32_16x16x32_bf16 v[144:147], a[136:139], a[64:67], v[144:147]
s_waitcnt lgkmcnt(4)
v_mfma_f32_16x16x32_bf16 v[160:163], a[144:147], a[64:67], v[160:163]
ds_read_b64_tr_b16 a[128:129], v235 offset:192
v_mfma_f32_16x16x32_bf16 v[160:163], a[148:151], a[68:71], v[160:163]
v_mfma_f32_16x16x32_bf16 v[164:167], a[148:151], a[76:79], v[164:167]
ds_read_b64_tr_b16 a[130:131], v235 offset:1984
v_mfma_f32_16x16x32_bf16 v[164:167], a[144:147], a[72:75], v[164:167]
buffer_load_dwordx4 a[36:39], v224, s[8:11], s28 offen offset:1024 sc1
v_mfma_f32_16x16x32_bf16 v[168:171], a[144:147], a[80:83], v[168:171]
ds_read_b64_tr_b16 a[132:133], v235 offset:7360
v_mfma_f32_16x16x32_bf16 v[168:171], a[148:151], a[84:87], v[168:171]
v_mfma_f32_16x16x32_bf16 v[172:175], a[148:151], a[92:95], v[172:175]
ds_read_b64_tr_b16 a[134:135], v235 offset:9152
v_mfma_f32_16x16x32_bf16 v[172:175], a[144:147], a[88:91], v[172:175]
s_waitcnt lgkmcnt(4)
v_mfma_f32_16x16x32_bf16 v[188:191], a[152:155], a[88:91], v[188:191]
ds_read_b64_tr_b16 a[136:137], v235 offset:14528
v_mfma_f32_16x16x32_bf16 v[188:191], a[156:159], a[92:95], v[188:191]
buffer_load_dwordx4 a[44:47], v225, s[8:11], s28 offen offset:1024 sc1
v_mfma_f32_16x16x32_bf16 v[184:187], a[156:159], a[84:87], v[184:187]
ds_read_b64_tr_b16 a[138:139], v235 offset:16320
v_mfma_f32_16x16x32_bf16 v[184:187], a[152:155], a[80:83], v[184:187]
v_mfma_f32_16x16x32_bf16 v[180:183], a[152:155], a[72:75], v[180:183]
ds_read_b64_tr_b16 a[140:141], v235 offset:21696
v_mfma_f32_16x16x32_bf16 v[180:183], a[156:159], a[76:79], v[180:183]
v_mfma_f32_16x16x32_bf16 v[176:179], a[156:159], a[68:71], v[176:179]
ds_read_b64_tr_b16 a[142:143], v235 offset:23488
v_mfma_f32_16x16x32_bf16 v[176:179], a[152:155], a[64:67], v[176:179]
s_waitcnt lgkmcnt(4)
v_mfma_f32_16x16x32_bf16 v[192:195], a[128:131], a[64:67], v[192:195]
ds_read_b64_tr_b16 a[144:145], v235 offset:28672
v_mfma_f32_16x16x32_bf16 v[192:195], a[132:135], a[68:71], v[192:195]
buffer_load_dwordx4 a[52:55], v226, s[8:11], s28 offen offset:1024 sc1
v_mfma_f32_16x16x32_bf16 v[196:199], a[132:135], a[76:79], v[196:199]
ds_read_b64_tr_b16 a[146:147], v235 offset:30464
v_mfma_f32_16x16x32_bf16 v[196:199], a[128:131], a[72:75], v[196:199]
v_mfma_f32_16x16x32_bf16 v[200:203], a[128:131], a[80:83], v[200:203]
ds_read_b64_tr_b16 a[148:149], v235 offset:35840
v_mfma_f32_16x16x32_bf16 v[200:203], a[132:135], a[84:87], v[200:203]
v_mfma_f32_16x16x32_bf16 v[204:207], a[132:135], a[92:95], v[204:207]
ds_read_b64_tr_b16 a[150:151], v235 offset:37632
v_mfma_f32_16x16x32_bf16 v[204:207], a[128:131], a[88:91], v[204:207]
s_waitcnt lgkmcnt(4)
v_mfma_f32_16x16x32_bf16 v[220:223], a[136:139], a[88:91], v[220:223]
ds_read_b64_tr_b16 a[152:153], v235 offset:43008
v_mfma_f32_16x16x32_bf16 v[220:223], a[140:143], a[92:95], v[220:223]
buffer_load_dwordx4 a[60:63], v227, s[8:11], s28 offen offset:1024 sc1
v_mfma_f32_16x16x32_bf16 v[216:219], a[140:143], a[84:87], v[216:219]
ds_read_b64_tr_b16 a[154:155], v235 offset:44800
s_add_u32 s28, s28, 2048
v_mfma_f32_16x16x32_bf16 v[216:219], a[136:139], a[80:83], v[216:219]
v_mfma_f32_16x16x32_bf16 v[212:215], a[136:139], a[72:75], v[212:215]
ds_read_b64_tr_b16 a[156:157], v235 offset:50176
v_mfma_f32_16x16x32_bf16 v[212:215], a[140:143], a[76:79], v[212:215]
v_mfma_f32_16x16x32_bf16 v[208:211], a[140:143], a[68:71], v[208:211]
ds_read_b64_tr_b16 a[158:159], v235 offset:51968
v_mfma_f32_16x16x32_bf16 v[208:211], a[136:139], a[64:67], v[208:211]
s_waitcnt vmcnt(30) lgkmcnt(4)
v_mfma_f32_16x16x32_bf16 v[0:3], a[144:147], a[96:99], v[0:3]
ds_read_b64_tr_b16 a[128:129], v235 offset:28704
v_mfma_f32_16x16x32_bf16 v[0:3], a[148:151], a[100:103], v[0:3]
s_waitcnt vmcnt(23)
s_barrier
v_mfma_f32_16x16x32_bf16 v[4:7], a[148:151], a[108:111], v[4:7]
ds_read_b64_tr_b16 a[130:131], v235 offset:30496
s_add_u32 m0, s3, 0
v_mfma_f32_16x16x32_bf16 v[4:7], a[144:147], a[104:107], v[4:7]
buffer_load_dwordx4 v228, s[12:15], s52 offen offset:0  lds
v_mfma_f32_16x16x32_bf16 v[8:11], a[144:147], a[112:115], v[8:11]
ds_read_b64_tr_b16 a[132:133], v235 offset:35872
v_mfma_f32_16x16x32_bf16 v[8:11], a[148:151], a[116:119], v[8:11]
v_mfma_f32_16x16x32_bf16 v[12:15], a[148:151], a[124:127], v[12:15]
ds_read_b64_tr_b16 a[134:135], v235 offset:37664
v_mfma_f32_16x16x32_bf16 v[12:15], a[144:147], a[120:123], v[12:15]
s_waitcnt lgkmcnt(4)
v_mfma_f32_16x16x32_bf16 v[28:31], a[152:155], a[120:123], v[28:31]
ds_read_b64_tr_b16 a[136:137], v235 offset:43040
v_mfma_f32_16x16x32_bf16 v[28:31], a[156:159], a[124:127], v[28:31]
buffer_load_dwordx4 v229, s[12:15], s52 offen offset:1024  lds
v_mfma_f32_16x16x32_bf16 v[24:27], a[156:159], a[116:119], v[24:27]
ds_read_b64_tr_b16 a[138:139], v235 offset:44832
v_mfma_f32_16x16x32_bf16 v[24:27], a[152:155], a[112:115], v[24:27]
v_mfma_f32_16x16x32_bf16 v[20:23], a[152:155], a[104:107], v[20:23]
ds_read_b64_tr_b16 a[140:141], v235 offset:50208
v_mfma_f32_16x16x32_bf16 v[20:23], a[156:159], a[108:111], v[20:23]
v_mfma_f32_16x16x32_bf16 v[16:19], a[156:159], a[100:103], v[16:19]
ds_read_b64_tr_b16 a[142:143], v235 offset:52000
v_mfma_f32_16x16x32_bf16 v[16:19], a[152:155], a[96:99], v[16:19]
s_waitcnt lgkmcnt(4)
v_mfma_f32_16x16x32_bf16 v[32:35], a[128:131], a[96:99], v[32:35]
ds_read_b64_tr_b16 a[144:145], v235 offset:28736
v_mfma_f32_16x16x32_bf16 v[32:35], a[132:135], a[100:103], v[32:35]
buffer_load_dwordx4 v230, s[12:15], s52 offen offset:2048  lds
v_mfma_f32_16x16x32_bf16 v[36:39], a[132:135], a[108:111], v[36:39]
ds_read_b64_tr_b16 a[146:147], v235 offset:30528
v_mfma_f32_16x16x32_bf16 v[36:39], a[128:131], a[104:107], v[36:39]
v_mfma_f32_16x16x32_bf16 v[40:43], a[128:131], a[112:115], v[40:43]
ds_read_b64_tr_b16 a[148:149], v235 offset:35904
v_mfma_f32_16x16x32_bf16 v[40:43], a[132:135], a[116:119], v[40:43]
buffer_load_dwordx4 v231, s[12:15], s52 offen offset:3072  lds
v_mfma_f32_16x16x32_bf16 v[44:47], a[132:135], a[124:127], v[44:47]
ds_read_b64_tr_b16 a[150:151], v235 offset:37696
s_add_u32 m0, s3, 4096
v_mfma_f32_16x16x32_bf16 v[44:47], a[128:131], a[120:123], v[44:47]
s_waitcnt lgkmcnt(4)
v_mfma_f32_16x16x32_bf16 v[60:63], a[136:139], a[120:123], v[60:63]
ds_read_b64_tr_b16 a[152:153], v235 offset:43072
v_mfma_f32_16x16x32_bf16 v[60:63], a[140:143], a[124:127], v[60:63]
v_mfma_f32_16x16x32_bf16 v[56:59], a[140:143], a[116:119], v[56:59]
ds_read_b64_tr_b16 a[154:155], v235 offset:44864
v_mfma_f32_16x16x32_bf16 v[56:59], a[136:139], a[112:115], v[56:59]
buffer_load_dwordx4 v232, s[12:15], s52 offen offset:0  lds
v_mfma_f32_16x16x32_bf16 v[52:55], a[136:139], a[104:107], v[52:55]
ds_read_b64_tr_b16 a[156:157], v235 offset:50240
v_mfma_f32_16x16x32_bf16 v[52:55], a[140:143], a[108:111], v[52:55]
v_mfma_f32_16x16x32_bf16 v[48:51], a[140:143], a[100:103], v[48:51]
ds_read_b64_tr_b16 a[158:159], v235 offset:52032
v_mfma_f32_16x16x32_bf16 v[48:51], a[136:139], a[96:99], v[48:51]
s_waitcnt lgkmcnt(4)
v_mfma_f32_16x16x32_bf16 v[64:67], a[144:147], a[96:99], v[64:67]
ds_read_b64_tr_b16 a[128:129], v235 offset:28768
v_mfma_f32_16x16x32_bf16 v[64:67], a[148:151], a[100:103], v[64:67]
v_mfma_f32_16x16x32_bf16 v[68:71], a[148:151], a[108:111], v[68:71]
ds_read_b64_tr_b16 a[130:131], v235 offset:30560
v_mfma_f32_16x16x32_bf16 v[68:71], a[144:147], a[104:107], v[68:71]
buffer_load_dwordx4 v233, s[12:15], s52 offen offset:1024  lds
v_mfma_f32_16x16x32_bf16 v[72:75], a[144:147], a[112:115], v[72:75]
ds_read_b64_tr_b16 a[132:133], v235 offset:35936
v_mfma_f32_16x16x32_bf16 v[72:75], a[148:151], a[116:119], v[72:75]
v_mfma_f32_16x16x32_bf16 v[76:79], a[148:151], a[124:127], v[76:79]
ds_read_b64_tr_b16 a[134:135], v235 offset:37728
v_mfma_f32_16x16x32_bf16 v[76:79], a[144:147], a[120:123], v[76:79]
s_waitcnt lgkmcnt(4)
v_mfma_f32_16x16x32_bf16 v[92:95], a[152:155], a[120:123], v[92:95]
ds_read_b64_tr_b16 a[136:137], v235 offset:43104
v_mfma_f32_16x16x32_bf16 v[92:95], a[156:159], a[124:127], v[92:95]
buffer_load_dwordx4 v234, s[12:15], s52 offen offset:2048  lds
v_mfma_f32_16x16x32_bf16 v[88:91], a[156:159], a[116:119], v[88:91]
ds_read_b64_tr_b16 a[138:139], v235 offset:44896
s_add_u32 s52, s52, 458752
v_mfma_f32_16x16x32_bf16 v[88:91], a[152:155], a[112:115], v[88:91]
v_mfma_f32_16x16x32_bf16 v[84:87], a[152:155], a[104:107], v[84:87]
ds_read_b64_tr_b16 a[140:141], v235 offset:50272
v_mfma_f32_16x16x32_bf16 v[84:87], a[156:159], a[108:111], v[84:87]
v_mfma_f32_16x16x32_bf16 v[80:83], a[156:159], a[100:103], v[80:83]
ds_read_b64_tr_b16 a[142:143], v235 offset:52064
v_mfma_f32_16x16x32_bf16 v[80:83], a[152:155], a[96:99], v[80:83]
s_waitcnt lgkmcnt(4)
v_mfma_f32_16x16x32_bf16 v[96:99], a[128:131], a[96:99], v[96:99]
ds_read_b64_tr_b16 a[144:145], v235 offset:28800
v_mfma_f32_16x16x32_bf16 v[96:99], a[132:135], a[100:103], v[96:99]
buffer_load_dwordx4 a[64:67], v224, s[8:11], s28 offen offset:0 sc1
v_mfma_f32_16x16x32_bf16 v[100:103], a[132:135], a[108:111], v[100:103]
ds_read_b64_tr_b16 a[146:147], v235 offset:30592
v_mfma_f32_16x16x32_bf16 v[100:103], a[128:131], a[104:107], v[100:103]
v_mfma_f32_16x16x32_bf16 v[104:107], a[128:131], a[112:115], v[104:107]
ds_read_b64_tr_b16 a[148:149], v235 offset:35968
v_mfma_f32_16x16x32_bf16 v[104:107], a[132:135], a[116:119], v[104:107]
buffer_load_dwordx4 a[72:75], v225, s[8:11], s28 offen offset:0 sc1
v_mfma_f32_16x16x32_bf16 v[108:111], a[132:135], a[124:127], v[108:111]
ds_read_b64_tr_b16 a[150:151], v235 offset:37760
v_mfma_f32_16x16x32_bf16 v[108:111], a[128:131], a[120:123], v[108:111]
s_waitcnt lgkmcnt(4)
v_mfma_f32_16x16x32_bf16 v[124:127], a[136:139], a[120:123], v[124:127]
ds_read_b64_tr_b16 a[152:153], v235 offset:43136
v_mfma_f32_16x16x32_bf16 v[124:127], a[140:143], a[124:127], v[124:127]
v_mfma_f32_16x16x32_bf16 v[120:123], a[140:143], a[116:119], v[120:123]
ds_read_b64_tr_b16 a[154:155], v235 offset:44928
v_mfma_f32_16x16x32_bf16 v[120:123], a[136:139], a[112:115], v[120:123]
buffer_load_dwordx4 a[80:83], v226, s[8:11], s28 offen offset:0 sc1
v_mfma_f32_16x16x32_bf16 v[116:119], a[136:139], a[104:107], v[116:119]
ds_read_b64_tr_b16 a[156:157], v235 offset:50304
v_mfma_f32_16x16x32_bf16 v[116:119], a[140:143], a[108:111], v[116:119]
v_mfma_f32_16x16x32_bf16 v[112:115], a[140:143], a[100:103], v[112:115]
ds_read_b64_tr_b16 a[158:159], v235 offset:52096
v_mfma_f32_16x16x32_bf16 v[112:115], a[136:139], a[96:99], v[112:115]
s_waitcnt lgkmcnt(4)
v_mfma_f32_16x16x32_bf16 v[128:131], a[144:147], a[96:99], v[128:131]
ds_read_b64_tr_b16 a[128:129], v235 offset:28832
v_mfma_f32_16x16x32_bf16 v[128:131], a[148:151], a[100:103], v[128:131]
v_mfma_f32_16x16x32_bf16 v[132:135], a[148:151], a[108:111], v[132:135]
ds_read_b64_tr_b16 a[130:131], v235 offset:30624
v_mfma_f32_16x16x32_bf16 v[132:135], a[144:147], a[104:107], v[132:135]
buffer_load_dwordx4 a[88:91], v227, s[8:11], s28 offen offset:0 sc1
v_mfma_f32_16x16x32_bf16 v[136:139], a[144:147], a[112:115], v[136:139]
ds_read_b64_tr_b16 a[132:133], v235 offset:36000
v_mfma_f32_16x16x32_bf16 v[136:139], a[148:151], a[116:119], v[136:139]
v_mfma_f32_16x16x32_bf16 v[140:143], a[148:151], a[124:127], v[140:143]
ds_read_b64_tr_b16 a[134:135], v235 offset:37792
v_mfma_f32_16x16x32_bf16 v[140:143], a[144:147], a[120:123], v[140:143]
s_waitcnt lgkmcnt(4)
v_mfma_f32_16x16x32_bf16 v[156:159], a[152:155], a[120:123], v[156:159]
ds_read_b64_tr_b16 a[136:137], v235 offset:43168
v_mfma_f32_16x16x32_bf16 v[156:159], a[156:159], a[124:127], v[156:159]
buffer_load_dwordx4 a[68:71], v224, s[8:11], s28 offen offset:1024 sc1
v_mfma_f32_16x16x32_bf16 v[152:155], a[156:159], a[116:119], v[152:155]
ds_read_b64_tr_b16 a[138:139], v235 offset:44960
v_mfma_f32_16x16x32_bf16 v[152:155], a[152:155], a[112:115], v[152:155]
v_mfma_f32_16x16x32_bf16 v[148:151], a[152:155], a[104:107], v[148:151]
ds_read_b64_tr_b16 a[140:141], v235 offset:50336
v_mfma_f32_16x16x32_bf16 v[148:151], a[156:159], a[108:111], v[148:151]
v_mfma_f32_16x16x32_bf16 v[144:147], a[156:159], a[100:103], v[144:147]
ds_read_b64_tr_b16 a[142:143], v235 offset:52128
v_mfma_f32_16x16x32_bf16 v[144:147], a[152:155], a[96:99], v[144:147]
s_waitcnt lgkmcnt(4)
v_mfma_f32_16x16x32_bf16 v[160:163], a[128:131], a[96:99], v[160:163]
ds_read_b64_tr_b16 a[144:145], v235 offset:28864
v_mfma_f32_16x16x32_bf16 v[160:163], a[132:135], a[100:103], v[160:163]
buffer_load_dwordx4 a[76:79], v225, s[8:11], s28 offen offset:1024 sc1
v_mfma_f32_16x16x32_bf16 v[164:167], a[132:135], a[108:111], v[164:167]
ds_read_b64_tr_b16 a[146:147], v235 offset:30656
v_mfma_f32_16x16x32_bf16 v[164:167], a[128:131], a[104:107], v[164:167]
v_mfma_f32_16x16x32_bf16 v[168:171], a[128:131], a[112:115], v[168:171]
ds_read_b64_tr_b16 a[148:149], v235 offset:36032
v_mfma_f32_16x16x32_bf16 v[168:171], a[132:135], a[116:119], v[168:171]
buffer_load_dwordx4 a[84:87], v226, s[8:11], s28 offen offset:1024 sc1
v_mfma_f32_16x16x32_bf16 v[172:175], a[132:135], a[124:127], v[172:175]
ds_read_b64_tr_b16 a[150:151], v235 offset:37824
v_mfma_f32_16x16x32_bf16 v[172:175], a[128:131], a[120:123], v[172:175]
s_waitcnt lgkmcnt(4)
v_mfma_f32_16x16x32_bf16 v[188:191], a[136:139], a[120:123], v[188:191]
ds_read_b64_tr_b16 a[152:153], v235 offset:43200
v_mfma_f32_16x16x32_bf16 v[188:191], a[140:143], a[124:127], v[188:191]
v_mfma_f32_16x16x32_bf16 v[184:187], a[140:143], a[116:119], v[184:187]
ds_read_b64_tr_b16 a[154:155], v235 offset:44992
v_mfma_f32_16x16x32_bf16 v[184:187], a[136:139], a[112:115], v[184:187]
buffer_load_dwordx4 a[92:95], v227, s[8:11], s28 offen offset:1024 sc1
v_mfma_f32_16x16x32_bf16 v[180:183], a[136:139], a[104:107], v[180:183]
ds_read_b64_tr_b16 a[156:157], v235 offset:50368
s_add_u32 s28, s28, 2048
v_mfma_f32_16x16x32_bf16 v[180:183], a[140:143], a[108:111], v[180:183]
v_mfma_f32_16x16x32_bf16 v[176:179], a[140:143], a[100:103], v[176:179]
ds_read_b64_tr_b16 a[158:159], v235 offset:52160
v_mfma_f32_16x16x32_bf16 v[176:179], a[136:139], a[96:99], v[176:179]
s_waitcnt lgkmcnt(4)
v_mfma_f32_16x16x32_bf16 v[192:195], a[144:147], a[96:99], v[192:195]
ds_read_b64_tr_b16 a[128:129], v236 offset:28672
v_mfma_f32_16x16x32_bf16 v[192:195], a[148:151], a[100:103], v[192:195]
v_mfma_f32_16x16x32_bf16 v[196:199], a[148:151], a[108:111], v[196:199]
ds_read_b64_tr_b16 a[130:131], v236 offset:30464
v_mfma_f32_16x16x32_bf16 v[196:199], a[144:147], a[104:107], v[196:199]
v_mfma_f32_16x16x32_bf16 v[200:203], a[144:147], a[112:115], v[200:203]
ds_read_b64_tr_b16 a[132:133], v236 offset:35840
v_mfma_f32_16x16x32_bf16 v[200:203], a[148:151], a[116:119], v[200:203]
v_mfma_f32_16x16x32_bf16 v[204:207], a[148:151], a[124:127], v[204:207]
ds_read_b64_tr_b16 a[134:135], v236 offset:37632
v_mfma_f32_16x16x32_bf16 v[204:207], a[144:147], a[120:123], v[204:207]
s_waitcnt lgkmcnt(4)
v_mfma_f32_16x16x32_bf16 v[220:223], a[152:155], a[120:123], v[220:223]
ds_read_b64_tr_b16 a[136:137], v236 offset:43008
v_mfma_f32_16x16x32_bf16 v[220:223], a[156:159], a[124:127], v[220:223]
v_mfma_f32_16x16x32_bf16 v[216:219], a[156:159], a[116:119], v[216:219]
ds_read_b64_tr_b16 a[138:139], v236 offset:44800
v_mfma_f32_16x16x32_bf16 v[216:219], a[152:155], a[112:115], v[216:219]
v_mfma_f32_16x16x32_bf16 v[212:215], a[152:155], a[104:107], v[212:215]
ds_read_b64_tr_b16 a[140:141], v236 offset:50176
v_mfma_f32_16x16x32_bf16 v[212:215], a[156:159], a[108:111], v[212:215]
v_mfma_f32_16x16x32_bf16 v[208:211], a[156:159], a[100:103], v[208:211]
ds_read_b64_tr_b16 a[142:143], v236 offset:51968
v_mfma_f32_16x16x32_bf16 v[208:211], a[152:155], a[96:99], v[208:211]
s_waitcnt vmcnt(30) lgkmcnt(4)
v_mfma_f32_16x16x32_bf16 v[0:3], a[128:131], a[0:3], v[0:3]
ds_read_b64_tr_b16 a[144:145], v236 offset:28704
v_mfma_f32_16x16x32_bf16 v[0:3], a[132:135], a[4:7], v[0:3]
s_waitcnt vmcnt(23)
s_barrier
v_mfma_f32_16x16x32_bf16 v[4:7], a[132:135], a[12:15], v[4:7]
ds_read_b64_tr_b16 a[146:147], v236 offset:30496
s_add_u32 m0, s3, 28672
v_mfma_f32_16x16x32_bf16 v[4:7], a[128:131], a[8:11], v[4:7]
buffer_load_dwordx4 v228, s[12:15], s52 offen offset:0  lds
v_mfma_f32_16x16x32_bf16 v[8:11], a[128:131], a[16:19], v[8:11]
ds_read_b64_tr_b16 a[148:149], v236 offset:35872
v_mfma_f32_16x16x32_bf16 v[8:11], a[132:135], a[20:23], v[8:11]
v_mfma_f32_16x16x32_bf16 v[12:15], a[132:135], a[28:31], v[12:15]
ds_read_b64_tr_b16 a[150:151], v236 offset:37664
v_mfma_f32_16x16x32_bf16 v[12:15], a[128:131], a[24:27], v[12:15]
s_waitcnt lgkmcnt(4)
v_mfma_f32_16x16x32_bf16 v[28:31], a[136:139], a[24:27], v[28:31]
ds_read_b64_tr_b16 a[152:153], v236 offset:43040
v_mfma_f32_16x16x32_bf16 v[28:31], a[140:143], a[28:31], v[28:31]
buffer_load_dwordx4 v229, s[12:15], s52 offen offset:1024  lds
v_mfma_f32_16x16x32_bf16 v[24:27], a[140:143], a[20:23], v[24:27]
ds_read_b64_tr_b16 a[154:155], v236 offset:44832
v_mfma_f32_16x16x32_bf16 v[24:27], a[136:139], a[16:19], v[24:27]
v_mfma_f32_16x16x32_bf16 v[20:23], a[136:139], a[8:11], v[20:23]
ds_read_b64_tr_b16 a[156:157], v236 offset:50208
v_mfma_f32_16x16x32_bf16 v[20:23], a[140:143], a[12:15], v[20:23]
buffer_load_dwordx4 v230, s[12:15], s52 offen offset:2048  lds
v_mfma_f32_16x16x32_bf16 v[16:19], a[140:143], a[4:7], v[16:19]
ds_read_b64_tr_b16 a[158:159], v236 offset:52000
v_mfma_f32_16x16x32_bf16 v[16:19], a[136:139], a[0:3], v[16:19]
s_waitcnt lgkmcnt(4)
v_mfma_f32_16x16x32_bf16 v[32:35], a[144:147], a[0:3], v[32:35]
ds_read_b64_tr_b16 a[128:129], v236 offset:28736
v_mfma_f32_16x16x32_bf16 v[32:35], a[148:151], a[4:7], v[32:35]
buffer_load_dwordx4 v231, s[12:15], s52 offen offset:3072  lds
v_mfma_f32_16x16x32_bf16 v[36:39], a[148:151], a[12:15], v[36:39]
ds_read_b64_tr_b16 a[130:131], v236 offset:30528
s_add_u32 m0, s3, 32768
v_mfma_f32_16x16x32_bf16 v[36:39], a[144:147], a[8:11], v[36:39]
v_mfma_f32_16x16x32_bf16 v[40:43], a[144:147], a[16:19], v[40:43]
ds_read_b64_tr_b16 a[132:133], v236 offset:35904
v_mfma_f32_16x16x32_bf16 v[40:43], a[148:151], a[20:23], v[40:43]
v_mfma_f32_16x16x32_bf16 v[44:47], a[148:151], a[28:31], v[44:47]
ds_read_b64_tr_b16 a[134:135], v236 offset:37696
v_mfma_f32_16x16x32_bf16 v[44:47], a[144:147], a[24:27], v[44:47]
s_waitcnt lgkmcnt(4)
v_mfma_f32_16x16x32_bf16 v[60:63], a[152:155], a[24:27], v[60:63]
ds_read_b64_tr_b16 a[136:137], v236 offset:43072
v_mfma_f32_16x16x32_bf16 v[60:63], a[156:159], a[28:31], v[60:63]
buffer_load_dwordx4 v232, s[12:15], s52 offen offset:0  lds
v_mfma_f32_16x16x32_bf16 v[56:59], a[156:159], a[20:23], v[56:59]
ds_read_b64_tr_b16 a[138:139], v236 offset:44864
v_mfma_f32_16x16x32_bf16 v[56:59], a[152:155], a[16:19], v[56:59]
v_mfma_f32_16x16x32_bf16 v[52:55], a[152:155], a[8:11], v[52:55]
ds_read_b64_tr_b16 a[140:141], v236 offset:50240
v_mfma_f32_16x16x32_bf16 v[52:55], a[156:159], a[12:15], v[52:55]
buffer_load_dwordx4 v233, s[12:15], s52 offen offset:1024  lds
v_mfma_f32_16x16x32_bf16 v[48:51], a[156:159], a[4:7], v[48:51]
ds_read_b64_tr_b16 a[142:143], v236 offset:52032
v_mfma_f32_16x16x32_bf16 v[48:51], a[152:155], a[0:3], v[48:51]
s_waitcnt lgkmcnt(4)
v_mfma_f32_16x16x32_bf16 v[64:67], a[128:131], a[0:3], v[64:67]
ds_read_b64_tr_b16 a[144:145], v236 offset:28768
v_mfma_f32_16x16x32_bf16 v[64:67], a[132:135], a[4:7], v[64:67]
buffer_load_dwordx4 v234, s[12:15], s52 offen offset:2048  lds
v_mfma_f32_16x16x32_bf16 v[68:71], a[132:135], a[12:15], v[68:71]
ds_read_b64_tr_b16 a[146:147], v236 offset:30560
s_add_u32 s52, s52, 458752
v_mfma_f32_16x16x32_bf16 v[68:71], a[128:131], a[8:11], v[68:71]
v_mfma_f32_16x16x32_bf16 v[72:75], a[128:131], a[16:19], v[72:75]
ds_read_b64_tr_b16 a[148:149], v236 offset:35936
v_mfma_f32_16x16x32_bf16 v[72:75], a[132:135], a[20:23], v[72:75]
v_mfma_f32_16x16x32_bf16 v[76:79], a[132:135], a[28:31], v[76:79]
ds_read_b64_tr_b16 a[150:151], v236 offset:37728
v_mfma_f32_16x16x32_bf16 v[76:79], a[128:131], a[24:27], v[76:79]
s_waitcnt lgkmcnt(4)
v_mfma_f32_16x16x32_bf16 v[92:95], a[136:139], a[24:27], v[92:95]
ds_read_b64_tr_b16 a[152:153], v236 offset:43104
v_mfma_f32_16x16x32_bf16 v[92:95], a[140:143], a[28:31], v[92:95]
buffer_load_dwordx4 a[96:99], v224, s[8:11], s28 offen offset:0 sc1
v_mfma_f32_16x16x32_bf16 v[88:91], a[140:143], a[20:23], v[88:91]
ds_read_b64_tr_b16 a[154:155], v236 offset:44896
v_mfma_f32_16x16x32_bf16 v[88:91], a[136:139], a[16:19], v[88:91]
v_mfma_f32_16x16x32_bf16 v[84:87], a[136:139], a[8:11], v[84:87]
ds_read_b64_tr_b16 a[156:157], v236 offset:50272
v_mfma_f32_16x16x32_bf16 v[84:87], a[140:143], a[12:15], v[84:87]
buffer_load_dwordx4 a[104:107], v225, s[8:11], s28 offen offset:0 sc1
v_mfma_f32_16x16x32_bf16 v[80:83], a[140:143], a[4:7], v[80:83]
ds_read_b64_tr_b16 a[158:159], v236 offset:52064
v_mfma_f32_16x16x32_bf16 v[80:83], a[136:139], a[0:3], v[80:83]
s_waitcnt lgkmcnt(4)
v_mfma_f32_16x16x32_bf16 v[96:99], a[144:147], a[0:3], v[96:99]
ds_read_b64_tr_b16 a[128:129], v236 offset:28800
v_mfma_f32_16x16x32_bf16 v[96:99], a[148:151], a[4:7], v[96:99]
buffer_load_dwordx4 a[112:115], v226, s[8:11], s28 offen offset:0 sc1
v_mfma_f32_16x16x32_bf16 v[100:103], a[148:151], a[12:15], v[100:103]
ds_read_b64_tr_b16 a[130:131], v236 offset:30592
v_mfma_f32_16x16x32_bf16 v[100:103], a[144:147], a[8:11], v[100:103]
v_mfma_f32_16x16x32_bf16 v[104:107], a[144:147], a[16:19], v[104:107]
ds_read_b64_tr_b16 a[132:133], v236 offset:35968
v_mfma_f32_16x16x32_bf16 v[104:107], a[148:151], a[20:23], v[104:107]
v_mfma_f32_16x16x32_bf16 v[108:111], a[148:151], a[28:31], v[108:111]
ds_read_b64_tr_b16 a[134:135], v236 offset:37760
v_mfma_f32_16x16x32_bf16 v[108:111], a[144:147], a[24:27], v[108:111]
s_waitcnt lgkmcnt(4)
v_mfma_f32_16x16x32_bf16 v[124:127], a[152:155], a[24:27], v[124:127]
ds_read_b64_tr_b16 a[136:137], v236 offset:43136
v_mfma_f32_16x16x32_bf16 v[124:127], a[156:159], a[28:31], v[124:127]
buffer_load_dwordx4 a[120:123], v227, s[8:11], s28 offen offset:0 sc1
v_mfma_f32_16x16x32_bf16 v[120:123], a[156:159], a[20:23], v[120:123]
ds_read_b64_tr_b16 a[138:139], v236 offset:44928
v_mfma_f32_16x16x32_bf16 v[120:123], a[152:155], a[16:19], v[120:123]
v_mfma_f32_16x16x32_bf16 v[116:119], a[152:155], a[8:11], v[116:119]
ds_read_b64_tr_b16 a[140:141], v236 offset:50304
v_mfma_f32_16x16x32_bf16 v[116:119], a[156:159], a[12:15], v[116:119]
buffer_load_dwordx4 a[100:103], v224, s[8:11], s28 offen offset:1024 sc1
v_mfma_f32_16x16x32_bf16 v[112:115], a[156:159], a[4:7], v[112:115]
ds_read_b64_tr_b16 a[142:143], v236 offset:52096
v_mfma_f32_16x16x32_bf16 v[112:115], a[152:155], a[0:3], v[112:115]
s_waitcnt lgkmcnt(4)
v_mfma_f32_16x16x32_bf16 v[128:131], a[128:131], a[0:3], v[128:131]
ds_read_b64_tr_b16 a[144:145], v236 offset:28832
v_mfma_f32_16x16x32_bf16 v[128:131], a[132:135], a[4:7], v[128:131]
v_mfma_f32_16x16x32_bf16 v[132:135], a[132:135], a[12:15], v[132:135]
ds_read_b64_tr_b16 a[146:147], v236 offset:30624
v_mfma_f32_16x16x32_bf16 v[132:135], a[128:131], a[8:11], v[132:135]
buffer_load_dwordx4 a[108:111], v225, s[8:11], s28 offen offset:1024 sc1
v_mfma_f32_16x16x32_bf16 v[136:139], a[128:131], a[16:19], v[136:139]
ds_read_b64_tr_b16 a[148:149], v236 offset:36000
v_mfma_f32_16x16x32_bf16 v[136:139], a[132:135], a[20:23], v[136:139]
v_mfma_f32_16x16x32_bf16 v[140:143], a[132:135], a[28:31], v[140:143]
ds_read_b64_tr_b16 a[150:151], v236 offset:37792
v_mfma_f32_16x16x32_bf16 v[140:143], a[128:131], a[24:27], v[140:143]
s_waitcnt lgkmcnt(4)
v_mfma_f32_16x16x32_bf16 v[156:159], a[136:139], a[24:27], v[156:159]
ds_read_b64_tr_b16 a[152:153], v236 offset:43168
v_mfma_f32_16x16x32_bf16 v[156:159], a[140:143], a[28:31], v[156:159]
buffer_load_dwordx4 a[116:119], v226, s[8:11], s28 offen offset:1024 sc1
v_mfma_f32_16x16x32_bf16 v[152:155], a[140:143], a[20:23], v[152:155]
ds_read_b64_tr_b16 a[154:155], v236 offset:44960
v_mfma_f32_16x16x32_bf16 v[152:155], a[136:139], a[16:19], v[152:155]
v_mfma_f32_16x16x32_bf16 v[148:151], a[136:139], a[8:11], v[148:151]
ds_read_b64_tr_b16 a[156:157], v236 offset:50336
v_mfma_f32_16x16x32_bf16 v[148:151], a[140:143], a[12:15], v[148:151]
buffer_load_dwordx4 a[124:127], v227, s[8:11], s28 offen offset:1024 sc1
v_mfma_f32_16x16x32_bf16 v[144:147], a[140:143], a[4:7], v[144:147]
ds_read_b64_tr_b16 a[158:159], v236 offset:52128
s_add_u32 s28, s28, 2048
v_mfma_f32_16x16x32_bf16 v[144:147], a[136:139], a[0:3], v[144:147]
s_waitcnt lgkmcnt(4)
v_mfma_f32_16x16x32_bf16 v[160:163], a[144:147], a[0:3], v[160:163]
ds_read_b64_tr_b16 a[128:129], v236 offset:28864
s_add_u32 s53, s98, 4194304
v_mfma_f32_16x16x32_bf16 v[160:163], a[148:151], a[4:7], v[160:163]
v_mfma_f32_16x16x32_bf16 v[164:167], a[148:151], a[12:15], v[164:167]
ds_read_b64_tr_b16 a[130:131], v236 offset:30656
v_mfma_f32_16x16x32_bf16 v[164:167], a[144:147], a[8:11], v[164:167]
v_mfma_f32_16x16x32_bf16 v[168:171], a[144:147], a[16:19], v[168:171]
ds_read_b64_tr_b16 a[132:133], v236 offset:36032
v_mfma_f32_16x16x32_bf16 v[168:171], a[148:151], a[20:23], v[168:171]
v_mfma_f32_16x16x32_bf16 v[172:175], a[148:151], a[28:31], v[172:175]
ds_read_b64_tr_b16 a[134:135], v236 offset:37824
v_mfma_f32_16x16x32_bf16 v[172:175], a[144:147], a[24:27], v[172:175]
s_waitcnt lgkmcnt(4)
v_mfma_f32_16x16x32_bf16 v[188:191], a[152:155], a[24:27], v[188:191]
ds_read_b64_tr_b16 a[136:137], v236 offset:43200
v_mfma_f32_16x16x32_bf16 v[188:191], a[156:159], a[28:31], v[188:191]
buffer_load_dword v255, v253, s[20:23], s53 offen
v_mfma_f32_16x16x32_bf16 v[184:187], a[156:159], a[20:23], v[184:187]
ds_read_b64_tr_b16 a[138:139], v236 offset:44992
s_add_u32 s53, s98, 6291456
v_mfma_f32_16x16x32_bf16 v[184:187], a[152:155], a[16:19], v[184:187]
v_mfma_f32_16x16x32_bf16 v[180:183], a[152:155], a[8:11], v[180:183]
ds_read_b64_tr_b16 a[140:141], v236 offset:50368
v_mfma_f32_16x16x32_bf16 v[180:183], a[156:159], a[12:15], v[180:183]
v_mfma_f32_16x16x32_bf16 v[176:179], a[156:159], a[4:7], v[176:179]
ds_read_b64_tr_b16 a[142:143], v236 offset:52160
v_mfma_f32_16x16x32_bf16 v[176:179], a[152:155], a[0:3], v[176:179]
s_waitcnt lgkmcnt(4)
v_mfma_f32_16x16x32_bf16 v[192:195], a[128:131], a[0:3], v[192:195]
ds_read_b64_tr_b16 a[144:145], v236 offset:0
v_mfma_f32_16x16x32_bf16 v[192:195], a[132:135], a[4:7], v[192:195]
buffer_load_dword v255, v253, s[20:23], s53 offen
v_mfma_f32_16x16x32_bf16 v[196:199], a[132:135], a[12:15], v[196:199]
ds_read_b64_tr_b16 a[146:147], v236 offset:1792
v_mfma_f32_16x16x32_bf16 v[196:199], a[128:131], a[8:11], v[196:199]
v_mfma_f32_16x16x32_bf16 v[200:203], a[128:131], a[16:19], v[200:203]
ds_read_b64_tr_b16 a[148:149], v236 offset:7168
v_mfma_f32_16x16x32_bf16 v[200:203], a[132:135], a[20:23], v[200:203]
v_mfma_f32_16x16x32_bf16 v[204:207], a[132:135], a[28:31], v[204:207]
ds_read_b64_tr_b16 a[150:151], v236 offset:8960
v_mfma_f32_16x16x32_bf16 v[204:207], a[128:131], a[24:27], v[204:207]
s_waitcnt lgkmcnt(4)
v_mfma_f32_16x16x32_bf16 v[220:223], a[136:139], a[24:27], v[220:223]
ds_read_b64_tr_b16 a[152:153], v236 offset:14336
v_mfma_f32_16x16x32_bf16 v[220:223], a[140:143], a[28:31], v[220:223]
v_mfma_f32_16x16x32_bf16 v[216:219], a[140:143], a[20:23], v[216:219]
ds_read_b64_tr_b16 a[154:155], v236 offset:16128
v_mfma_f32_16x16x32_bf16 v[216:219], a[136:139], a[16:19], v[216:219]
v_mfma_f32_16x16x32_bf16 v[212:215], a[136:139], a[8:11], v[212:215]
ds_read_b64_tr_b16 a[156:157], v236 offset:21504
v_mfma_f32_16x16x32_bf16 v[212:215], a[140:143], a[12:15], v[212:215]
s_waitcnt vmcnt(10)
s_barrier
v_mfma_f32_16x16x32_bf16 v[208:211], a[140:143], a[4:7], v[208:211]
ds_read_b64_tr_b16 a[158:159], v236 offset:23296
v_mfma_f32_16x16x32_bf16 v[208:211], a[136:139], a[0:3], v[208:211]
s_waitcnt vmcnt(32) lgkmcnt(4)
v_mfma_f32_16x16x32_bf16 v[0:3], a[144:147], a[32:35], v[0:3]
ds_read_b64_tr_b16 a[128:129], v235 offset:0
v_mfma_f32_16x16x32_bf16 v[0:3], a[148:151], a[36:39], v[0:3]
v_mfma_f32_16x16x32_bf16 v[4:7], a[148:151], a[44:47], v[4:7]
ds_read_b64_tr_b16 a[130:131], v235 offset:1792
v_mfma_f32_16x16x32_bf16 v[4:7], a[144:147], a[40:43], v[4:7]
v_mfma_f32_16x16x32_bf16 v[8:11], a[144:147], a[48:51], v[8:11]
ds_read_b64_tr_b16 a[132:133], v235 offset:7168
v_mfma_f32_16x16x32_bf16 v[8:11], a[148:151], a[52:55], v[8:11]
v_mfma_f32_16x16x32_bf16 v[12:15], a[148:151], a[60:63], v[12:15]
ds_read_b64_tr_b16 a[134:135], v235 offset:8960
v_mfma_f32_16x16x32_bf16 v[12:15], a[144:147], a[56:59], v[12:15]
s_waitcnt lgkmcnt(4)
v_mfma_f32_16x16x32_bf16 v[28:31], a[152:155], a[56:59], v[28:31]
ds_read_b64_tr_b16 a[136:137], v235 offset:14336
v_mfma_f32_16x16x32_bf16 v[28:31], a[156:159], a[60:63], v[28:31]
v_mfma_f32_16x16x32_bf16 v[24:27], a[156:159], a[52:55], v[24:27]
ds_read_b64_tr_b16 a[138:139], v235 offset:16128
v_mfma_f32_16x16x32_bf16 v[24:27], a[152:155], a[48:51], v[24:27]
v_mfma_f32_16x16x32_bf16 v[20:23], a[152:155], a[40:43], v[20:23]
ds_read_b64_tr_b16 a[140:141], v235 offset:21504
v_mfma_f32_16x16x32_bf16 v[20:23], a[156:159], a[44:47], v[20:23]
v_mfma_f32_16x16x32_bf16 v[16:19], a[156:159], a[36:39], v[16:19]
ds_read_b64_tr_b16 a[142:143], v235 offset:23296
v_mfma_f32_16x16x32_bf16 v[16:19], a[152:155], a[32:35], v[16:19]
s_waitcnt vmcnt(17) lgkmcnt(4)
v_mfma_f32_16x16x32_bf16 v[0:3], a[128:131], a[64:67], v[0:3]
ds_read_b64_tr_b16 a[144:145], v235 offset:28672
v_mfma_f32_16x16x32_bf16 v[0:3], a[132:135], a[68:71], v[0:3]
v_mfma_f32_16x16x32_bf16 v[4:7], a[132:135], a[76:79], v[4:7]
ds_read_b64_tr_b16 a[146:147], v235 offset:30464
v_mfma_f32_16x16x32_bf16 v[4:7], a[128:131], a[72:75], v[4:7]
v_mfma_f32_16x16x32_bf16 v[8:11], a[128:131], a[80:83], v[8:11]
ds_read_b64_tr_b16 a[148:149], v235 offset:35840
v_mfma_f32_16x16x32_bf16 v[8:11], a[132:135], a[84:87], v[8:11]
v_mfma_f32_16x16x32_bf16 v[12:15], a[132:135], a[92:95], v[12:15]
ds_read_b64_tr_b16 a[150:151], v235 offset:37632
v_mfma_f32_16x16x32_bf16 v[12:15], a[128:131], a[88:91], v[12:15]
s_waitcnt lgkmcnt(4)
v_mfma_f32_16x16x32_bf16 v[28:31], a[136:139], a[88:91], v[28:31]
ds_read_b64_tr_b16 a[152:153], v235 offset:43008
v_mfma_f32_16x16x32_bf16 v[28:31], a[140:143], a[92:95], v[28:31]
v_mfma_f32_16x16x32_bf16 v[24:27], a[140:143], a[84:87], v[24:27]
ds_read_b64_tr_b16 a[154:155], v235 offset:44800
v_mfma_f32_16x16x32_bf16 v[24:27], a[136:139], a[80:83], v[24:27]
v_mfma_f32_16x16x32_bf16 v[20:23], a[136:139], a[72:75], v[20:23]
ds_read_b64_tr_b16 a[156:157], v235 offset:50176
v_mfma_f32_16x16x32_bf16 v[20:23], a[140:143], a[76:79], v[20:23]
v_mfma_f32_16x16x32_bf16 v[16:19], a[140:143], a[68:71], v[16:19]
ds_read_b64_tr_b16 a[158:159], v235 offset:51968
v_mfma_f32_16x16x32_bf16 v[16:19], a[136:139], a[64:67], v[16:19]
s_waitcnt vmcnt(2) lgkmcnt(4)
v_mfma_f32_16x16x32_bf16 v[0:3], a[144:147], a[96:99], v[0:3]
ds_read_b64_tr_b16 a[128:129], v236 offset:32
v_mfma_f32_16x16x32_bf16 v[0:3], a[148:151], a[100:103], v[0:3]
v_mfma_f32_16x16x32_bf16 v[4:7], a[148:151], a[108:111], v[4:7]
ds_read_b64_tr_b16 a[130:131], v236 offset:1824
v_mfma_f32_16x16x32_bf16 v[4:7], a[144:147], a[104:107], v[4:7]
v_mfma_f32_16x16x32_bf16 v[8:11], a[144:147], a[112:115], v[8:11]
ds_read_b64_tr_b16 a[132:133], v236 offset:7200
v_mfma_f32_16x16x32_bf16 v[8:11], a[148:151], a[116:119], v[8:11]
v_mfma_f32_16x16x32_bf16 v[12:15], a[148:151], a[124:127], v[12:15]
ds_read_b64_tr_b16 a[134:135], v236 offset:8992
v_mfma_f32_16x16x32_bf16 v[12:15], a[144:147], a[120:123], v[12:15]
s_waitcnt lgkmcnt(4)
v_mfma_f32_16x16x32_bf16 v[28:31], a[152:155], a[120:123], v[28:31]
ds_read_b64_tr_b16 a[136:137], v236 offset:14368
v_mfma_f32_16x16x32_bf16 v[28:31], a[156:159], a[124:127], v[28:31]
v_mfma_f32_16x16x32_bf16 v[24:27], a[156:159], a[116:119], v[24:27]
ds_read_b64_tr_b16 a[138:139], v236 offset:16160
v_mfma_f32_16x16x32_bf16 v[24:27], a[152:155], a[112:115], v[24:27]
v_mfma_f32_16x16x32_bf16 v[20:23], a[152:155], a[104:107], v[20:23]
ds_read_b64_tr_b16 a[140:141], v236 offset:21536
v_mfma_f32_16x16x32_bf16 v[20:23], a[156:159], a[108:111], v[20:23]
v_mfma_f32_16x16x32_bf16 v[16:19], a[156:159], a[100:103], v[16:19]
ds_read_b64_tr_b16 a[142:143], v236 offset:23328
v_mfma_f32_16x16x32_bf16 v[16:19], a[152:155], a[96:99], v[16:19]
s_waitcnt lgkmcnt(4)
v_mfma_f32_16x16x32_bf16 v[32:35], a[128:131], a[32:35], v[32:35]
ds_read_b64_tr_b16 a[144:145], v235 offset:32
v_mfma_f32_16x16x32_bf16 v[32:35], a[132:135], a[36:39], v[32:35]
v_mul_f32 v8, v8, v24
v_mul_f32 v9, v9, v25
v_mfma_f32_16x16x32_bf16 v[36:39], a[132:135], a[44:47], v[36:39]
ds_read_b64_tr_b16 a[146:147], v235 offset:1824
v_mul_f32 v10, v10, v26
v_mfma_f32_16x16x32_bf16 v[36:39], a[128:131], a[40:43], v[36:39]
v_mul_f32 v11, v11, v27
v_mfma_f32_16x16x32_bf16 v[40:43], a[128:131], a[48:51], v[40:43]
ds_read_b64_tr_b16 a[148:149], v235 offset:7200
v_mul_f32 v12, v12, v28
v_mfma_f32_16x16x32_bf16 v[40:43], a[132:135], a[52:55], v[40:43]
v_mul_f32 v13, v13, v29
v_mfma_f32_16x16x32_bf16 v[44:47], a[132:135], a[60:63], v[44:47]
ds_read_b64_tr_b16 a[150:151], v235 offset:8992
v_mul_f32 v14, v14, v30
v_mfma_f32_16x16x32_bf16 v[44:47], a[128:131], a[56:59], v[44:47]
v_mul_f32 v15, v15, v31
s_waitcnt lgkmcnt(4)
v_mfma_f32_16x16x32_bf16 v[60:63], a[136:139], a[56:59], v[60:63]
ds_read_b64_tr_b16 a[152:153], v235 offset:14368
v_cvt_pk_bf16_f32 v24, v8, v9
v_mfma_f32_16x16x32_bf16 v[60:63], a[140:143], a[60:63], v[60:63]
v_cvt_pk_bf16_f32 v25, v10, v11
v_cvt_pk_bf16_f32 v26, v12, v13
v_mfma_f32_16x16x32_bf16 v[56:59], a[140:143], a[52:55], v[56:59]
ds_read_b64_tr_b16 a[154:155], v235 offset:16160
v_cvt_pk_bf16_f32 v27, v14, v15
v_mfma_f32_16x16x32_bf16 v[56:59], a[136:139], a[48:51], v[56:59]
v_accvgpr_write_b32 a176, v24
v_accvgpr_write_b32 a177, v25
v_mfma_f32_16x16x32_bf16 v[52:55], a[136:139], a[40:43], v[52:55]
ds_read_b64_tr_b16 a[156:157], v235 offset:21536
v_accvgpr_write_b32 a184, v26
v_mfma_f32_16x16x32_bf16 v[52:55], a[140:143], a[44:47], v[52:55]
v_accvgpr_write_b32 a185, v27
v_mfma_f32_16x16x32_bf16 v[48:51], a[140:143], a[36:39], v[48:51]
ds_read_b64_tr_b16 a[158:159], v235 offset:23328
v_mfma_f32_16x16x32_bf16 v[48:51], a[136:139], a[32:35], v[48:51]
s_waitcnt lgkmcnt(4)
v_mfma_f32_16x16x32_bf16 v[32:35], a[144:147], a[64:67], v[32:35]
ds_read_b64_tr_b16 a[128:129], v235 offset:28704
v_mfma_f32_16x16x32_bf16 v[32:35], a[148:151], a[68:71], v[32:35]
v_permlane16_swap_b32 v24, v26
v_mfma_f32_16x16x32_bf16 v[36:39], a[148:151], a[76:79], v[36:39]
ds_read_b64_tr_b16 a[130:131], v235 offset:30496
v_mfma_f32_16x16x32_bf16 v[36:39], a[144:147], a[72:75], v[36:39]
v_permlane16_swap_b32 v25, v27
v_mfma_f32_16x16x32_bf16 v[40:43], a[144:147], a[80:83], v[40:43]
ds_read_b64_tr_b16 a[132:133], v235 offset:35872
v_mfma_f32_16x16x32_bf16 v[40:43], a[148:151], a[84:87], v[40:43]
buffer_store_dwordx4 v[24:27], v249, s[16:19], s5 offen sc1
v_mfma_f32_16x16x32_bf16 v[44:47], a[148:151], a[92:95], v[44:47]
ds_read_b64_tr_b16 a[134:135], v235 offset:37664
v_mul_f32 v0, v0, v16
v_mfma_f32_16x16x32_bf16 v[44:47], a[144:147], a[88:91], v[44:47]
v_mul_f32 v1, v1, v17
s_waitcnt lgkmcnt(4)
v_mfma_f32_16x16x32_bf16 v[60:63], a[152:155], a[88:91], v[60:63]
ds_read_b64_tr_b16 a[136:137], v235 offset:43040
v_mul_f32 v2, v2, v18
v_mfma_f32_16x16x32_bf16 v[60:63], a[156:159], a[92:95], v[60:63]
v_mul_f32 v3, v3, v19
v_mul_f32 v4, v4, v20
v_mfma_f32_16x16x32_bf16 v[56:59], a[156:159], a[84:87], v[56:59]
ds_read_b64_tr_b16 a[138:139], v235 offset:44832
v_mul_f32 v5, v5, v21
v_mfma_f32_16x16x32_bf16 v[56:59], a[152:155], a[80:83], v[56:59]
v_mul_f32 v6, v6, v22
v_mul_f32 v7, v7, v23
v_mfma_f32_16x16x32_bf16 v[52:55], a[152:155], a[72:75], v[52:55]
ds_read_b64_tr_b16 a[140:141], v235 offset:50208
v_cvt_pk_bf16_f32 v16, v0, v1
v_mfma_f32_16x16x32_bf16 v[52:55], a[156:159], a[76:79], v[52:55]
v_cvt_pk_bf16_f32 v17, v2, v3
v_cvt_pk_bf16_f32 v18, v4, v5
v_mfma_f32_16x16x32_bf16 v[48:51], a[156:159], a[68:71], v[48:51]
ds_read_b64_tr_b16 a[142:143], v235 offset:52000
v_cvt_pk_bf16_f32 v19, v6, v7
v_mfma_f32_16x16x32_bf16 v[48:51], a[152:155], a[64:67], v[48:51]
v_accvgpr_write_b32 a160, v16
s_waitcnt lgkmcnt(4)
v_mfma_f32_16x16x32_bf16 v[32:35], a[128:131], a[96:99], v[32:35]
ds_read_b64_tr_b16 a[144:145], v236 offset:64
v_accvgpr_write_b32 a161, v17
v_mfma_f32_16x16x32_bf16 v[32:35], a[132:135], a[100:103], v[32:35]
v_mfma_f32_16x16x32_bf16 v[36:39], a[132:135], a[108:111], v[36:39]
ds_read_b64_tr_b16 a[146:147], v236 offset:1856
v_accvgpr_write_b32 a168, v18
v_mfma_f32_16x16x32_bf16 v[36:39], a[128:131], a[104:107], v[36:39]
v_accvgpr_write_b32 a169, v19
v_mfma_f32_16x16x32_bf16 v[40:43], a[128:131], a[112:115], v[40:43]
ds_read_b64_tr_b16 a[148:149], v236 offset:7232
v_mfma_f32_16x16x32_bf16 v[40:43], a[132:135], a[116:119], v[40:43]
v_permlane16_swap_b32 v16, v18
v_mfma_f32_16x16x32_bf16 v[44:47], a[132:135], a[124:127], v[44:47]
ds_read_b64_tr_b16 a[150:151], v236 offset:9024
v_permlane16_swap_b32 v17, v19
v_mfma_f32_16x16x32_bf16 v[44:47], a[128:131], a[120:123], v[44:47]
s_waitcnt lgkmcnt(4)
v_mfma_f32_16x16x32_bf16 v[60:63], a[136:139], a[120:123], v[60:63]
ds_read_b64_tr_b16 a[152:153], v236 offset:14400
v_mfma_f32_16x16x32_bf16 v[60:63], a[140:143], a[124:127], v[60:63]
buffer_store_dwordx4 v[16:19], v248, s[16:19], s5 offen sc1
v_mfma_f32_16x16x32_bf16 v[56:59], a[140:143], a[116:119], v[56:59]
ds_read_b64_tr_b16 a[154:155], v236 offset:16192
s_add_u32 s5, s5, 4096
v_mfma_f32_16x16x32_bf16 v[56:59], a[136:139], a[112:115], v[56:59]
v_mfma_f32_16x16x32_bf16 v[52:55], a[136:139], a[104:107], v[52:55]
ds_read_b64_tr_b16 a[156:157], v236 offset:21568
v_accvgpr_read_b32 v20, a240
v_mfma_f32_16x16x32_bf16 v[52:55], a[140:143], a[108:111], v[52:55]
v_accvgpr_read_b32 v21, a241
v_mfma_f32_16x16x32_bf16 v[48:51], a[140:143], a[100:103], v[48:51]
ds_read_b64_tr_b16 a[158:159], v236 offset:23360
v_accvgpr_read_b32 v22, a242
v_mfma_f32_16x16x32_bf16 v[48:51], a[136:139], a[96:99], v[48:51]
v_accvgpr_read_b32 v23, a243
s_waitcnt lgkmcnt(4)
v_mfma_f32_16x16x32_bf16 v[64:67], a[144:147], a[32:35], v[64:67]
ds_read_b64_tr_b16 a[128:129], v235 offset:64
v_accvgpr_read_b32 v24, a244
v_mfma_f32_16x16x32_bf16 v[64:67], a[148:151], a[36:39], v[64:67]
s_add_u32 m0, s4, 146944
v_mfma_f32_16x16x32_bf16 v[68:71], a[148:151], a[44:47], v[68:71]
ds_read_b64_tr_b16 a[130:131], v235 offset:1856
v_mul_f32 v40, v40, v56
s_add_u32 s35, s54, 0
v_mfma_f32_16x16x32_bf16 v[68:71], a[144:147], a[40:43], v[68:71]
v_mul_f32 v41, v41, v57
v_mul_f32 v42, v42, v58
buffer_load_dwordx4 v20, s[20:23], s35 offen offset:0  lds
v_mfma_f32_16x16x32_bf16 v[72:75], a[144:147], a[48:51], v[72:75]
ds_read_b64_tr_b16 a[132:133], v235 offset:7232
v_mul_f32 v43, v43, v59
v_mfma_f32_16x16x32_bf16 v[72:75], a[148:151], a[52:55], v[72:75]
v_mul_f32 v44, v44, v60
v_accvgpr_read_b32 v0, a224
v_mfma_f32_16x16x32_bf16 v[76:79], a[148:151], a[60:63], v[76:79]
ds_read_b64_tr_b16 a[134:135], v235 offset:9024
v_mul_f32 v45, v45, v61
v_mfma_f32_16x16x32_bf16 v[76:79], a[144:147], a[56:59], v[76:79]
v_mul_f32 v46, v46, v62
v_accvgpr_read_b32 v1, a225
s_waitcnt lgkmcnt(4)
v_mfma_f32_16x16x32_bf16 v[92:95], a[152:155], a[56:59], v[92:95]
ds_read_b64_tr_b16 a[136:137], v235 offset:14400
v_mul_f32 v47, v47, v63
s_add_u32 s35, s54, 992
v_mfma_f32_16x16x32_bf16 v[92:95], a[156:159], a[60:63], v[92:95]
v_accvgpr_read_b32 v2, a226
buffer_load_dwordx4 v20, s[20:23], s35 offen offset:1056  lds
v_mfma_f32_16x16x32_bf16 v[88:91], a[156:159], a[52:55], v[88:91]
ds_read_b64_tr_b16 a[138:139], v235 offset:16192
v_cvt_pk_bf16_f32 v56, v40, v41
v_mfma_f32_16x16x32_bf16 v[88:91], a[152:155], a[48:51], v[88:91]
v_cvt_pk_bf16_f32 v57, v42, v43
v_cvt_pk_bf16_f32 v58, v44, v45
v_mfma_f32_16x16x32_bf16 v[84:87], a[152:155], a[40:43], v[84:87]
ds_read_b64_tr_b16 a[140:141], v235 offset:21568
v_cvt_pk_bf16_f32 v59, v46, v47
v_mfma_f32_16x16x32_bf16 v[84:87], a[156:159], a[44:47], v[84:87]
v_accvgpr_write_b32 a178, v56
v_accvgpr_read_b32 v3, a227
v_mfma_f32_16x16x32_bf16 v[80:83], a[156:159], a[36:39], v[80:83]
ds_read_b64_tr_b16 a[142:143], v235 offset:23360
v_accvgpr_write_b32 a179, v57
v_mfma_f32_16x16x32_bf16 v[80:83], a[152:155], a[32:35], v[80:83]
v_accvgpr_write_b32 a186, v58
s_waitcnt lgkmcnt(4)
v_mfma_f32_16x16x32_bf16 v[64:67], a[128:131], a[64:67], v[64:67]
ds_read_b64_tr_b16 a[144:145], v235 offset:28736
v_accvgpr_write_b32 a187, v59
s_add_u32 s35, s54, 1984
v_mfma_f32_16x16x32_bf16 v[64:67], a[132:135], a[68:71], v[64:67]
v_permlane16_swap_b32 v56, v58
buffer_load_dwordx4 v20, s[20:23], s35 offen offset:2112  lds
v_mfma_f32_16x16x32_bf16 v[68:71], a[132:135], a[76:79], v[68:71]
ds_read_b64_tr_b16 a[146:147], v235 offset:30528
v_accvgpr_read_b32 v4, a228
v_mfma_f32_16x16x32_bf16 v[68:71], a[128:131], a[72:75], v[68:71]
v_permlane16_swap_b32 v57, v59
v_mfma_f32_16x16x32_bf16 v[72:75], a[128:131], a[80:83], v[72:75]
ds_read_b64_tr_b16 a[148:149], v235 offset:35904
v_accvgpr_read_b32 v5, a229
v_mfma_f32_16x16x32_bf16 v[72:75], a[132:135], a[84:87], v[72:75]
buffer_store_dwordx4 v[56:59], v249, s[16:19], s5 offen sc1
v_mfma_f32_16x16x32_bf16 v[76:79], a[132:135], a[92:95], v[76:79]
ds_read_b64_tr_b16 a[150:151], v235 offset:37696
v_mul_f32 v32, v32, v48
v_accvgpr_read_b32 v6, a230
v_mfma_f32_16x16x32_bf16 v[76:79], a[128:131], a[88:91], v[76:79]
v_mul_f32 v33, v33, v49
s_waitcnt lgkmcnt(4)
v_mfma_f32_16x16x32_bf16 v[92:95], a[136:139], a[88:91], v[92:95]
ds_read_b64_tr_b16 a[152:153], v235 offset:43072
v_mul_f32 v34, v34, v50
v_accvgpr_read_b32 v7, a231
v_mfma_f32_16x16x32_bf16 v[92:95], a[140:143], a[92:95], v[92:95]
s_add_u32 s35, s54, 2976
buffer_load_dwordx4 v20, s[20:23], s35 offen offset:3168  lds
v_mfma_f32_16x16x32_bf16 v[88:91], a[140:143], a[84:87], v[88:91]
ds_read_b64_tr_b16 a[154:155], v235 offset:44864
v_mul_f32 v35, v35, v51
v_accvgpr_read_b32 v8, a232
v_mfma_f32_16x16x32_bf16 v[88:91], a[136:139], a[80:83], v[88:91]
v_mul_f32 v36, v36, v52
v_mul_f32 v37, v37, v53
v_mfma_f32_16x16x32_bf16 v[84:87], a[136:139], a[72:75], v[84:87]
ds_read_b64_tr_b16 a[156:157], v235 offset:50240
v_mul_f32 v38, v38, v54
v_accvgpr_read_b32 v9, a233
v_mfma_f32_16x16x32_bf16 v[84:87], a[140:143], a[76:79], v[84:87]
v_mul_f32 v39, v39, v55
v_cvt_pk_bf16_f32 v48, v32, v33
v_mfma_f32_16x16x32_bf16 v[80:83], a[140:143], a[68:71], v[80:83]
ds_read_b64_tr_b16 a[158:159], v235 offset:52032
v_cvt_pk_bf16_f32 v49, v34, v35
v_accvgpr_read_b32 v10, a234
v_mfma_f32_16x16x32_bf16 v[80:83], a[136:139], a[64:67], v[80:83]
v_cvt_pk_bf16_f32 v50, v36, v37
s_add_u32 m0, s4, 130048
s_waitcnt lgkmcnt(4)
v_mfma_f32_16x16x32_bf16 v[64:67], a[144:147], a[96:99], v[64:67]
ds_read_b64_tr_b16 a[128:129], v236 offset:96
v_cvt_pk_bf16_f32 v51, v38, v39
v_accvgpr_read_b32 v11, a235
v_mfma_f32_16x16x32_bf16 v[64:67], a[148:151], a[100:103], v[64:67]
s_add_u32 s35, s55, 0
buffer_load_dwordx4 v21, s[20:23], s35 offen offset:0  lds
v_mfma_f32_16x16x32_bf16 v[68:71], a[148:151], a[108:111], v[68:71]
ds_read_b64_tr_b16 a[130:131], v236 offset:1888
v_accvgpr_write_b32 a162, v48
v_accvgpr_read_b32 v12, a236
v_mfma_f32_16x16x32_bf16 v[68:71], a[144:147], a[104:107], v[68:71]
v_accvgpr_write_b32 a163, v49
v_accvgpr_write_b32 a170, v50
v_mfma_f32_16x16x32_bf16 v[72:75], a[144:147], a[112:115], v[72:75]
ds_read_b64_tr_b16 a[132:133], v236 offset:7264
v_accvgpr_write_b32 a171, v51
v_mfma_f32_16x16x32_bf16 v[72:75], a[148:151], a[116:119], v[72:75]
v_permlane16_swap_b32 v48, v50
v_mfma_f32_16x16x32_bf16 v[76:79], a[148:151], a[124:127], v[76:79]
ds_read_b64_tr_b16 a[134:135], v236 offset:9056
v_permlane16_swap_b32 v49, v51
v_mfma_f32_16x16x32_bf16 v[76:79], a[144:147], a[120:123], v[76:79]
v_accvgpr_read_b32 v13, a237
s_waitcnt lgkmcnt(4)
v_mfma_f32_16x16x32_bf16 v[92:95], a[152:155], a[120:123], v[92:95]
ds_read_b64_tr_b16 a[136:137], v236 offset:14432
s_add_u32 s35, s55, 992
v_mfma_f32_16x16x32_bf16 v[92:95], a[156:159], a[124:127], v[92:95]
buffer_store_dwordx4 v[48:51], v248, s[16:19], s5 offen sc1
v_mfma_f32_16x16x32_bf16 v[88:91], a[156:159], a[116:119], v[88:91]
ds_read_b64_tr_b16 a[138:139], v236 offset:16224
s_add_u32 s5, s5, 4096
v_mfma_f32_16x16x32_bf16 v[88:91], a[152:155], a[112:115], v[88:91]
v_accvgpr_read_b32 v14, a238
buffer_load_dwordx4 v21, s[20:23], s35 offen offset:1056  lds
v_mfma_f32_16x16x32_bf16 v[84:87], a[152:155], a[104:107], v[84:87]
ds_read_b64_tr_b16 a[140:141], v236 offset:21600
v_mfma_f32_16x16x32_bf16 v[84:87], a[156:159], a[108:111], v[84:87]
v_accvgpr_read_b32 v15, a239
v_mfma_f32_16x16x32_bf16 v[80:83], a[156:159], a[100:103], v[80:83]
ds_read_b64_tr_b16 a[142:143], v236 offset:23392
v_mfma_f32_16x16x32_bf16 v[80:83], a[152:155], a[96:99], v[80:83]
s_add_u32 s35, s55, 1984
s_waitcnt lgkmcnt(4)
v_mfma_f32_16x16x32_bf16 v[96:99], a[128:131], a[32:35], v[96:99]
ds_read_b64_tr_b16 a[144:145], v235 offset:96
v_mfma_f32_16x16x32_bf16 v[96:99], a[132:135], a[36:39], v[96:99]
buffer_load_dwordx4 v21, s[20:23], s35 offen offset:2112  lds
v_mfma_f32_16x16x32_bf16 v[100:103], a[132:135], a[44:47], v[100:103]
ds_read_b64_tr_b16 a[146:147], v235 offset:1888
v_mul_f32 v72, v72, v88
v_mfma_f32_16x16x32_bf16 v[100:103], a[128:131], a[40:43], v[100:103]
v_mul_f32 v73, v73, v89
v_mul_f32 v74, v74, v90
v_mfma_f32_16x16x32_bf16 v[104:107], a[128:131], a[48:51], v[104:107]
ds_read_b64_tr_b16 a[148:149], v235 offset:7264
v_mul_f32 v75, v75, v91
v_mfma_f32_16x16x32_bf16 v[104:107], a[132:135], a[52:55], v[104:107]
v_mul_f32 v76, v76, v92
v_mfma_f32_16x16x32_bf16 v[108:111], a[132:135], a[60:63], v[108:111]
ds_read_b64_tr_b16 a[150:151], v235 offset:9056
v_mul_f32 v77, v77, v93
s_add_u32 s35, s55, 2976
v_mfma_f32_16x16x32_bf16 v[108:111], a[128:131], a[56:59], v[108:111]
v_mul_f32 v78, v78, v94
s_waitcnt lgkmcnt(4)
v_mfma_f32_16x16x32_bf16 v[124:127], a[136:139], a[56:59], v[124:127]
ds_read_b64_tr_b16 a[152:153], v235 offset:14432
v_mul_f32 v79, v79, v95
v_mfma_f32_16x16x32_bf16 v[124:127], a[140:143], a[60:63], v[124:127]
buffer_load_dwordx4 v21, s[20:23], s35 offen offset:3168  lds
v_mfma_f32_16x16x32_bf16 v[120:123], a[140:143], a[52:55], v[120:123]
ds_read_b64_tr_b16 a[154:155], v235 offset:16224
v_cvt_pk_bf16_f32 v88, v72, v73
v_mfma_f32_16x16x32_bf16 v[120:123], a[136:139], a[48:51], v[120:123]
v_cvt_pk_bf16_f32 v89, v74, v75
v_cvt_pk_bf16_f32 v90, v76, v77
v_mfma_f32_16x16x32_bf16 v[116:119], a[136:139], a[40:43], v[116:119]
ds_read_b64_tr_b16 a[156:157], v235 offset:21600
v_cvt_pk_bf16_f32 v91, v78, v79
v_mfma_f32_16x16x32_bf16 v[116:119], a[140:143], a[44:47], v[116:119]
v_accvgpr_write_b32 a180, v88
v_mfma_f32_16x16x32_bf16 v[112:115], a[140:143], a[36:39], v[112:115]
ds_read_b64_tr_b16 a[158:159], v235 offset:23392
v_accvgpr_write_b32 a181, v89
s_add_u32 m0, s4, 113152
v_mfma_f32_16x16x32_bf16 v[112:115], a[136:139], a[32:35], v[112:115]
v_accvgpr_write_b32 a188, v90
s_add_u32 s35, s40, 0
s_waitcnt lgkmcnt(4)
v_mfma_f32_16x16x32_bf16 v[96:99], a[144:147], a[64:67], v[96:99]
ds_read_b64_tr_b16 a[128:129], v235 offset:28768
v_accvgpr_write_b32 a189, v91
v_mfma_f32_16x16x32_bf16 v[96:99], a[148:151], a[68:71], v[96:99]
v_permlane16_swap_b32 v88, v90
v_mfma_f32_16x16x32_bf16 v[100:103], a[148:151], a[76:79], v[100:103]
ds_read_b64_tr_b16 a[130:131], v235 offset:30560
buffer_load_dwordx4 v241, s[20:23], s35 offen offset:0  lds
v_mfma_f32_16x16x32_bf16 v[100:103], a[144:147], a[72:75], v[100:103]
v_permlane16_swap_b32 v89, v91
v_mfma_f32_16x16x32_bf16 v[104:107], a[144:147], a[80:83], v[104:107]
ds_read_b64_tr_b16 a[132:133], v235 offset:35936
v_mfma_f32_16x16x32_bf16 v[104:107], a[148:151], a[84:87], v[104:107]
buffer_store_dwordx4 v[88:91], v249, s[16:19], s5 offen sc1
v_mfma_f32_16x16x32_bf16 v[108:111], a[148:151], a[92:95], v[108:111]
ds_read_b64_tr_b16 a[134:135], v235 offset:37728
v_mul_f32 v64, v64, v80
v_mfma_f32_16x16x32_bf16 v[108:111], a[144:147], a[88:91], v[108:111]
v_mul_f32 v65, v65, v81
s_waitcnt lgkmcnt(4)
v_mfma_f32_16x16x32_bf16 v[124:127], a[152:155], a[88:91], v[124:127]
ds_read_b64_tr_b16 a[136:137], v235 offset:43104
v_mul_f32 v66, v66, v82
v_mfma_f32_16x16x32_bf16 v[124:127], a[156:159], a[92:95], v[124:127]
buffer_load_dwordx4 v242, s[20:23], s35 offen offset:1056  lds
v_mfma_f32_16x16x32_bf16 v[120:123], a[156:159], a[84:87], v[120:123]
ds_read_b64_tr_b16 a[138:139], v235 offset:44896
v_mul_f32 v67, v67, v83
v_mfma_f32_16x16x32_bf16 v[120:123], a[152:155], a[80:83], v[120:123]
v_mul_f32 v68, v68, v84
v_mul_f32 v69, v69, v85
v_mfma_f32_16x16x32_bf16 v[116:119], a[152:155], a[72:75], v[116:119]
ds_read_b64_tr_b16 a[140:141], v235 offset:50272
v_mul_f32 v70, v70, v86
v_mfma_f32_16x16x32_bf16 v[116:119], a[156:159], a[76:79], v[116:119]
v_mul_f32 v71, v71, v87
v_cvt_pk_bf16_f32 v80, v64, v65
buffer_load_dwordx4 v243, s[20:23], s35 offen offset:2112  lds
v_mfma_f32_16x16x32_bf16 v[112:115], a[156:159], a[68:71], v[112:115]
ds_read_b64_tr_b16 a[142:143], v235 offset:52064
v_cvt_pk_bf16_f32 v81, v66, v67
v_mfma_f32_16x16x32_bf16 v[112:115], a[152:155], a[64:67], v[112:115]
v_cvt_pk_bf16_f32 v82, v68, v69
s_waitcnt lgkmcnt(4)
v_mfma_f32_16x16x32_bf16 v[96:99], a[128:131], a[96:99], v[96:99]
ds_read_b64_tr_b16 a[144:145], v236 offset:128
v_cvt_pk_bf16_f32 v83, v70, v71
v_mfma_f32_16x16x32_bf16 v[96:99], a[132:135], a[100:103], v[96:99]
v_mfma_f32_16x16x32_bf16 v[100:103], a[132:135], a[108:111], v[100:103]
ds_read_b64_tr_b16 a[146:147], v236 offset:1920
v_accvgpr_write_b32 a164, v80
v_mfma_f32_16x16x32_bf16 v[100:103], a[128:131], a[104:107], v[100:103]
v_accvgpr_write_b32 a165, v81
v_accvgpr_write_b32 a172, v82
v_mfma_f32_16x16x32_bf16 v[104:107], a[128:131], a[112:115], v[104:107]
ds_read_b64_tr_b16 a[148:149], v236 offset:7296
v_accvgpr_write_b32 a173, v83
v_mfma_f32_16x16x32_bf16 v[104:107], a[132:135], a[116:119], v[104:107]
v_permlane16_swap_b32 v80, v82
v_mfma_f32_16x16x32_bf16 v[108:111], a[132:135], a[124:127], v[108:111]
ds_read_b64_tr_b16 a[150:151], v236 offset:9088
v_permlane16_swap_b32 v81, v83
v_mfma_f32_16x16x32_bf16 v[108:111], a[128:131], a[120:123], v[108:111]
buffer_load_dwordx4 v244, s[20:23], s35 offen offset:3168  lds
s_waitcnt lgkmcnt(4)
v_mfma_f32_16x16x32_bf16 v[124:127], a[136:139], a[120:123], v[124:127]
ds_read_b64_tr_b16 a[152:153], v236 offset:14464
v_mfma_f32_16x16x32_bf16 v[124:127], a[140:143], a[124:127], v[124:127]
buffer_store_dwordx4 v[80:83], v248, s[16:19], s5 offen sc1
v_mfma_f32_16x16x32_bf16 v[120:123], a[140:143], a[116:119], v[120:123]
ds_read_b64_tr_b16 a[154:155], v236 offset:16256
s_add_u32 s5, s5, 4096
v_mfma_f32_16x16x32_bf16 v[120:123], a[136:139], a[112:115], v[120:123]
s_waitcnt vmcnt(9)
buffer_store_dword v254, v250, s[44:47], s49 offen offset:0 sc1
v_mfma_f32_16x16x32_bf16 v[116:119], a[136:139], a[104:107], v[116:119]
ds_read_b64_tr_b16 a[156:157], v236 offset:21632
v_mfma_f32_16x16x32_bf16 v[116:119], a[140:143], a[108:111], v[116:119]
s_add_u32 m0, s4, 96256
s_add_u32 s35, s41, 0
v_mfma_f32_16x16x32_bf16 v[112:115], a[140:143], a[100:103], v[112:115]
ds_read_b64_tr_b16 a[158:159], v236 offset:23424
buffer_load_dwordx4 v241, s[20:23], s35 offen offset:0  lds
v_mfma_f32_16x16x32_bf16 v[112:115], a[136:139], a[96:99], v[112:115]
s_waitcnt lgkmcnt(4)
v_mfma_f32_16x16x32_bf16 v[128:131], a[144:147], a[32:35], v[128:131]
ds_read_b64_tr_b16 a[128:129], v235 offset:128
v_mfma_f32_16x16x32_bf16 v[128:131], a[148:151], a[36:39], v[128:131]
v_mfma_f32_16x16x32_bf16 v[132:135], a[148:151], a[44:47], v[132:135]
ds_read_b64_tr_b16 a[130:131], v235 offset:1920
v_mul_f32 v104, v104, v120
v_mfma_f32_16x16x32_bf16 v[132:135], a[144:147], a[40:43], v[132:135]
v_mul_f32 v105, v105, v121
v_mul_f32 v106, v106, v122
v_mfma_f32_16x16x32_bf16 v[136:139], a[144:147], a[48:51], v[136:139]
ds_read_b64_tr_b16 a[132:133], v235 offset:7296
v_mul_f32 v107, v107, v123
v_mfma_f32_16x16x32_bf16 v[136:139], a[148:151], a[52:55], v[136:139]
v_mul_f32 v108, v108, v124
buffer_load_dwordx4 v242, s[20:23], s35 offen offset:1056  lds
v_mfma_f32_16x16x32_bf16 v[140:143], a[148:151], a[60:63], v[140:143]
ds_read_b64_tr_b16 a[134:135], v235 offset:9088
v_mul_f32 v109, v109, v125
v_mfma_f32_16x16x32_bf16 v[140:143], a[144:147], a[56:59], v[140:143]
v_mul_f32 v110, v110, v126
s_waitcnt lgkmcnt(4)
v_mfma_f32_16x16x32_bf16 v[156:159], a[152:155], a[56:59], v[156:159]
ds_read_b64_tr_b16 a[136:137], v235 offset:14464
v_mul_f32 v111, v111, v127
v_mfma_f32_16x16x32_bf16 v[156:159], a[156:159], a[60:63], v[156:159]
v_mfma_f32_16x16x32_bf16 v[152:155], a[156:159], a[52:55], v[152:155]
ds_read_b64_tr_b16 a[138:139], v235 offset:16256
v_cvt_pk_bf16_f32 v120, v104, v105
v_mfma_f32_16x16x32_bf16 v[152:155], a[152:155], a[48:51], v[152:155]
v_cvt_pk_bf16_f32 v121, v106, v107
v_cvt_pk_bf16_f32 v122, v108, v109
v_mfma_f32_16x16x32_bf16 v[148:151], a[152:155], a[40:43], v[148:151]
ds_read_b64_tr_b16 a[140:141], v235 offset:21632
v_cvt_pk_bf16_f32 v123, v110, v111
v_mfma_f32_16x16x32_bf16 v[148:151], a[156:159], a[44:47], v[148:151]
v_accvgpr_write_b32 a182, v120
buffer_load_dwordx4 v243, s[20:23], s35 offen offset:2112  lds
v_mfma_f32_16x16x32_bf16 v[144:147], a[156:159], a[36:39], v[144:147]
ds_read_b64_tr_b16 a[142:143], v235 offset:23424
v_accvgpr_write_b32 a183, v121
v_mfma_f32_16x16x32_bf16 v[144:147], a[152:155], a[32:35], v[144:147]
v_accvgpr_write_b32 a190, v122
s_waitcnt lgkmcnt(4)
v_mfma_f32_16x16x32_bf16 v[128:131], a[128:131], a[64:67], v[128:131]
ds_read_b64_tr_b16 a[144:145], v235 offset:28800
v_accvgpr_write_b32 a191, v123
v_mfma_f32_16x16x32_bf16 v[128:131], a[132:135], a[68:71], v[128:131]
v_permlane16_swap_b32 v120, v122
v_mfma_f32_16x16x32_bf16 v[132:135], a[132:135], a[76:79], v[132:135]
ds_read_b64_tr_b16 a[146:147], v235 offset:30592
v_mfma_f32_16x16x32_bf16 v[132:135], a[128:131], a[72:75], v[132:135]
v_permlane16_swap_b32 v121, v123
v_mfma_f32_16x16x32_bf16 v[136:139], a[128:131], a[80:83], v[136:139]
ds_read_b64_tr_b16 a[148:149], v235 offset:35968
buffer_load_dwordx4 v244, s[20:23], s35 offen offset:3168  lds
v_mfma_f32_16x16x32_bf16 v[136:139], a[132:135], a[84:87], v[136:139]
buffer_store_dwordx4 v[120:123], v249, s[16:19], s5 offen sc1
v_mfma_f32_16x16x32_bf16 v[140:143], a[132:135], a[92:95], v[140:143]
ds_read_b64_tr_b16 a[150:151], v235 offset:37760
v_mul_f32 v96, v96, v112
v_mfma_f32_16x16x32_bf16 v[140:143], a[128:131], a[88:91], v[140:143]
v_mul_f32 v97, v97, v113
s_waitcnt lgkmcnt(4)
v_mfma_f32_16x16x32_bf16 v[156:159], a[136:139], a[88:91], v[156:159]
ds_read_b64_tr_b16 a[152:153], v235 offset:43136
v_mul_f32 v98, v98, v114
v_mfma_f32_16x16x32_bf16 v[156:159], a[140:143], a[92:95], v[156:159]
v_mfma_f32_16x16x32_bf16 v[152:155], a[140:143], a[84:87], v[152:155]
ds_read_b64_tr_b16 a[154:155], v235 offset:44928
v_mul_f32 v99, v99, v115
v_mfma_f32_16x16x32_bf16 v[152:155], a[136:139], a[80:83], v[152:155]
v_mul_f32 v100, v100, v116
v_mul_f32 v101, v101, v117
v_mfma_f32_16x16x32_bf16 v[148:151], a[136:139], a[72:75], v[148:151]
ds_read_b64_tr_b16 a[156:157], v235 offset:50304
v_mul_f32 v102, v102, v118
v_mfma_f32_16x16x32_bf16 v[148:151], a[140:143], a[76:79], v[148:151]
v_mul_f32 v103, v103, v119
v_cvt_pk_bf16_f32 v112, v96, v97
v_mfma_f32_16x16x32_bf16 v[144:147], a[140:143], a[68:71], v[144:147]
ds_read_b64_tr_b16 a[158:159], v235 offset:52096
v_cvt_pk_bf16_f32 v113, v98, v99
v_mfma_f32_16x16x32_bf16 v[144:147], a[136:139], a[64:67], v[144:147]
v_cvt_pk_bf16_f32 v114, v100, v101
s_waitcnt lgkmcnt(4)
v_mfma_f32_16x16x32_bf16 v[128:131], a[144:147], a[96:99], v[128:131]
ds_read_b64_tr_b16 a[128:129], v236 offset:160
v_cvt_pk_bf16_f32 v115, v102, v103
v_mfma_f32_16x16x32_bf16 v[128:131], a[148:151], a[100:103], v[128:131]
v_mfma_f32_16x16x32_bf16 v[132:135], a[148:151], a[108:111], v[132:135]
ds_read_b64_tr_b16 a[130:131], v236 offset:1952
v_accvgpr_write_b32 a166, v112
v_mfma_f32_16x16x32_bf16 v[132:135], a[144:147], a[104:107], v[132:135]
v_accvgpr_write_b32 a167, v113
v_accvgpr_write_b32 a174, v114
v_mfma_f32_16x16x32_bf16 v[136:139], a[144:147], a[112:115], v[136:139]
ds_read_b64_tr_b16 a[132:133], v236 offset:7328
v_accvgpr_write_b32 a175, v115
v_mfma_f32_16x16x32_bf16 v[136:139], a[148:151], a[116:119], v[136:139]
v_permlane16_swap_b32 v112, v114
v_mfma_f32_16x16x32_bf16 v[140:143], a[148:151], a[124:127], v[140:143]
ds_read_b64_tr_b16 a[134:135], v236 offset:9120
v_permlane16_swap_b32 v113, v115
v_mfma_f32_16x16x32_bf16 v[140:143], a[144:147], a[120:123], v[140:143]
s_waitcnt lgkmcnt(4)
v_mfma_f32_16x16x32_bf16 v[156:159], a[152:155], a[120:123], v[156:159]
ds_read_b64_tr_b16 a[136:137], v236 offset:14496
v_mfma_f32_16x16x32_bf16 v[156:159], a[156:159], a[124:127], v[156:159]
buffer_store_dwordx4 v[112:115], v248, s[16:19], s5 offen sc1
v_mfma_f32_16x16x32_bf16 v[152:155], a[156:159], a[116:119], v[152:155]
ds_read_b64_tr_b16 a[138:139], v236 offset:16288
s_add_u32 s5, s5, 4096
v_mfma_f32_16x16x32_bf16 v[152:155], a[152:155], a[112:115], v[152:155]
v_mfma_f32_16x16x32_bf16 v[148:151], a[152:155], a[104:107], v[148:151]
ds_read_b64_tr_b16 a[140:141], v236 offset:21664
v_mfma_f32_16x16x32_bf16 v[148:151], a[156:159], a[108:111], v[148:151]
v_mfma_f32_16x16x32_bf16 v[144:147], a[156:159], a[100:103], v[144:147]
ds_read_b64_tr_b16 a[142:143], v236 offset:23456
v_mfma_f32_16x16x32_bf16 v[144:147], a[152:155], a[96:99], v[144:147]
s_waitcnt lgkmcnt(4)
v_mfma_f32_16x16x32_bf16 v[160:163], a[128:131], a[32:35], v[160:163]
ds_read_b64_tr_b16 a[144:145], v235 offset:160
v_mfma_f32_16x16x32_bf16 v[160:163], a[132:135], a[36:39], v[160:163]
v_mfma_f32_16x16x32_bf16 v[164:167], a[132:135], a[44:47], v[164:167]
ds_read_b64_tr_b16 a[146:147], v235 offset:1952
v_mul_f32 v136, v136, v152
v_mfma_f32_16x16x32_bf16 v[164:167], a[128:131], a[40:43], v[164:167]
v_mul_f32 v137, v137, v153
v_mul_f32 v138, v138, v154
v_mfma_f32_16x16x32_bf16 v[168:171], a[128:131], a[48:51], v[168:171]
ds_read_b64_tr_b16 a[148:149], v235 offset:7328
v_mul_f32 v139, v139, v155
v_mfma_f32_16x16x32_bf16 v[168:171], a[132:135], a[52:55], v[168:171]
v_mul_f32 v140, v140, v156
v_mfma_f32_16x16x32_bf16 v[172:175], a[132:135], a[60:63], v[172:175]
ds_read_b64_tr_b16 a[150:151], v235 offset:9120
v_mul_f32 v141, v141, v157
v_mfma_f32_16x16x32_bf16 v[172:175], a[128:131], a[56:59], v[172:175]
v_mul_f32 v142, v142, v158
s_waitcnt lgkmcnt(4)
v_mfma_f32_16x16x32_bf16 v[188:191], a[136:139], a[56:59], v[188:191]
ds_read_b64_tr_b16 a[152:153], v235 offset:14496
v_mul_f32 v143, v143, v159
v_mfma_f32_16x16x32_bf16 v[188:191], a[140:143], a[60:63], v[188:191]
v_mfma_f32_16x16x32_bf16 v[184:187], a[140:143], a[52:55], v[184:187]
ds_read_b64_tr_b16 a[154:155], v235 offset:16288
v_cvt_pk_bf16_f32 v152, v136, v137
v_mfma_f32_16x16x32_bf16 v[184:187], a[136:139], a[48:51], v[184:187]
v_cvt_pk_bf16_f32 v153, v138, v139
v_cvt_pk_bf16_f32 v154, v140, v141
v_mfma_f32_16x16x32_bf16 v[180:183], a[136:139], a[40:43], v[180:183]
ds_read_b64_tr_b16 a[156:157], v235 offset:21664
v_cvt_pk_bf16_f32 v155, v142, v143
v_mfma_f32_16x16x32_bf16 v[180:183], a[140:143], a[44:47], v[180:183]
v_accvgpr_write_b32 a208, v152
v_mfma_f32_16x16x32_bf16 v[176:179], a[140:143], a[36:39], v[176:179]
ds_read_b64_tr_b16 a[158:159], v235 offset:23456
v_accvgpr_write_b32 a209, v153
v_mfma_f32_16x16x32_bf16 v[176:179], a[136:139], a[32:35], v[176:179]
v_accvgpr_write_b32 a216, v154
s_waitcnt lgkmcnt(4)
v_mfma_f32_16x16x32_bf16 v[160:163], a[144:147], a[64:67], v[160:163]
ds_read_b64_tr_b16 a[128:129], v235 offset:28832
v_accvgpr_write_b32 a217, v155
v_mfma_f32_16x16x32_bf16 v[160:163], a[148:151], a[68:71], v[160:163]
v_permlane16_swap_b32 v152, v154
v_mfma_f32_16x16x32_bf16 v[164:167], a[148:151], a[76:79], v[164:167]
ds_read_b64_tr_b16 a[130:131], v235 offset:30624
v_mfma_f32_16x16x32_bf16 v[164:167], a[144:147], a[72:75], v[164:167]
v_permlane16_swap_b32 v153, v155
v_mfma_f32_16x16x32_bf16 v[168:171], a[144:147], a[80:83], v[168:171]
ds_read_b64_tr_b16 a[132:133], v235 offset:36000
v_mfma_f32_16x16x32_bf16 v[168:171], a[148:151], a[84:87], v[168:171]
buffer_store_dwordx4 v[152:155], v249, s[16:19], s5 offen sc1
v_mfma_f32_16x16x32_bf16 v[172:175], a[148:151], a[92:95], v[172:175]
ds_read_b64_tr_b16 a[134:135], v235 offset:37792
v_mul_f32 v128, v128, v144
v_mfma_f32_16x16x32_bf16 v[172:175], a[144:147], a[88:91], v[172:175]
v_mul_f32 v129, v129, v145
s_waitcnt lgkmcnt(4)
v_mfma_f32_16x16x32_bf16 v[188:191], a[152:155], a[88:91], v[188:191]
ds_read_b64_tr_b16 a[136:137], v235 offset:43168
v_mul_f32 v130, v130, v146
v_mfma_f32_16x16x32_bf16 v[188:191], a[156:159], a[92:95], v[188:191]
v_mfma_f32_16x16x32_bf16 v[184:187], a[156:159], a[84:87], v[184:187]
ds_read_b64_tr_b16 a[138:139], v235 offset:44960
v_mul_f32 v131, v131, v147
v_mfma_f32_16x16x32_bf16 v[184:187], a[152:155], a[80:83], v[184:187]
v_mul_f32 v132, v132, v148
v_mul_f32 v133, v133, v149
v_mfma_f32_16x16x32_bf16 v[180:183], a[152:155], a[72:75], v[180:183]
ds_read_b64_tr_b16 a[140:141], v235 offset:50336
v_mul_f32 v134, v134, v150
v_mfma_f32_16x16x32_bf16 v[180:183], a[156:159], a[76:79], v[180:183]
v_mul_f32 v135, v135, v151
v_cvt_pk_bf16_f32 v144, v128, v129
v_mfma_f32_16x16x32_bf16 v[176:179], a[156:159], a[68:71], v[176:179]
ds_read_b64_tr_b16 a[142:143], v235 offset:52128
v_cvt_pk_bf16_f32 v145, v130, v131
v_mfma_f32_16x16x32_bf16 v[176:179], a[152:155], a[64:67], v[176:179]
v_cvt_pk_bf16_f32 v146, v132, v133
s_waitcnt lgkmcnt(4)
v_mfma_f32_16x16x32_bf16 v[160:163], a[128:131], a[96:99], v[160:163]
ds_read_b64_tr_b16 a[144:145], v236 offset:192
v_cvt_pk_bf16_f32 v147, v134, v135
v_mfma_f32_16x16x32_bf16 v[160:163], a[132:135], a[100:103], v[160:163]
v_mfma_f32_16x16x32_bf16 v[164:167], a[132:135], a[108:111], v[164:167]
ds_read_b64_tr_b16 a[146:147], v236 offset:1984
v_accvgpr_write_b32 a192, v144
v_mfma_f32_16x16x32_bf16 v[164:167], a[128:131], a[104:107], v[164:167]
v_accvgpr_write_b32 a193, v145
v_accvgpr_write_b32 a200, v146
v_mfma_f32_16x16x32_bf16 v[168:171], a[128:131], a[112:115], v[168:171]
ds_read_b64_tr_b16 a[148:149], v236 offset:7360
v_accvgpr_write_b32 a201, v147
v_mfma_f32_16x16x32_bf16 v[168:171], a[132:135], a[116:119], v[168:171]
v_permlane16_swap_b32 v144, v146
v_mfma_f32_16x16x32_bf16 v[172:175], a[132:135], a[124:127], v[172:175]
ds_read_b64_tr_b16 a[150:151], v236 offset:9152
v_permlane16_swap_b32 v145, v147
v_mfma_f32_16x16x32_bf16 v[172:175], a[128:131], a[120:123], v[172:175]
s_waitcnt lgkmcnt(4)
v_mfma_f32_16x16x32_bf16 v[188:191], a[136:139], a[120:123], v[188:191]
ds_read_b64_tr_b16 a[152:153], v236 offset:14528
v_mfma_f32_16x16x32_bf16 v[188:191], a[140:143], a[124:127], v[188:191]
buffer_store_dwordx4 v[144:147], v248, s[16:19], s5 offen sc1
buffer_load_dword v252, v251, s[44:47], s50 offen offset:0 sc1
v_mfma_f32_16x16x32_bf16 v[184:187], a[140:143], a[116:119], v[184:187]
ds_read_b64_tr_b16 a[154:155], v236 offset:16320
s_add_u32 s5, s5, 4096
v_mfma_f32_16x16x32_bf16 v[184:187], a[136:139], a[112:115], v[184:187]
s_waitcnt vmcnt(3)
buffer_store_dword v254, v250, s[44:47], s49 offen offset:128 sc1
v_mfma_f32_16x16x32_bf16 v[180:183], a[136:139], a[104:107], v[180:183]
ds_read_b64_tr_b16 a[156:157], v236 offset:21696
v_mfma_f32_16x16x32_bf16 v[180:183], a[140:143], a[108:111], v[180:183]
v_mfma_f32_16x16x32_bf16 v[176:179], a[140:143], a[100:103], v[176:179]
ds_read_b64_tr_b16 a[158:159], v236 offset:23488
v_mfma_f32_16x16x32_bf16 v[176:179], a[136:139], a[96:99], v[176:179]
s_waitcnt lgkmcnt(4)
v_mfma_f32_16x16x32_bf16 v[192:195], a[144:147], a[32:35], v[192:195]
ds_read_b64_tr_b16 a[128:129], v235 offset:192
v_mfma_f32_16x16x32_bf16 v[192:195], a[148:151], a[36:39], v[192:195]
v_mfma_f32_16x16x32_bf16 v[196:199], a[148:151], a[44:47], v[196:199]
ds_read_b64_tr_b16 a[130:131], v235 offset:1984
v_mul_f32 v168, v168, v184
v_mfma_f32_16x16x32_bf16 v[196:199], a[144:147], a[40:43], v[196:199]
v_mul_f32 v169, v169, v185
v_mul_f32 v170, v170, v186
v_mfma_f32_16x16x32_bf16 v[200:203], a[144:147], a[48:51], v[200:203]
ds_read_b64_tr_b16 a[132:133], v235 offset:7360
v_mul_f32 v171, v171, v187
v_mfma_f32_16x16x32_bf16 v[200:203], a[148:151], a[52:55], v[200:203]
v_mul_f32 v172, v172, v188
v_mfma_f32_16x16x32_bf16 v[204:207], a[148:151], a[60:63], v[204:207]
ds_read_b64_tr_b16 a[134:135], v235 offset:9152
v_mul_f32 v173, v173, v189
v_mfma_f32_16x16x32_bf16 v[204:207], a[144:147], a[56:59], v[204:207]
v_mul_f32 v174, v174, v190
s_waitcnt lgkmcnt(4)
v_mfma_f32_16x16x32_bf16 v[220:223], a[152:155], a[56:59], v[220:223]
ds_read_b64_tr_b16 a[136:137], v235 offset:14528
v_mul_f32 v175, v175, v191
v_mfma_f32_16x16x32_bf16 v[220:223], a[156:159], a[60:63], v[220:223]
v_mfma_f32_16x16x32_bf16 v[216:219], a[156:159], a[52:55], v[216:219]
ds_read_b64_tr_b16 a[138:139], v235 offset:16320
v_cvt_pk_bf16_f32 v184, v168, v169
v_mfma_f32_16x16x32_bf16 v[216:219], a[152:155], a[48:51], v[216:219]
v_cvt_pk_bf16_f32 v185, v170, v171
v_cvt_pk_bf16_f32 v186, v172, v173
v_mfma_f32_16x16x32_bf16 v[212:215], a[152:155], a[40:43], v[212:215]
ds_read_b64_tr_b16 a[140:141], v235 offset:21696
v_cvt_pk_bf16_f32 v187, v174, v175
v_mfma_f32_16x16x32_bf16 v[212:215], a[156:159], a[44:47], v[212:215]
v_accvgpr_write_b32 a210, v184
v_mfma_f32_16x16x32_bf16 v[208:211], a[156:159], a[36:39], v[208:211]
ds_read_b64_tr_b16 a[142:143], v235 offset:23488
v_accvgpr_write_b32 a211, v185
v_mfma_f32_16x16x32_bf16 v[208:211], a[152:155], a[32:35], v[208:211]
v_accvgpr_write_b32 a218, v186
s_waitcnt lgkmcnt(4)
v_mfma_f32_16x16x32_bf16 v[192:195], a[128:131], a[64:67], v[192:195]
ds_read_b64_tr_b16 a[144:145], v235 offset:28864
v_accvgpr_write_b32 a219, v187
v_mfma_f32_16x16x32_bf16 v[192:195], a[132:135], a[68:71], v[192:195]
v_permlane16_swap_b32 v184, v186
v_mfma_f32_16x16x32_bf16 v[196:199], a[132:135], a[76:79], v[196:199]
ds_read_b64_tr_b16 a[146:147], v235 offset:30656
v_mfma_f32_16x16x32_bf16 v[196:199], a[128:131], a[72:75], v[196:199]
v_permlane16_swap_b32 v185, v187
v_mfma_f32_16x16x32_bf16 v[200:203], a[128:131], a[80:83], v[200:203]
ds_read_b64_tr_b16 a[148:149], v235 offset:36032
v_mfma_f32_16x16x32_bf16 v[200:203], a[132:135], a[84:87], v[200:203]
buffer_store_dwordx4 v[184:187], v249, s[16:19], s5 offen sc1
v_mfma_f32_16x16x32_bf16 v[204:207], a[132:135], a[92:95], v[204:207]
ds_read_b64_tr_b16 a[150:151], v235 offset:37824
v_mul_f32 v160, v160, v176
v_mfma_f32_16x16x32_bf16 v[204:207], a[128:131], a[88:91], v[204:207]
v_mul_f32 v161, v161, v177
s_waitcnt lgkmcnt(4)
v_mfma_f32_16x16x32_bf16 v[220:223], a[136:139], a[88:91], v[220:223]
ds_read_b64_tr_b16 a[152:153], v235 offset:43200
v_mul_f32 v162, v162, v178
v_mfma_f32_16x16x32_bf16 v[220:223], a[140:143], a[92:95], v[220:223]
v_mfma_f32_16x16x32_bf16 v[216:219], a[140:143], a[84:87], v[216:219]
ds_read_b64_tr_b16 a[154:155], v235 offset:44992
v_mul_f32 v163, v163, v179
v_mfma_f32_16x16x32_bf16 v[216:219], a[136:139], a[80:83], v[216:219]
v_mul_f32 v164, v164, v180
v_mul_f32 v165, v165, v181
v_mfma_f32_16x16x32_bf16 v[212:215], a[136:139], a[72:75], v[212:215]
ds_read_b64_tr_b16 a[156:157], v235 offset:50368
v_mul_f32 v166, v166, v182
v_mfma_f32_16x16x32_bf16 v[212:215], a[140:143], a[76:79], v[212:215]
s_waitcnt vmcnt(23)
s_barrier
v_mfma_f32_16x16x32_bf16 v[208:211], a[140:143], a[68:71], v[208:211]
ds_read_b64_tr_b16 a[158:159], v235 offset:52160
v_mul_f32 v167, v167, v183
v_mfma_f32_16x16x32_bf16 v[208:211], a[136:139], a[64:67], v[208:211]
v_cvt_pk_bf16_f32 v176, v160, v161
s_waitcnt lgkmcnt(4)
v_mfma_f32_16x16x32_bf16 v[192:195], a[144:147], a[96:99], v[192:195]
ds_read_b64_tr_b16 a[128:129], v245 offset:33792
v_cvt_pk_bf16_f32 v177, v162, v163
v_mfma_f32_16x16x32_bf16 v[192:195], a[148:151], a[100:103], v[192:195]
s_waitcnt vmcnt(2)
v_cmp_ne_u32 vcc, v254, v252
v_mfma_f32_16x16x32_bf16 v[196:199], a[148:151], a[108:111], v[196:199]
ds_read_b64_tr_b16 a[130:131], v245 offset:34048
v_cvt_pk_bf16_f32 v178, v164, v165
v_mfma_f32_16x16x32_bf16 v[196:199], a[144:147], a[104:107], v[196:199]
v_cvt_pk_bf16_f32 v179, v166, v167
v_accvgpr_write_b32 a194, v176
s_cbranch_vccnz L_f_slow0
L_f_cont0:
v_mfma_f32_16x16x32_bf16 v[200:203], a[144:147], a[112:115], v[200:203]
ds_read_b64_tr_b16 a[132:133], v245 offset:42240
v_accvgpr_write_b32 a195, v177
v_mfma_f32_16x16x32_bf16 v[200:203], a[148:151], a[116:119], v[200:203]
v_accvgpr_write_b32 a202, v178
v_accvgpr_write_b32 a203, v179
v_mfma_f32_16x16x32_bf16 v[204:207], a[148:151], a[124:127], v[204:207]
ds_read_b64_tr_b16 a[134:135], v245 offset:42496
v_permlane16_swap_b32 v176, v178
v_mfma_f32_16x16x32_bf16 v[204:207], a[144:147], a[120:123], v[204:207]
s_add_u32 s34, s57, 0
s_waitcnt lgkmcnt(4)
v_mfma_f32_16x16x32_bf16 v[220:223], a[152:155], a[120:123], v[220:223]
ds_read_b64_tr_b16 a[136:137], v245 offset:33824
buffer_load_dwordx4 a[196:199], v23, s[16:19], s34 offen sc1
v_mfma_f32_16x16x32_bf16 v[220:223], a[156:159], a[124:127], v[220:223]
v_permlane16_swap_b32 v177, v179
v_mfma_f32_16x16x32_bf16 v[216:219], a[156:159], a[116:119], v[216:219]
ds_read_b64_tr_b16 a[138:139], v245 offset:34080
s_add_u32 s34, s57, 114688
v_mfma_f32_16x16x32_bf16 v[216:219], a[152:155], a[112:115], v[216:219]
buffer_store_dwordx4 v[176:179], v248, s[16:19], s5 offen sc1
v_mfma_f32_16x16x32_bf16 v[212:215], a[152:155], a[104:107], v[212:215]
ds_read_b64_tr_b16 a[140:141], v245 offset:42272
s_add_u32 s5, s5, 4096
v_mfma_f32_16x16x32_bf16 v[212:215], a[156:159], a[108:111], v[212:215]
buffer_load_dwordx4 a[204:207], v23, s[16:19], s34 offen sc1
v_mfma_f32_16x16x32_bf16 v[208:211], a[156:159], a[100:103], v[208:211]
ds_read_b64_tr_b16 a[142:143], v245 offset:42528
s_add_u32 s34, s57, 229376
v_mfma_f32_16x16x32_bf16 v[208:211], a[152:155], a[96:99], v[208:211]
buffer_load_dwordx4 a[212:215], v23, s[16:19], s34 offen sc1
s_waitcnt lgkmcnt(4)
v_mfma_f32_16x16x32_bf16 v[96:99], a[128:131], a[160:163], 0
ds_read_b64_tr_b16 a[144:145], v245 offset:33856
v_mfma_f32_16x16x32_bf16 v[96:99], a[132:135], a[164:167], v[96:99]
s_barrier
v_mfma_f32_16x16x32_bf16 v[100:103], a[132:135], a[172:175], 0
ds_read_b64_tr_b16 a[146:147], v245 offset:34112
v_mul_f32 v200, v200, v216
v_mfma_f32_16x16x32_bf16 v[100:103], a[128:131], a[168:171], v[100:103]
v_mul_f32 v201, v201, v217
v_mul_f32 v202, v202, v218
v_mfma_f32_16x16x32_bf16 v[104:107], a[128:131], a[176:179], 0
ds_read_b64_tr_b16 a[148:149], v245 offset:42304
v_mul_f32 v203, v203, v219
v_mfma_f32_16x16x32_bf16 v[104:107], a[132:135], a[180:183], v[104:107]
v_mul_f32 v204, v204, v220
s_add_u32 s34, s57, 344064
buffer_load_dwordx4 a[220:223], v23, s[16:19], s34 offen sc1
v_mfma_f32_16x16x32_bf16 v[108:111], a[132:135], a[188:191], 0
ds_read_b64_tr_b16 a[150:151], v245 offset:42560
v_mul_f32 v205, v205, v221
v_mfma_f32_16x16x32_bf16 v[108:111], a[128:131], a[184:187], v[108:111]
v_mul_f32 v206, v206, v222
s_add_u32 s34, s37, 0
s_waitcnt lgkmcnt(4)
v_mfma_f32_16x16x32_bf16 v[124:127], a[136:139], a[184:187], 0
ds_read_b64_tr_b16 a[152:153], v245 offset:33888
v_mul_f32 v207, v207, v223
v_mfma_f32_16x16x32_bf16 v[124:127], a[140:143], a[188:191], v[124:127]
buffer_load_dwordx4 a[224:227], v237, s[16:19], s34 offen sc1
v_mfma_f32_16x16x32_bf16 v[120:123], a[140:143], a[180:183], 0
ds_read_b64_tr_b16 a[154:155], v245 offset:34144
v_cvt_pk_bf16_f32 v216, v200, v201
v_mfma_f32_16x16x32_bf16 v[120:123], a[136:139], a[176:179], v[120:123]
v_cvt_pk_bf16_f32 v217, v202, v203
v_cvt_pk_bf16_f32 v218, v204, v205
v_mfma_f32_16x16x32_bf16 v[116:119], a[136:139], a[168:171], 0
ds_read_b64_tr_b16 a[156:157], v245 offset:42336
v_cvt_pk_bf16_f32 v219, v206, v207
v_mfma_f32_16x16x32_bf16 v[116:119], a[140:143], a[172:175], v[116:119]
buffer_load_dwordx4 a[232:235], v238, s[16:19], s34 offen sc1
v_mfma_f32_16x16x32_bf16 v[112:115], a[140:143], a[164:167], 0
ds_read_b64_tr_b16 a[158:159], v245 offset:42592
v_mfma_f32_16x16x32_bf16 v[112:115], a[136:139], a[160:163], v[112:115]
s_waitcnt lgkmcnt(4)
v_mfma_f32_16x16x32_bf16 v[128:131], a[144:147], a[160:163], 0
ds_read_b64_tr_b16 a[128:129], v245 offset:33920
buffer_load_dwordx4 a[240:243], v239, s[16:19], s34 offen sc1
v_mfma_f32_16x16x32_bf16 v[128:131], a[148:151], a[164:167], v[128:131]
v_permlane16_swap_b32 v216, v218
v_mfma_f32_16x16x32_bf16 v[132:135], a[148:151], a[172:175], 0
ds_read_b64_tr_b16 a[130:131], v245 offset:34176
v_mfma_f32_16x16x32_bf16 v[132:135], a[144:147], a[168:171], v[132:135]
v_permlane16_swap_b32 v217, v219
v_mfma_f32_16x16x32_bf16 v[136:139], a[144:147], a[176:179], 0
ds_read_b64_tr_b16 a[132:133], v245 offset:42368
buffer_load_dwordx4 a[248:251], v240, s[16:19], s34 offen sc1
v_mfma_f32_16x16x32_bf16 v[136:139], a[148:151], a[180:183], v[136:139]
buffer_store_dwordx4 v[216:219], v249, s[16:19], s5 offen sc1
v_mfma_f32_16x16x32_bf16 v[140:143], a[148:151], a[188:191], 0
ds_read_b64_tr_b16 a[134:135], v245 offset:42624
v_mul_f32 v192, v192, v208
v_mfma_f32_16x16x32_bf16 v[140:143], a[144:147], a[184:187], v[140:143]
v_mul_f32 v193, v193, v209
s_waitcnt lgkmcnt(4)
v_mfma_f32_16x16x32_bf16 v[156:159], a[152:155], a[184:187], 0
ds_read_b64_tr_b16 a[136:137], v245 offset:33952
v_mul_f32 v194, v194, v210
v_mfma_f32_16x16x32_bf16 v[156:159], a[156:159], a[188:191], v[156:159]
s_add_u32 s34, s38, 0
buffer_load_dwordx4 a[228:231], v237, s[16:19], s34 offen sc1
v_mfma_f32_16x16x32_bf16 v[152:155], a[156:159], a[180:183], 0
ds_read_b64_tr_b16 a[138:139], v245 offset:34208
v_mul_f32 v195, v195, v211
v_mfma_f32_16x16x32_bf16 v[152:155], a[152:155], a[176:179], v[152:155]
v_mul_f32 v196, v196, v212
v_mul_f32 v197, v197, v213
v_mfma_f32_16x16x32_bf16 v[148:151], a[152:155], a[168:171], 0
ds_read_b64_tr_b16 a[140:141], v245 offset:42400
v_mul_f32 v198, v198, v214
v_mfma_f32_16x16x32_bf16 v[148:151], a[156:159], a[172:175], v[148:151]
v_mul_f32 v199, v199, v215
v_cvt_pk_bf16_f32 v208, v192, v193
buffer_load_dwordx4 a[236:239], v238, s[16:19], s34 offen sc1
v_mfma_f32_16x16x32_bf16 v[144:147], a[156:159], a[164:167], 0
ds_read_b64_tr_b16 a[142:143], v245 offset:42656
v_cvt_pk_bf16_f32 v209, v194, v195
v_mfma_f32_16x16x32_bf16 v[144:147], a[152:155], a[160:163], v[144:147]
v_cvt_pk_bf16_f32 v210, v196, v197
s_waitcnt lgkmcnt(4)
v_mfma_f32_16x16x32_bf16 v[160:163], a[128:131], a[160:163], 0
ds_read_b64_tr_b16 a[144:145], v245 offset:33984
v_cvt_pk_bf16_f32 v211, v198, v199
v_mfma_f32_16x16x32_bf16 v[160:163], a[132:135], a[164:167], v[160:163]
v_permlane16_swap_b32 v208, v210
v_mfma_f32_16x16x32_bf16 v[164:167], a[132:135], a[172:175], 0
ds_read_b64_tr_b16 a[146:147], v245 offset:34240
buffer_load_dwordx4 a[244:247], v239, s[16:19], s34 offen sc1
v_mfma_f32_16x16x32_bf16 v[164:167], a[128:131], a[168:171], v[164:167]
v_permlane16_swap_b32 v209, v211
v_mfma_f32_16x16x32_bf16 v[168:171], a[128:131], a[176:179], 0
ds_read_b64_tr_b16 a[148:149], v245 offset:42432
v_mfma_f32_16x16x32_bf16 v[168:171], a[132:135], a[180:183], v[168:171]
buffer_store_dwordx4 v[208:211], v248, s[16:19], s5 offen sc1
v_mfma_f32_16x16x32_bf16 v[172:175], a[132:135], a[188:191], 0
ds_read_b64_tr_b16 a[150:151], v245 offset:42688
s_add_u32 s5, s5, 4096
v_mfma_f32_16x16x32_bf16 v[172:175], a[128:131], a[184:187], v[172:175]
s_waitcnt lgkmcnt(4)
v_mfma_f32_16x16x32_bf16 v[188:191], a[136:139], a[184:187], 0
ds_read_b64_tr_b16 a[152:153], v245 offset:34016
v_mfma_f32_16x16x32_bf16 v[188:191], a[140:143], a[188:191], v[188:191]
buffer_load_dwordx4 a[252:255], v240, s[16:19], s34 offen sc1
v_mfma_f32_16x16x32_bf16 v[184:187], a[140:143], a[180:183], 0
ds_read_b64_tr_b16 a[154:155], v245 offset:34272
v_mfma_f32_16x16x32_bf16 v[184:187], a[136:139], a[176:179], v[184:187]
s_add_u32 s34, s39, 0
buffer_load_dwordx4 a[0:3], v237, s[16:19], s34 offen sc1
v_mfma_f32_16x16x32_bf16 v[180:183], a[136:139], a[168:171], 0
ds_read_b64_tr_b16 a[156:157], v245 offset:42464
v_mfma_f32_16x16x32_bf16 v[180:183], a[140:143], a[172:175], v[180:183]
s_waitcnt vmcnt(34)
s_barrier
v_mfma_f32_16x16x32_bf16 v[176:179], a[140:143], a[164:167], 0
ds_read_b64_tr_b16 a[158:159], v245 offset:42720
v_mfma_f32_16x16x32_bf16 v[176:179], a[136:139], a[160:163], v[176:179]
s_waitcnt lgkmcnt(4)
v_mfma_f32_16x16x32_bf16 v[192:195], a[144:147], a[160:163], 0
ds_read_b64_tr_b16 a[128:129], v245 offset:16896
v_mfma_f32_16x16x32_bf16 v[192:195], a[148:151], a[164:167], v[192:195]
buffer_load_dwordx4 a[8:11], v238, s[16:19], s34 offen sc1
v_mfma_f32_16x16x32_bf16 v[196:199], a[148:151], a[172:175], 0
ds_read_b64_tr_b16 a[130:131], v245 offset:17152
v_mfma_f32_16x16x32_bf16 v[196:199], a[144:147], a[168:171], v[196:199]
v_mfma_f32_16x16x32_bf16 v[200:203], a[144:147], a[176:179], 0
ds_read_b64_tr_b16 a[132:133], v245 offset:25344
v_mfma_f32_16x16x32_bf16 v[200:203], a[148:151], a[180:183], v[200:203]
buffer_load_dwordx4 a[16:19], v239, s[16:19], s34 offen sc1
v_mfma_f32_16x16x32_bf16 v[204:207], a[148:151], a[188:191], 0
ds_read_b64_tr_b16 a[134:135], v245 offset:25600
v_mfma_f32_16x16x32_bf16 v[204:207], a[144:147], a[184:187], v[204:207]
s_waitcnt lgkmcnt(4)
v_mfma_f32_16x16x32_bf16 v[220:223], a[152:155], a[184:187], 0
ds_read_b64_tr_b16 a[136:137], v245 offset:16928
v_mfma_f32_16x16x32_bf16 v[220:223], a[156:159], a[188:191], v[220:223]
buffer_load_dwordx4 a[24:27], v240, s[16:19], s34 offen sc1
v_mfma_f32_16x16x32_bf16 v[216:219], a[156:159], a[180:183], 0
ds_read_b64_tr_b16 a[138:139], v245 offset:17184
v_mfma_f32_16x16x32_bf16 v[216:219], a[152:155], a[176:179], v[216:219]
v_mfma_f32_16x16x32_bf16 v[212:215], a[152:155], a[168:171], 0
ds_read_b64_tr_b16 a[140:141], v245 offset:25376
v_mfma_f32_16x16x32_bf16 v[212:215], a[156:159], a[172:175], v[212:215]
v_mfma_f32_16x16x32_bf16 v[208:211], a[156:159], a[164:167], 0
ds_read_b64_tr_b16 a[142:143], v245 offset:25632
s_add_u32 s34, s37, 4096
v_mfma_f32_16x16x32_bf16 v[208:211], a[152:155], a[160:163], v[208:211]
s_waitcnt vmcnt(14) lgkmcnt(4)
v_mfma_f32_16x16x32_bf16 v[96:99], a[128:131], a[192:195], v[96:99]
ds_read_b64_tr_b16 a[144:145], v245 offset:16960
v_mfma_f32_16x16x32_bf16 v[96:99], a[132:135], a[196:199], v[96:99]
buffer_load_dwordx4 a[4:7], v237, s[16:19], s34 offen sc1
v_mfma_f32_16x16x32_bf16 v[100:103], a[132:135], a[204:207], v[100:103]
ds_read_b64_tr_b16 a[146:147], v245 offset:17216
v_mfma_f32_16x16x32_bf16 v[100:103], a[128:131], a[200:203], v[100:103]
buffer_load_dwordx4 a[12:15], v238, s[16:19], s34 offen sc1
v_mfma_f32_16x16x32_bf16 v[104:107], a[128:131], a[208:211], v[104:107]
ds_read_b64_tr_b16 a[148:149], v245 offset:25408
v_mfma_f32_16x16x32_bf16 v[104:107], a[132:135], a[212:215], v[104:107]
v_mfma_f32_16x16x32_bf16 v[108:111], a[132:135], a[220:223], v[108:111]
ds_read_b64_tr_b16 a[150:151], v245 offset:25664
v_mfma_f32_16x16x32_bf16 v[108:111], a[128:131], a[216:219], v[108:111]
s_waitcnt lgkmcnt(4)
v_mfma_f32_16x16x32_bf16 v[124:127], a[136:139], a[216:219], v[124:127]
ds_read_b64_tr_b16 a[152:153], v245 offset:16992
v_mfma_f32_16x16x32_bf16 v[124:127], a[140:143], a[220:223], v[124:127]
buffer_load_dwordx4 a[20:23], v239, s[16:19], s34 offen sc1
v_mfma_f32_16x16x32_bf16 v[120:123], a[140:143], a[212:215], v[120:123]
ds_read_b64_tr_b16 a[154:155], v245 offset:17248
v_mfma_f32_16x16x32_bf16 v[120:123], a[136:139], a[208:211], v[120:123]
buffer_load_dwordx4 a[28:31], v240, s[16:19], s34 offen sc1
v_mfma_f32_16x16x32_bf16 v[116:119], a[136:139], a[200:203], v[116:119]
ds_read_b64_tr_b16 a[156:157], v245 offset:25440
v_mfma_f32_16x16x32_bf16 v[116:119], a[140:143], a[204:207], v[116:119]
v_mfma_f32_16x16x32_bf16 v[112:115], a[140:143], a[196:199], v[112:115]
ds_read_b64_tr_b16 a[158:159], v245 offset:25696
v_mfma_f32_16x16x32_bf16 v[112:115], a[136:139], a[192:195], v[112:115]
s_waitcnt lgkmcnt(4)
v_mfma_f32_16x16x32_bf16 v[128:131], a[144:147], a[192:195], v[128:131]
ds_read_b64_tr_b16 a[128:129], v245 offset:17024
s_add_u32 m0, s4, 79360
v_mfma_f32_16x16x32_bf16 v[128:131], a[148:151], a[196:199], v[128:131]
s_add_u32 s35, s42, 32768
v_mfma_f32_16x16x32_bf16 v[132:135], a[148:151], a[204:207], v[132:135]
ds_read_b64_tr_b16 a[130:131], v245 offset:17280
v_mfma_f32_16x16x32_bf16 v[132:135], a[144:147], a[200:203], v[132:135]
buffer_load_dwordx4 v241, s[20:23], s35 offen offset:0  lds
v_mfma_f32_16x16x32_bf16 v[136:139], a[144:147], a[208:211], v[136:139]
ds_read_b64_tr_b16 a[132:133], v245 offset:25472
v_mfma_f32_16x16x32_bf16 v[136:139], a[148:151], a[212:215], v[136:139]
buffer_load_dwordx4 v242, s[20:23], s35 offen offset:1056  lds
v_mfma_f32_16x16x32_bf16 v[140:143], a[148:151], a[220:223], v[140:143]
ds_read_b64_tr_b16 a[134:135], v245 offset:25728
v_mfma_f32_16x16x32_bf16 v[140:143], a[144:147], a[216:219], v[140:143]
s_waitcnt lgkmcnt(4)
v_mfma_f32_16x16x32_bf16 v[156:159], a[152:155], a[216:219], v[156:159]
ds_read_b64_tr_b16 a[136:137], v245 offset:17056
v_mfma_f32_16x16x32_bf16 v[156:159], a[156:159], a[220:223], v[156:159]
buffer_load_dwordx4 v243, s[20:23], s35 offen offset:2112  lds
v_mfma_f32_16x16x32_bf16 v[152:155], a[156:159], a[212:215], v[152:155]
ds_read_b64_tr_b16 a[138:139], v245 offset:17312
v_mfma_f32_16x16x32_bf16 v[152:155], a[152:155], a[208:211], v[152:155]
v_mfma_f32_16x16x32_bf16 v[148:151], a[152:155], a[200:203], v[148:151]
ds_read_b64_tr_b16 a[140:141], v245 offset:25504
v_mfma_f32_16x16x32_bf16 v[148:151], a[156:159], a[204:207], v[148:151]
v_mfma_f32_16x16x32_bf16 v[144:147], a[156:159], a[196:199], v[144:147]
ds_read_b64_tr_b16 a[142:143], v245 offset:25760
v_mfma_f32_16x16x32_bf16 v[144:147], a[152:155], a[192:195], v[144:147]
s_waitcnt lgkmcnt(4)
v_mfma_f32_16x16x32_bf16 v[160:163], a[128:131], a[192:195], v[160:163]
ds_read_b64_tr_b16 a[144:145], v245 offset:17088
v_mfma_f32_16x16x32_bf16 v[160:163], a[132:135], a[196:199], v[160:163]
buffer_load_dwordx4 v244, s[20:23], s35 offen offset:3168  lds
v_mfma_f32_16x16x32_bf16 v[164:167], a[132:135], a[204:207], v[164:167]
ds_read_b64_tr_b16 a[146:147], v245 offset:17344
s_add_u32 s34, s38, 4096
v_mfma_f32_16x16x32_bf16 v[164:167], a[128:131], a[200:203], v[164:167]
buffer_load_dwordx4 a[32:35], v237, s[16:19], s34 offen sc1
v_mfma_f32_16x16x32_bf16 v[168:171], a[128:131], a[208:211], v[168:171]
ds_read_b64_tr_b16 a[148:149], v245 offset:25536
v_mfma_f32_16x16x32_bf16 v[168:171], a[132:135], a[212:215], v[168:171]
v_mfma_f32_16x16x32_bf16 v[172:175], a[132:135], a[220:223], v[172:175]
ds_read_b64_tr_b16 a[150:151], v245 offset:25792
v_mfma_f32_16x16x32_bf16 v[172:175], a[128:131], a[216:219], v[172:175]
s_waitcnt lgkmcnt(4)
v_mfma_f32_16x16x32_bf16 v[188:191], a[136:139], a[216:219], v[188:191]
ds_read_b64_tr_b16 a[152:153], v245 offset:17120
v_mfma_f32_16x16x32_bf16 v[188:191], a[140:143], a[220:223], v[188:191]
buffer_load_dwordx4 a[40:43], v238, s[16:19], s34 offen sc1
v_mfma_f32_16x16x32_bf16 v[184:187], a[140:143], a[212:215], v[184:187]
ds_read_b64_tr_b16 a[154:155], v245 offset:17376
v_mfma_f32_16x16x32_bf16 v[184:187], a[136:139], a[208:211], v[184:187]
v_mfma_f32_16x16x32_bf16 v[180:183], a[136:139], a[200:203], v[180:183]
ds_read_b64_tr_b16 a[156:157], v245 offset:25568
buffer_load_dwordx4 a[48:51], v239, s[16:19], s34 offen sc1
v_mfma_f32_16x16x32_bf16 v[180:183], a[140:143], a[204:207], v[180:183]
s_waitcnt vmcnt(43)
s_barrier
v_mfma_f32_16x16x32_bf16 v[176:179], a[140:143], a[196:199], v[176:179]
ds_read_b64_tr_b16 a[158:159], v245 offset:25824
v_mfma_f32_16x16x32_bf16 v[176:179], a[136:139], a[192:195], v[176:179]
buffer_load_dword v252, v251, s[44:47], s50 offen offset:128 sc1
s_waitcnt lgkmcnt(4)
v_mfma_f32_16x16x32_bf16 v[192:195], a[144:147], a[192:195], v[192:195]
ds_read_b64_tr_b16 a[128:129], v245 offset:0
v_mfma_f32_16x16x32_bf16 v[192:195], a[148:151], a[196:199], v[192:195]
buffer_load_dwordx4 a[56:59], v240, s[16:19], s34 offen sc1
v_mfma_f32_16x16x32_bf16 v[196:199], a[148:151], a[204:207], v[196:199]
ds_read_b64_tr_b16 a[130:131], v245 offset:256
v_mfma_f32_16x16x32_bf16 v[196:199], a[144:147], a[200:203], v[196:199]
v_mfma_f32_16x16x32_bf16 v[200:203], a[144:147], a[208:211], v[200:203]
ds_read_b64_tr_b16 a[132:133], v245 offset:8448
v_mfma_f32_16x16x32_bf16 v[200:203], a[148:151], a[212:215], v[200:203]
s_add_u32 s34, s39, 4096
buffer_load_dwordx4 a[36:39], v237, s[16:19], s34 offen sc1
v_mfma_f32_16x16x32_bf16 v[204:207], a[148:151], a[220:223], v[204:207]
ds_read_b64_tr_b16 a[134:135], v245 offset:8704
v_mfma_f32_16x16x32_bf16 v[204:207], a[144:147], a[216:219], v[204:207]
s_waitcnt lgkmcnt(4)
v_mfma_f32_16x16x32_bf16 v[220:223], a[152:155], a[216:219], v[220:223]
ds_read_b64_tr_b16 a[136:137], v245 offset:32
v_mfma_f32_16x16x32_bf16 v[220:223], a[156:159], a[220:223], v[220:223]
buffer_load_dwordx4 a[44:47], v238, s[16:19], s34 offen sc1
v_mfma_f32_16x16x32_bf16 v[216:219], a[156:159], a[212:215], v[216:219]
ds_read_b64_tr_b16 a[138:139], v245 offset:288
v_mfma_f32_16x16x32_bf16 v[216:219], a[152:155], a[208:211], v[216:219]
v_mfma_f32_16x16x32_bf16 v[212:215], a[152:155], a[200:203], v[212:215]
ds_read_b64_tr_b16 a[140:141], v245 offset:8480
v_mfma_f32_16x16x32_bf16 v[212:215], a[156:159], a[204:207], v[212:215]
v_mfma_f32_16x16x32_bf16 v[208:211], a[156:159], a[196:199], v[208:211]
ds_read_b64_tr_b16 a[142:143], v245 offset:8736
buffer_load_dwordx4 a[52:55], v239, s[16:19], s34 offen sc1
v_mfma_f32_16x16x32_bf16 v[208:211], a[152:155], a[192:195], v[208:211]
s_waitcnt vmcnt(20) lgkmcnt(4)
v_mfma_f32_16x16x32_bf16 v[96:99], a[128:131], a[224:227], v[96:99]
ds_read_b64_tr_b16 a[144:145], v245 offset:64
v_mfma_f32_16x16x32_bf16 v[96:99], a[132:135], a[228:231], v[96:99]
s_waitcnt vmcnt(21)
buffer_store_dword v254, v250, s[44:47], s49 offen offset:256 sc1
v_mfma_f32_16x16x32_bf16 v[100:103], a[132:135], a[236:239], v[100:103]
ds_read_b64_tr_b16 a[146:147], v245 offset:320
v_mbcnt_lo_u32_b32 v228, -1, 0
v_mfma_f32_16x16x32_bf16 v[100:103], a[128:131], a[232:235], v[100:103]
buffer_load_dwordx4 a[60:63], v240, s[16:19], s34 offen sc1
v_mfma_f32_16x16x32_bf16 v[104:107], a[128:131], a[240:243], v[104:107]
ds_read_b64_tr_b16 a[148:149], v245 offset:8512
v_mbcnt_hi_u32_b32 v228, -1, v228
v_mfma_f32_16x16x32_bf16 v[104:107], a[132:135], a[244:247], v[104:107]
v_bfe_u32 v224, v228, 3, 1
v_mfma_f32_16x16x32_bf16 v[108:111], a[132:135], a[252:255], v[108:111]
ds_read_b64_tr_b16 a[150:151], v245 offset:8768
v_lshlrev_b32 v224, 16, v224
v_mfma_f32_16x16x32_bf16 v[108:111], a[128:131], a[248:251], v[108:111]
s_add_u32 m0, s4, 62464
s_waitcnt lgkmcnt(4)
v_mfma_f32_16x16x32_bf16 v[124:127], a[136:139], a[248:251], v[124:127]
ds_read_b64_tr_b16 a[152:153], v245 offset:96
s_add_u32 s35, s40, 65536
v_mfma_f32_16x16x32_bf16 v[124:127], a[140:143], a[252:255], v[124:127]
buffer_load_dwordx4 v241, s[20:23], s35 offen offset:0  lds
v_mfma_f32_16x16x32_bf16 v[120:123], a[140:143], a[244:247], v[120:123]
ds_read_b64_tr_b16 a[154:155], v245 offset:352
v_lshrrev_b32 v229, 4, v228
v_mfma_f32_16x16x32_bf16 v[120:123], a[136:139], a[240:243], v[120:123]
v_lshl_add_u32 v224, v229, 7, v224
v_mfma_f32_16x16x32_bf16 v[116:119], a[136:139], a[232:235], v[116:119]
ds_read_b64_tr_b16 a[156:157], v245 offset:8544
v_and_b32 v229, 7, v228
v_mfma_f32_16x16x32_bf16 v[116:119], a[140:143], a[236:239], v[116:119]
buffer_load_dwordx4 v242, s[20:23], s35 offen offset:1056  lds
v_mfma_f32_16x16x32_bf16 v[112:115], a[140:143], a[228:231], v[112:115]
ds_read_b64_tr_b16 a[158:159], v245 offset:8800
v_lshl_add_u32 v224, v229, 4, v224
v_mfma_f32_16x16x32_bf16 v[112:115], a[136:139], a[224:227], v[112:115]
v_add_u32 v225, 131072, v224
s_waitcnt lgkmcnt(4)
v_mfma_f32_16x16x32_bf16 v[128:131], a[144:147], a[224:227], v[128:131]
ds_read_b64_tr_b16 a[128:129], v245 offset:128
v_add_u32 v226, 262144, v224
v_mfma_f32_16x16x32_bf16 v[128:131], a[148:151], a[228:231], v[128:131]
buffer_load_dwordx4 v243, s[20:23], s35 offen offset:2112  lds
v_mfma_f32_16x16x32_bf16 v[132:135], a[148:151], a[236:239], v[132:135]
ds_read_b64_tr_b16 a[130:131], v245 offset:384
v_add_u32 v227, 393216, v224
v_mfma_f32_16x16x32_bf16 v[132:135], a[144:147], a[232:235], v[132:135]
v_lshrrev_b32 v229, 4, v228
v_mfma_f32_16x16x32_bf16 v[136:139], a[144:147], a[240:243], v[136:139]
ds_read_b64_tr_b16 a[132:133], v245 offset:8576
v_bfe_u32 v230, v228, 3, 1
v_mfma_f32_16x16x32_bf16 v[136:139], a[148:151], a[244:247], v[136:139]
buffer_load_dwordx4 v244, s[20:23], s35 offen offset:3168  lds
v_mfma_f32_16x16x32_bf16 v[140:143], a[148:151], a[252:255], v[140:143]
ds_read_b64_tr_b16 a[134:135], v245 offset:8832
v_lshl_add_u32 v229, v229, 3, v230
v_mfma_f32_16x16x32_bf16 v[140:143], a[144:147], a[248:251], v[140:143]
s_waitcnt vmcnt(10)
v_cmp_ne_u32 vcc, v254, v252
s_waitcnt lgkmcnt(4)
v_mfma_f32_16x16x32_bf16 v[156:159], a[152:155], a[248:251], v[156:159]
ds_read_b64_tr_b16 a[136:137], v245 offset:160
v_mul_u32_u24 v229, 4096, v229
v_mfma_f32_16x16x32_bf16 v[156:159], a[156:159], a[252:255], v[156:159]
s_cbranch_vccnz L_f_slow1
L_f_cont1:
v_lshlrev_b32 v230, 4, v228
v_mfma_f32_16x16x32_bf16 v[152:155], a[156:159], a[244:247], v[152:155]
ds_read_b64_tr_b16 a[138:139], v245 offset:416
s_add_u32 s34, s37, 8192
v_mfma_f32_16x16x32_bf16 v[152:155], a[152:155], a[240:243], v[152:155]
buffer_load_dwordx4 a[64:67], v237, s[16:19], s34 offen sc1
v_mfma_f32_16x16x32_bf16 v[148:151], a[152:155], a[232:235], v[148:151]
ds_read_b64_tr_b16 a[140:141], v245 offset:8608
v_bfe_u32 v231, v228, 3, 1
v_mfma_f32_16x16x32_bf16 v[148:151], a[156:159], a[236:239], v[148:151]
v_lshlrev_b32 v231, 9, v231
v_mfma_f32_16x16x32_bf16 v[144:147], a[156:159], a[228:231], v[144:147]
ds_read_b64_tr_b16 a[142:143], v245 offset:8864
v_and_b32 v232, 7, v228
v_mfma_f32_16x16x32_bf16 v[144:147], a[152:155], a[224:227], v[144:147]
v_lshl_add_u32 v231, v232, 2, v231
s_waitcnt lgkmcnt(4)
v_mfma_f32_16x16x32_bf16 v[160:163], a[128:131], a[224:227], v[160:163]
ds_read_b64_tr_b16 a[144:145], v245 offset:192
s_lshr_b32 s30, s48, 3
v_mfma_f32_16x16x32_bf16 v[160:163], a[132:135], a[228:231], v[160:163]
buffer_load_dwordx4 a[72:75], v238, s[16:19], s34 offen sc1
v_mfma_f32_16x16x32_bf16 v[164:167], a[132:135], a[236:239], v[164:167]
ds_read_b64_tr_b16 a[146:147], v245 offset:448
s_xor_b32 s30, s30, 3
v_mfma_f32_16x16x32_bf16 v[164:167], a[128:131], a[232:235], v[164:167]
buffer_load_dwordx4 a[80:83], v239, s[16:19], s34 offen sc1
v_mfma_f32_16x16x32_bf16 v[168:171], a[128:131], a[240:243], v[168:171]
ds_read_b64_tr_b16 a[148:149], v245 offset:8640
v_lshrrev_b32 v232, 5, v228
v_mfma_f32_16x16x32_bf16 v[168:171], a[132:135], a[244:247], v[168:171]
v_lshrrev_b32 v233, 4, v228
v_mfma_f32_16x16x32_bf16 v[172:175], a[132:135], a[252:255], v[172:175]
ds_read_b64_tr_b16 a[150:151], v245 offset:8896
v_min_u32 v233, 2, v233
v_mfma_f32_16x16x32_bf16 v[172:175], a[128:131], a[248:251], v[172:175]
v_xor_b32 v233, s30, v233
s_waitcnt lgkmcnt(4)
v_mfma_f32_16x16x32_bf16 v[188:191], a[136:139], a[248:251], v[188:191]
ds_read_b64_tr_b16 a[152:153], v245 offset:224
v_mul_u32_u24 v233, 32768, v233
v_mfma_f32_16x16x32_bf16 v[188:191], a[140:143], a[252:255], v[188:191]
buffer_load_dwordx4 a[88:91], v240, s[16:19], s34 offen sc1
v_mfma_f32_16x16x32_bf16 v[184:187], a[140:143], a[244:247], v[184:187]
ds_read_b64_tr_b16 a[154:155], v245 offset:480
v_lshl_add_u32 v233, v232, 7, v233
v_mfma_f32_16x16x32_bf16 v[184:187], a[136:139], a[240:243], v[184:187]
v_xor_b32 v232, s30, v232
v_mfma_f32_16x16x32_bf16 v[180:183], a[136:139], a[232:235], v[180:183]
ds_read_b64_tr_b16 a[156:157], v245 offset:8672
s_add_u32 s34, s38, 8192
v_mfma_f32_16x16x32_bf16 v[180:183], a[140:143], a[236:239], v[180:183]
s_waitcnt vmcnt(52)
s_barrier
v_mfma_f32_16x16x32_bf16 v[176:179], a[140:143], a[228:231], v[176:179]
ds_read_b64_tr_b16 a[158:159], v245 offset:8928
buffer_load_dwordx4 a[68:71], v237, s[16:19], s34 offen sc1
v_mfma_f32_16x16x32_bf16 v[176:179], a[136:139], a[224:227], v[176:179]
v_mul_u32_u24 v232, 32768, v232
s_waitcnt lgkmcnt(4)
v_mfma_f32_16x16x32_bf16 v[192:195], a[144:147], a[224:227], v[192:195]
ds_read_b64_tr_b16 a[128:129], v246 offset:33792
s_cmp_eq_u32 s99, 0
s_cselect_b32 s30, 0x40000000, 0
v_mfma_f32_16x16x32_bf16 v[192:195], a[148:151], a[228:231], v[192:195]
buffer_load_dwordx4 a[76:79], v238, s[16:19], s34 offen sc1
v_mfma_f32_16x16x32_bf16 v[196:199], a[148:151], a[236:239], v[196:199]
ds_read_b64_tr_b16 a[130:131], v246 offset:34048
s_add_u32 s31, s96, 49152
v_mfma_f32_16x16x32_bf16 v[196:199], a[144:147], a[232:235], v[196:199]
s_add_u32 s31, s31, s30
v_mfma_f32_16x16x32_bf16 v[200:203], a[144:147], a[240:243], v[200:203]
ds_read_b64_tr_b16 a[132:133], v246 offset:42240
s_lshl_b32 s33, s94, 2
v_mfma_f32_16x16x32_bf16 v[200:203], a[148:151], a[244:247], v[200:203]
buffer_load_dwordx4 a[84:87], v239, s[16:19], s34 offen sc1
v_mfma_f32_16x16x32_bf16 v[204:207], a[148:151], a[252:255], v[204:207]
ds_read_b64_tr_b16 a[134:135], v246 offset:42496
s_add_u32 s33, s33, s29
v_mfma_f32_16x16x32_bf16 v[204:207], a[144:147], a[248:251], v[204:207]
s_lshl_b32 s33, s33, 12
s_waitcnt lgkmcnt(4)
v_mfma_f32_16x16x32_bf16 v[220:223], a[152:155], a[248:251], v[220:223]
ds_read_b64_tr_b16 a[136:137], v246 offset:33824
s_bfe_u32 s53, s48, 0x20001
v_mfma_f32_16x16x32_bf16 v[220:223], a[156:159], a[252:255], v[220:223]
s_lshl_b32 s53, s53, 7
v_mfma_f32_16x16x32_bf16 v[216:219], a[156:159], a[244:247], v[216:219]
ds_read_b64_tr_b16 a[138:139], v246 offset:34080
s_add_u32 s33, s33, s53
v_mfma_f32_16x16x32_bf16 v[216:219], a[152:155], a[240:243], v[216:219]
buffer_load_dwordx4 a[92:95], v240, s[16:19], s34 offen sc1
v_mfma_f32_16x16x32_bf16 v[212:215], a[152:155], a[232:235], v[212:215]
ds_read_b64_tr_b16 a[140:141], v246 offset:42272
s_add_u32 s33, s33, 16777216
v_mfma_f32_16x16x32_bf16 v[212:215], a[156:159], a[236:239], v[212:215]
s_add_u32 s33, s33, s30
v_mfma_f32_16x16x32_bf16 v[208:211], a[156:159], a[228:231], v[208:211]
ds_read_b64_tr_b16 a[142:143], v246 offset:42528
s_add_u32 m0, s4, 45568
v_mfma_f32_16x16x32_bf16 v[208:211], a[152:155], a[224:227], v[208:211]
s_add_u32 s35, s41, 65536
s_waitcnt vmcnt(26) lgkmcnt(4)
v_mfma_f32_16x16x32_bf16 v[96:99], a[128:131], a[0:3], v[96:99]
ds_read_b64_tr_b16 a[144:145], v246 offset:33856
v_mfma_f32_16x16x32_bf16 v[96:99], a[132:135], a[4:7], v[96:99]
buffer_load_dwordx4 v241, s[20:23], s35 offen offset:0  lds
v_mfma_f32_16x16x32_bf16 v[100:103], a[132:135], a[12:15], v[100:103]
ds_read_b64_tr_b16 a[146:147], v246 offset:34112
v_mfma_f32_16x16x32_bf16 v[100:103], a[128:131], a[8:11], v[100:103]
buffer_load_dwordx4 v242, s[20:23], s35 offen offset:1056  lds
v_mfma_f32_16x16x32_bf16 v[104:107], a[128:131], a[16:19], v[104:107]
ds_read_b64_tr_b16 a[148:149], v246 offset:42304
v_mfma_f32_16x16x32_bf16 v[104:107], a[132:135], a[20:23], v[104:107]
v_mfma_f32_16x16x32_bf16 v[108:111], a[132:135], a[28:31], v[108:111]
ds_read_b64_tr_b16 a[150:151], v246 offset:42560
v_mfma_f32_16x16x32_bf16 v[108:111], a[128:131], a[24:27], v[108:111]
s_waitcnt lgkmcnt(4)
v_mfma_f32_16x16x32_bf16 v[124:127], a[136:139], a[24:27], v[124:127]
ds_read_b64_tr_b16 a[152:153], v246 offset:33888
v_mfma_f32_16x16x32_bf16 v[124:127], a[140:143], a[28:31], v[124:127]
buffer_load_dwordx4 v243, s[20:23], s35 offen offset:2112  lds
v_mfma_f32_16x16x32_bf16 v[120:123], a[140:143], a[20:23], v[120:123]
ds_read_b64_tr_b16 a[154:155], v246 offset:34144
v_mfma_f32_16x16x32_bf16 v[120:123], a[136:139], a[16:19], v[120:123]
v_mfma_f32_16x16x32_bf16 v[116:119], a[136:139], a[8:11], v[116:119]
ds_read_b64_tr_b16 a[156:157], v246 offset:42336
v_mfma_f32_16x16x32_bf16 v[116:119], a[140:143], a[12:15], v[116:119]
buffer_load_dwordx4 v244, s[20:23], s35 offen offset:3168  lds
v_mfma_f32_16x16x32_bf16 v[112:115], a[140:143], a[4:7], v[112:115]
ds_read_b64_tr_b16 a[158:159], v246 offset:42592
v_mfma_f32_16x16x32_bf16 v[112:115], a[136:139], a[0:3], v[112:115]
s_waitcnt lgkmcnt(4)
v_mfma_f32_16x16x32_bf16 v[128:131], a[144:147], a[0:3], v[128:131]
ds_read_b64_tr_b16 a[128:129], v246 offset:33920
v_mfma_f32_16x16x32_bf16 v[128:131], a[148:151], a[4:7], v[128:131]
s_add_u32 s34, s39, 8192
v_mfma_f32_16x16x32_bf16 v[132:135], a[148:151], a[12:15], v[132:135]
ds_read_b64_tr_b16 a[130:131], v246 offset:34176
v_mfma_f32_16x16x32_bf16 v[132:135], a[144:147], a[8:11], v[132:135]
buffer_load_dwordx4 a[160:163], v237, s[16:19], s34 offen sc1
v_mfma_f32_16x16x32_bf16 v[136:139], a[144:147], a[16:19], v[136:139]
ds_read_b64_tr_b16 a[132:133], v246 offset:42368
v_mfma_f32_16x16x32_bf16 v[136:139], a[148:151], a[20:23], v[136:139]
buffer_load_dwordx4 a[168:171], v238, s[16:19], s34 offen sc1
v_mfma_f32_16x16x32_bf16 v[140:143], a[148:151], a[28:31], v[140:143]
ds_read_b64_tr_b16 a[134:135], v246 offset:42624
v_mfma_f32_16x16x32_bf16 v[140:143], a[144:147], a[24:27], v[140:143]
s_waitcnt lgkmcnt(4)
v_mfma_f32_16x16x32_bf16 v[156:159], a[152:155], a[24:27], v[156:159]
ds_read_b64_tr_b16 a[136:137], v246 offset:33952
v_mfma_f32_16x16x32_bf16 v[156:159], a[156:159], a[28:31], v[156:159]
v_mfma_f32_16x16x32_bf16 v[152:155], a[156:159], a[20:23], v[152:155]
ds_read_b64_tr_b16 a[138:139], v246 offset:34208
v_mfma_f32_16x16x32_bf16 v[152:155], a[152:155], a[16:19], v[152:155]
buffer_load_dwordx4 a[176:179], v239, s[16:19], s34 offen sc1
v_mfma_f32_16x16x32_bf16 v[148:151], a[152:155], a[8:11], v[148:151]
ds_read_b64_tr_b16 a[140:141], v246 offset:42400
v_mfma_f32_16x16x32_bf16 v[148:151], a[156:159], a[12:15], v[148:151]
v_mfma_f32_16x16x32_bf16 v[144:147], a[156:159], a[4:7], v[144:147]
ds_read_b64_tr_b16 a[142:143], v246 offset:42656
v_mfma_f32_16x16x32_bf16 v[144:147], a[152:155], a[0:3], v[144:147]
s_waitcnt lgkmcnt(4)
v_mfma_f32_16x16x32_bf16 v[160:163], a[128:131], a[0:3], v[160:163]
ds_read_b64_tr_b16 a[144:145], v246 offset:33984
v_mfma_f32_16x16x32_bf16 v[160:163], a[132:135], a[4:7], v[160:163]
buffer_load_dwordx4 a[184:187], v240, s[16:19], s34 offen sc1
v_mfma_f32_16x16x32_bf16 v[164:167], a[132:135], a[12:15], v[164:167]
ds_read_b64_tr_b16 a[146:147], v246 offset:34240
v_mfma_f32_16x16x32_bf16 v[164:167], a[128:131], a[8:11], v[164:167]
s_add_u32 s34, s37, 12288
v_mfma_f32_16x16x32_bf16 v[168:171], a[128:131], a[16:19], v[168:171]
ds_read_b64_tr_b16 a[148:149], v246 offset:42432
v_mfma_f32_16x16x32_bf16 v[168:171], a[132:135], a[20:23], v[168:171]
buffer_load_dwordx4 a[164:167], v237, s[16:19], s34 offen sc1
v_mfma_f32_16x16x32_bf16 v[172:175], a[132:135], a[28:31], v[172:175]
ds_read_b64_tr_b16 a[150:151], v246 offset:42688
v_mfma_f32_16x16x32_bf16 v[172:175], a[128:131], a[24:27], v[172:175]
s_waitcnt lgkmcnt(4)
v_mfma_f32_16x16x32_bf16 v[188:191], a[136:139], a[24:27], v[188:191]
ds_read_b64_tr_b16 a[152:153], v246 offset:34016
v_mfma_f32_16x16x32_bf16 v[188:191], a[140:143], a[28:31], v[188:191]
buffer_load_dwordx4 a[172:175], v238, s[16:19], s34 offen sc1
v_mfma_f32_16x16x32_bf16 v[184:187], a[140:143], a[20:23], v[184:187]
ds_read_b64_tr_b16 a[154:155], v246 offset:34272
v_mfma_f32_16x16x32_bf16 v[184:187], a[136:139], a[16:19], v[184:187]
v_mfma_f32_16x16x32_bf16 v[180:183], a[136:139], a[8:11], v[180:183]
ds_read_b64_tr_b16 a[156:157], v246 offset:42464
buffer_load_dwordx4 a[180:183], v239, s[16:19], s34 offen sc1
v_mfma_f32_16x16x32_bf16 v[180:183], a[140:143], a[12:15], v[180:183]
s_waitcnt vmcnt(33)
s_barrier
v_mfma_f32_16x16x32_bf16 v[176:179], a[140:143], a[4:7], v[176:179]
ds_read_b64_tr_b16 a[158:159], v246 offset:42720
v_mfma_f32_16x16x32_bf16 v[176:179], a[136:139], a[0:3], v[176:179]
s_waitcnt lgkmcnt(4)
v_mfma_f32_16x16x32_bf16 v[192:195], a[144:147], a[0:3], v[192:195]
ds_read_b64_tr_b16 a[128:129], v246 offset:16896
v_mfma_f32_16x16x32_bf16 v[192:195], a[148:151], a[4:7], v[192:195]
buffer_load_dwordx4 a[188:191], v240, s[16:19], s34 offen sc1
v_mfma_f32_16x16x32_bf16 v[196:199], a[148:151], a[12:15], v[196:199]
ds_read_b64_tr_b16 a[130:131], v246 offset:17152
v_mfma_f32_16x16x32_bf16 v[196:199], a[144:147], a[8:11], v[196:199]
v_mfma_f32_16x16x32_bf16 v[200:203], a[144:147], a[16:19], v[200:203]
ds_read_b64_tr_b16 a[132:133], v246 offset:25344
v_mfma_f32_16x16x32_bf16 v[200:203], a[148:151], a[20:23], v[200:203]
s_add_u32 m0, s4, 28672
s_add_u32 s35, s42, 98304
v_mfma_f32_16x16x32_bf16 v[204:207], a[148:151], a[28:31], v[204:207]
ds_read_b64_tr_b16 a[134:135], v246 offset:25600
buffer_load_dwordx4 v241, s[20:23], s35 offen offset:0  lds
v_mfma_f32_16x16x32_bf16 v[204:207], a[144:147], a[24:27], v[204:207]
s_waitcnt lgkmcnt(4)
v_mfma_f32_16x16x32_bf16 v[220:223], a[152:155], a[24:27], v[220:223]
ds_read_b64_tr_b16 a[136:137], v246 offset:16928
v_mfma_f32_16x16x32_bf16 v[220:223], a[156:159], a[28:31], v[220:223]
v_mfma_f32_16x16x32_bf16 v[216:219], a[156:159], a[20:23], v[216:219]
ds_read_b64_tr_b16 a[138:139], v246 offset:17184
v_mfma_f32_16x16x32_bf16 v[216:219], a[152:155], a[16:19], v[216:219]
buffer_load_dwordx4 v242, s[20:23], s35 offen offset:1056  lds
v_mfma_f32_16x16x32_bf16 v[212:215], a[152:155], a[8:11], v[212:215]
ds_read_b64_tr_b16 a[140:141], v246 offset:25376
v_mfma_f32_16x16x32_bf16 v[212:215], a[156:159], a[12:15], v[212:215]
v_mfma_f32_16x16x32_bf16 v[208:211], a[156:159], a[4:7], v[208:211]
ds_read_b64_tr_b16 a[142:143], v246 offset:25632
v_mfma_f32_16x16x32_bf16 v[208:211], a[152:155], a[0:3], v[208:211]
s_waitcnt vmcnt(26) lgkmcnt(4)
v_mfma_f32_16x16x32_bf16 v[96:99], a[128:131], a[32:35], v[96:99]
ds_read_b64_tr_b16 a[144:145], v246 offset:16960
v_mfma_f32_16x16x32_bf16 v[96:99], a[132:135], a[36:39], v[96:99]
buffer_load_dwordx4 v243, s[20:23], s35 offen offset:2112  lds
v_mfma_f32_16x16x32_bf16 v[100:103], a[132:135], a[44:47], v[100:103]
ds_read_b64_tr_b16 a[146:147], v246 offset:17216
v_mfma_f32_16x16x32_bf16 v[100:103], a[128:131], a[40:43], v[100:103]
buffer_load_dwordx4 v244, s[20:23], s35 offen offset:3168  lds
v_mfma_f32_16x16x32_bf16 v[104:107], a[128:131], a[48:51], v[104:107]
ds_read_b64_tr_b16 a[148:149], v246 offset:25408
v_mfma_f32_16x16x32_bf16 v[104:107], a[132:135], a[52:55], v[104:107]
v_mfma_f32_16x16x32_bf16 v[108:111], a[132:135], a[60:63], v[108:111]
ds_read_b64_tr_b16 a[150:151], v246 offset:25664
v_mfma_f32_16x16x32_bf16 v[108:111], a[128:131], a[56:59], v[108:111]
s_waitcnt lgkmcnt(4)
v_mfma_f32_16x16x32_bf16 v[124:127], a[136:139], a[56:59], v[124:127]
ds_read_b64_tr_b16 a[152:153], v246 offset:16992
s_add_u32 s34, s38, 12288
v_mfma_f32_16x16x32_bf16 v[124:127], a[140:143], a[60:63], v[124:127]
buffer_load_dwordx4 a[192:195], v237, s[16:19], s34 offen sc1
v_mfma_f32_16x16x32_bf16 v[120:123], a[140:143], a[52:55], v[120:123]
ds_read_b64_tr_b16 a[154:155], v246 offset:17248
v_mfma_f32_16x16x32_bf16 v[120:123], a[136:139], a[48:51], v[120:123]
v_mfma_f32_16x16x32_bf16 v[116:119], a[136:139], a[40:43], v[116:119]
ds_read_b64_tr_b16 a[156:157], v246 offset:25440
v_mfma_f32_16x16x32_bf16 v[116:119], a[140:143], a[44:47], v[116:119]
buffer_load_dwordx4 a[200:203], v238, s[16:19], s34 offen sc1
v_mfma_f32_16x16x32_bf16 v[112:115], a[140:143], a[36:39], v[112:115]
ds_read_b64_tr_b16 a[158:159], v246 offset:25696
v_mfma_f32_16x16x32_bf16 v[112:115], a[136:139], a[32:35], v[112:115]
s_waitcnt lgkmcnt(4)
v_mfma_f32_16x16x32_bf16 v[128:131], a[144:147], a[32:35], v[128:131]
ds_read_b64_tr_b16 a[128:129], v246 offset:17024
v_mfma_f32_16x16x32_bf16 v[128:131], a[148:151], a[36:39], v[128:131]
buffer_load_dwordx4 a[208:211], v239, s[16:19], s34 offen sc1
v_mfma_f32_16x16x32_bf16 v[132:135], a[148:151], a[44:47], v[132:135]
ds_read_b64_tr_b16 a[130:131], v246 offset:17280
v_mfma_f32_16x16x32_bf16 v[132:135], a[144:147], a[40:43], v[132:135]
v_mfma_f32_16x16x32_bf16 v[136:139], a[144:147], a[48:51], v[136:139]
ds_read_b64_tr_b16 a[132:133], v246 offset:25472
v_mfma_f32_16x16x32_bf16 v[136:139], a[148:151], a[52:55], v[136:139]
v_mfma_f32_16x16x32_bf16 v[140:143], a[148:151], a[60:63], v[140:143]
ds_read_b64_tr_b16 a[134:135], v246 offset:25728
v_mfma_f32_16x16x32_bf16 v[140:143], a[144:147], a[56:59], v[140:143]
s_waitcnt lgkmcnt(4)
v_mfma_f32_16x16x32_bf16 v[156:159], a[152:155], a[56:59], v[156:159]
ds_read_b64_tr_b16 a[136:137], v246 offset:17056
v_mfma_f32_16x16x32_bf16 v[156:159], a[156:159], a[60:63], v[156:159]
buffer_load_dwordx4 a[216:219], v240, s[16:19], s34 offen sc1
v_mfma_f32_16x16x32_bf16 v[152:155], a[156:159], a[52:55], v[152:155]
ds_read_b64_tr_b16 a[138:139], v246 offset:17312
s_add_u32 s34, s39, 12288
v_mfma_f32_16x16x32_bf16 v[152:155], a[152:155], a[48:51], v[152:155]
buffer_load_dwordx4 a[196:199], v237, s[16:19], s34 offen sc1
v_mfma_f32_16x16x32_bf16 v[148:151], a[152:155], a[40:43], v[148:151]
ds_read_b64_tr_b16 a[140:141], v246 offset:25504
v_mfma_f32_16x16x32_bf16 v[148:151], a[156:159], a[44:47], v[148:151]
v_mfma_f32_16x16x32_bf16 v[144:147], a[156:159], a[36:39], v[144:147]
ds_read_b64_tr_b16 a[142:143], v246 offset:25760
v_mfma_f32_16x16x32_bf16 v[144:147], a[152:155], a[32:35], v[144:147]
s_waitcnt lgkmcnt(4)
v_mfma_f32_16x16x32_bf16 v[160:163], a[128:131], a[32:35], v[160:163]
ds_read_b64_tr_b16 a[144:145], v246 offset:17088
v_mfma_f32_16x16x32_bf16 v[160:163], a[132:135], a[36:39], v[160:163]
buffer_load_dwordx4 a[204:207], v238, s[16:19], s34 offen sc1
v_mfma_f32_16x16x32_bf16 v[164:167], a[132:135], a[44:47], v[164:167]
ds_read_b64_tr_b16 a[146:147], v246 offset:17344
v_mfma_f32_16x16x32_bf16 v[164:167], a[128:131], a[40:43], v[164:167]
buffer_load_dwordx4 a[212:215], v239, s[16:19], s34 offen sc1
v_mfma_f32_16x16x32_bf16 v[168:171], a[128:131], a[48:51], v[168:171]
ds_read_b64_tr_b16 a[148:149], v246 offset:25536
v_mfma_f32_16x16x32_bf16 v[168:171], a[132:135], a[52:55], v[168:171]
v_mfma_f32_16x16x32_bf16 v[172:175], a[132:135], a[60:63], v[172:175]
ds_read_b64_tr_b16 a[150:151], v246 offset:25792
v_mfma_f32_16x16x32_bf16 v[172:175], a[128:131], a[56:59], v[172:175]
s_waitcnt lgkmcnt(4)
v_mfma_f32_16x16x32_bf16 v[188:191], a[136:139], a[56:59], v[188:191]
ds_read_b64_tr_b16 a[152:153], v246 offset:17120
v_mfma_f32_16x16x32_bf16 v[188:191], a[140:143], a[60:63], v[188:191]
buffer_load_dwordx4 a[220:223], v240, s[16:19], s34 offen sc1
v_mfma_f32_16x16x32_bf16 v[184:187], a[140:143], a[52:55], v[184:187]
ds_read_b64_tr_b16 a[154:155], v246 offset:17376
v_mfma_f32_16x16x32_bf16 v[184:187], a[136:139], a[48:51], v[184:187]
v_mfma_f32_16x16x32_bf16 v[180:183], a[136:139], a[40:43], v[180:183]
ds_read_b64_tr_b16 a[156:157], v246 offset:25568
v_mfma_f32_16x16x32_bf16 v[180:183], a[140:143], a[44:47], v[180:183]
s_waitcnt vmcnt(32)
s_barrier
v_mfma_f32_16x16x32_bf16 v[176:179], a[140:143], a[36:39], v[176:179]
ds_read_b64_tr_b16 a[158:159], v246 offset:25824
s_add_u32 m0, s4, 146944
v_mfma_f32_16x16x32_bf16 v[176:179], a[136:139], a[32:35], v[176:179]
buffer_load_dword v252, v251, s[44:47], s50 offen offset:256 sc1
s_waitcnt lgkmcnt(4)
v_mfma_f32_16x16x32_bf16 v[192:195], a[144:147], a[32:35], v[192:195]
ds_read_b64_tr_b16 a[128:129], v246 offset:0
s_add_u32 s35, s40, 131072
v_mfma_f32_16x16x32_bf16 v[192:195], a[148:151], a[36:39], v[192:195]
buffer_load_dwordx4 v241, s[20:23], s35 offen offset:0  lds
v_mfma_f32_16x16x32_bf16 v[196:199], a[148:151], a[44:47], v[196:199]
ds_read_b64_tr_b16 a[130:131], v246 offset:256
v_mfma_f32_16x16x32_bf16 v[196:199], a[144:147], a[40:43], v[196:199]
buffer_load_dwordx4 v242, s[20:23], s35 offen offset:1056  lds
v_mfma_f32_16x16x32_bf16 v[200:203], a[144:147], a[48:51], v[200:203]
ds_read_b64_tr_b16 a[132:133], v246 offset:8448
v_mfma_f32_16x16x32_bf16 v[200:203], a[148:151], a[52:55], v[200:203]
v_mfma_f32_16x16x32_bf16 v[204:207], a[148:151], a[60:63], v[204:207]
ds_read_b64_tr_b16 a[134:135], v246 offset:8704
v_mfma_f32_16x16x32_bf16 v[204:207], a[144:147], a[56:59], v[204:207]
s_waitcnt lgkmcnt(4)
v_mfma_f32_16x16x32_bf16 v[220:223], a[152:155], a[56:59], v[220:223]
ds_read_b64_tr_b16 a[136:137], v246 offset:32
v_mfma_f32_16x16x32_bf16 v[220:223], a[156:159], a[60:63], v[220:223]
buffer_load_dwordx4 v243, s[20:23], s35 offen offset:2112  lds
v_mfma_f32_16x16x32_bf16 v[216:219], a[156:159], a[52:55], v[216:219]
ds_read_b64_tr_b16 a[138:139], v246 offset:288
v_mfma_f32_16x16x32_bf16 v[216:219], a[152:155], a[48:51], v[216:219]
buffer_load_dwordx4 v244, s[20:23], s35 offen offset:3168  lds
v_mfma_f32_16x16x32_bf16 v[212:215], a[152:155], a[40:43], v[212:215]
ds_read_b64_tr_b16 a[140:141], v246 offset:8480
v_mfma_f32_16x16x32_bf16 v[212:215], a[156:159], a[44:47], v[212:215]
v_mfma_f32_16x16x32_bf16 v[208:211], a[156:159], a[36:39], v[208:211]
ds_read_b64_tr_b16 a[142:143], v246 offset:8736
v_mfma_f32_16x16x32_bf16 v[208:211], a[152:155], a[32:35], v[208:211]
s_waitcnt vmcnt(29) lgkmcnt(4)
v_mfma_f32_16x16x32_bf16 v[96:99], a[128:131], a[64:67], v[96:99]
ds_read_b64_tr_b16 a[144:145], v246 offset:64
v_mfma_f32_16x16x32_bf16 v[96:99], a[132:135], a[68:71], v[96:99]
v_mfma_f32_16x16x32_bf16 v[100:103], a[132:135], a[76:79], v[100:103]
ds_read_b64_tr_b16 a[146:147], v246 offset:320
v_mfma_f32_16x16x32_bf16 v[100:103], a[128:131], a[72:75], v[100:103]
v_mfma_f32_16x16x32_bf16 v[104:107], a[128:131], a[80:83], v[104:107]
ds_read_b64_tr_b16 a[148:149], v246 offset:8512
v_mfma_f32_16x16x32_bf16 v[104:107], a[132:135], a[84:87], v[104:107]
v_mfma_f32_16x16x32_bf16 v[108:111], a[132:135], a[92:95], v[108:111]
ds_read_b64_tr_b16 a[150:151], v246 offset:8768
v_mfma_f32_16x16x32_bf16 v[108:111], a[128:131], a[88:91], v[108:111]
s_waitcnt lgkmcnt(4)
v_mfma_f32_16x16x32_bf16 v[124:127], a[136:139], a[88:91], v[124:127]
ds_read_b64_tr_b16 a[152:153], v246 offset:96
v_mfma_f32_16x16x32_bf16 v[124:127], a[140:143], a[92:95], v[124:127]
v_mfma_f32_16x16x32_bf16 v[120:123], a[140:143], a[84:87], v[120:123]
ds_read_b64_tr_b16 a[154:155], v246 offset:352
v_mfma_f32_16x16x32_bf16 v[120:123], a[136:139], a[80:83], v[120:123]
v_mfma_f32_16x16x32_bf16 v[116:119], a[136:139], a[72:75], v[116:119]
ds_read_b64_tr_b16 a[156:157], v246 offset:8544
v_mfma_f32_16x16x32_bf16 v[116:119], a[140:143], a[76:79], v[116:119]
v_mfma_f32_16x16x32_bf16 v[112:115], a[140:143], a[68:71], v[112:115]
ds_read_b64_tr_b16 a[158:159], v246 offset:8800
v_mfma_f32_16x16x32_bf16 v[112:115], a[136:139], a[64:67], v[112:115]
s_waitcnt lgkmcnt(4)
v_mfma_f32_16x16x32_bf16 v[128:131], a[144:147], a[64:67], v[128:131]
ds_read_b64_tr_b16 a[128:129], v246 offset:128
v_mfma_f32_16x16x32_bf16 v[128:131], a[148:151], a[68:71], v[128:131]
v_mfma_f32_16x16x32_bf16 v[132:135], a[148:151], a[76:79], v[132:135]
ds_read_b64_tr_b16 a[130:131], v246 offset:384
v_mfma_f32_16x16x32_bf16 v[132:135], a[144:147], a[72:75], v[132:135]
v_mfma_f32_16x16x32_bf16 v[136:139], a[144:147], a[80:83], v[136:139]
ds_read_b64_tr_b16 a[132:133], v246 offset:8576
v_mfma_f32_16x16x32_bf16 v[136:139], a[148:151], a[84:87], v[136:139]
v_mfma_f32_16x16x32_bf16 v[140:143], a[148:151], a[92:95], v[140:143]
ds_read_b64_tr_b16 a[134:135], v246 offset:8832
v_mfma_f32_16x16x32_bf16 v[140:143], a[144:147], a[88:91], v[140:143]
s_waitcnt vmcnt(4)
v_cmp_ne_u32 vcc, v254, v252
s_waitcnt lgkmcnt(4)
v_mfma_f32_16x16x32_bf16 v[156:159], a[152:155], a[88:91], v[156:159]
ds_read_b64_tr_b16 a[136:137], v246 offset:160
v_mfma_f32_16x16x32_bf16 v[156:159], a[156:159], a[92:95], v[156:159]
s_cbranch_vccnz L_f_slow2
L_f_cont2:
v_mfma_f32_16x16x32_bf16 v[152:155], a[156:159], a[84:87], v[152:155]
ds_read_b64_tr_b16 a[138:139], v246 offset:416
s_add_u32 s34, s37, 16384
v_mfma_f32_16x16x32_bf16 v[152:155], a[152:155], a[80:83], v[152:155]
buffer_load_dwordx4 a[224:227], v237, s[16:19], s34 offen sc1
v_mfma_f32_16x16x32_bf16 v[148:151], a[152:155], a[72:75], v[148:151]
ds_read_b64_tr_b16 a[140:141], v246 offset:8608
v_mfma_f32_16x16x32_bf16 v[148:151], a[156:159], a[76:79], v[148:151]
v_mfma_f32_16x16x32_bf16 v[144:147], a[156:159], a[68:71], v[144:147]
ds_read_b64_tr_b16 a[142:143], v246 offset:8864
v_mfma_f32_16x16x32_bf16 v[144:147], a[152:155], a[64:67], v[144:147]
s_waitcnt lgkmcnt(4)
v_mfma_f32_16x16x32_bf16 v[160:163], a[128:131], a[64:67], v[160:163]
ds_read_b64_tr_b16 a[144:145], v246 offset:192
v_mfma_f32_16x16x32_bf16 v[160:163], a[132:135], a[68:71], v[160:163]
buffer_load_dwordx4 a[232:235], v238, s[16:19], s34 offen sc1
v_mfma_f32_16x16x32_bf16 v[164:167], a[132:135], a[76:79], v[164:167]
ds_read_b64_tr_b16 a[146:147], v246 offset:448
v_mfma_f32_16x16x32_bf16 v[164:167], a[128:131], a[72:75], v[164:167]
buffer_load_dwordx4 a[240:243], v239, s[16:19], s34 offen sc1
v_mfma_f32_16x16x32_bf16 v[168:171], a[128:131], a[80:83], v[168:171]
ds_read_b64_tr_b16 a[148:149], v246 offset:8640
v_mfma_f32_16x16x32_bf16 v[168:171], a[132:135], a[84:87], v[168:171]
v_mfma_f32_16x16x32_bf16 v[172:175], a[132:135], a[92:95], v[172:175]
ds_read_b64_tr_b16 a[150:151], v246 offset:8896
v_mfma_f32_16x16x32_bf16 v[172:175], a[128:131], a[88:91], v[172:175]
s_waitcnt lgkmcnt(4)
v_mfma_f32_16x16x32_bf16 v[188:191], a[136:139], a[88:91], v[188:191]
ds_read_b64_tr_b16 a[152:153], v246 offset:224
v_mfma_f32_16x16x32_bf16 v[188:191], a[140:143], a[92:95], v[188:191]
buffer_load_dwordx4 a[248:251], v240, s[16:19], s34 offen sc1
v_mfma_f32_16x16x32_bf16 v[184:187], a[140:143], a[84:87], v[184:187]
ds_read_b64_tr_b16 a[154:155], v246 offset:480
s_add_u32 s34, s38, 16384
v_mfma_f32_16x16x32_bf16 v[184:187], a[136:139], a[80:83], v[184:187]
buffer_load_dwordx4 a[228:231], v237, s[16:19], s34 offen sc1
v_mfma_f32_16x16x32_bf16 v[180:183], a[136:139], a[72:75], v[180:183]
ds_read_b64_tr_b16 a[156:157], v246 offset:8672
v_mfma_f32_16x16x32_bf16 v[180:183], a[140:143], a[76:79], v[180:183]
s_waitcnt vmcnt(30)
s_barrier
v_mfma_f32_16x16x32_bf16 v[176:179], a[140:143], a[68:71], v[176:179]
ds_read_b64_tr_b16 a[158:159], v246 offset:8928
v_mfma_f32_16x16x32_bf16 v[176:179], a[136:139], a[64:67], v[176:179]
s_waitcnt lgkmcnt(4)
v_mfma_f32_16x16x32_bf16 v[192:195], a[144:147], a[64:67], v[192:195]
ds_read_b64_tr_b16 a[128:129], v247 offset:33792
v_mfma_f32_16x16x32_bf16 v[192:195], a[148:151], a[68:71], v[192:195]
buffer_load_dwordx4 a[236:239], v238, s[16:19], s34 offen sc1
v_mfma_f32_16x16x32_bf16 v[196:199], a[148:151], a[76:79], v[196:199]
ds_read_b64_tr_b16 a[130:131], v247 offset:34048
v_mfma_f32_16x16x32_bf16 v[196:199], a[144:147], a[72:75], v[196:199]
buffer_load_dwordx4 a[244:247], v239, s[16:19], s34 offen sc1
v_mfma_f32_16x16x32_bf16 v[200:203], a[144:147], a[80:83], v[200:203]
ds_read_b64_tr_b16 a[132:133], v247 offset:42240
v_mfma_f32_16x16x32_bf16 v[200:203], a[148:151], a[84:87], v[200:203]
v_mfma_f32_16x16x32_bf16 v[204:207], a[148:151], a[92:95], v[204:207]
ds_read_b64_tr_b16 a[134:135], v247 offset:42496
v_mfma_f32_16x16x32_bf16 v[204:207], a[144:147], a[88:91], v[204:207]
s_waitcnt lgkmcnt(4)
v_mfma_f32_16x16x32_bf16 v[220:223], a[152:155], a[88:91], v[220:223]
ds_read_b64_tr_b16 a[136:137], v247 offset:33824
v_mfma_f32_16x16x32_bf16 v[220:223], a[156:159], a[92:95], v[220:223]
buffer_load_dwordx4 a[252:255], v240, s[16:19], s34 offen sc1
v_mfma_f32_16x16x32_bf16 v[216:219], a[156:159], a[84:87], v[216:219]
ds_read_b64_tr_b16 a[138:139], v247 offset:34080
v_mfma_f32_16x16x32_bf16 v[216:219], a[152:155], a[80:83], v[216:219]
s_add_u32 m0, s4, 130048
s_add_u32 s35, s41, 131072
v_mfma_f32_16x16x32_bf16 v[212:215], a[152:155], a[72:75], v[212:215]
ds_read_b64_tr_b16 a[140:141], v247 offset:42272
v_mfma_f32_16x16x32_bf16 v[212:215], a[156:159], a[76:79], v[212:215]
buffer_load_dwordx4 v241, s[20:23], s35 offen offset:0  lds
v_mfma_f32_16x16x32_bf16 v[208:211], a[156:159], a[68:71], v[208:211]
ds_read_b64_tr_b16 a[142:143], v247 offset:42528
v_mfma_f32_16x16x32_bf16 v[208:211], a[152:155], a[64:67], v[208:211]
s_waitcnt vmcnt(26) lgkmcnt(4)
v_mfma_f32_16x16x32_bf16 v[96:99], a[128:131], a[160:163], v[96:99]
ds_read_b64_tr_b16 a[144:145], v247 offset:33856
v_mfma_f32_16x16x32_bf16 v[96:99], a[132:135], a[164:167], v[96:99]
buffer_load_dwordx4 v242, s[20:23], s35 offen offset:1056  lds
v_mfma_f32_16x16x32_bf16 v[100:103], a[132:135], a[172:175], v[100:103]
ds_read_b64_tr_b16 a[146:147], v247 offset:34112
v_mfma_f32_16x16x32_bf16 v[100:103], a[128:131], a[168:171], v[100:103]
v_mfma_f32_16x16x32_bf16 v[104:107], a[128:131], a[176:179], v[104:107]
ds_read_b64_tr_b16 a[148:149], v247 offset:42304
v_mfma_f32_16x16x32_bf16 v[104:107], a[132:135], a[180:183], v[104:107]
buffer_load_dwordx4 v243, s[20:23], s35 offen offset:2112  lds
v_mfma_f32_16x16x32_bf16 v[108:111], a[132:135], a[188:191], v[108:111]
ds_read_b64_tr_b16 a[150:151], v247 offset:42560
v_mfma_f32_16x16x32_bf16 v[108:111], a[128:131], a[184:187], v[108:111]
s_waitcnt lgkmcnt(4)
v_mfma_f32_16x16x32_bf16 v[124:127], a[136:139], a[184:187], v[124:127]
ds_read_b64_tr_b16 a[152:153], v247 offset:33888
v_mfma_f32_16x16x32_bf16 v[124:127], a[140:143], a[188:191], v[124:127]
buffer_load_dwordx4 v244, s[20:23], s35 offen offset:3168  lds
v_mfma_f32_16x16x32_bf16 v[120:123], a[140:143], a[180:183], v[120:123]
ds_read_b64_tr_b16 a[154:155], v247 offset:34144
v_mfma_f32_16x16x32_bf16 v[120:123], a[136:139], a[176:179], v[120:123]
v_mfma_f32_16x16x32_bf16 v[116:119], a[136:139], a[168:171], v[116:119]
ds_read_b64_tr_b16 a[156:157], v247 offset:42336
s_add_u32 s34, s39, 16384
v_mfma_f32_16x16x32_bf16 v[116:119], a[140:143], a[172:175], v[116:119]
buffer_load_dwordx4 a[0:3], v237, s[16:19], s34 offen sc1
v_mfma_f32_16x16x32_bf16 v[112:115], a[140:143], a[164:167], v[112:115]
ds_read_b64_tr_b16 a[158:159], v247 offset:42592
v_mfma_f32_16x16x32_bf16 v[112:115], a[136:139], a[160:163], v[112:115]
s_waitcnt lgkmcnt(4)
v_mfma_f32_16x16x32_bf16 v[128:131], a[144:147], a[160:163], v[128:131]
ds_read_b64_tr_b16 a[128:129], v247 offset:33920
v_mfma_f32_16x16x32_bf16 v[128:131], a[148:151], a[164:167], v[128:131]
buffer_load_dwordx4 a[8:11], v238, s[16:19], s34 offen sc1
v_mfma_f32_16x16x32_bf16 v[132:135], a[148:151], a[172:175], v[132:135]
ds_read_b64_tr_b16 a[130:131], v247 offset:34176
v_mfma_f32_16x16x32_bf16 v[132:135], a[144:147], a[168:171], v[132:135]
v_mfma_f32_16x16x32_bf16 v[136:139], a[144:147], a[176:179], v[136:139]
ds_read_b64_tr_b16 a[132:133], v247 offset:42368
v_mfma_f32_16x16x32_bf16 v[136:139], a[148:151], a[180:183], v[136:139]
buffer_load_dwordx4 a[16:19], v239, s[16:19], s34 offen sc1
v_mfma_f32_16x16x32_bf16 v[140:143], a[148:151], a[188:191], v[140:143]
ds_read_b64_tr_b16 a[134:135], v247 offset:42624
v_mfma_f32_16x16x32_bf16 v[140:143], a[144:147], a[184:187], v[140:143]
s_waitcnt lgkmcnt(4)
v_mfma_f32_16x16x32_bf16 v[156:159], a[152:155], a[184:187], v[156:159]
ds_read_b64_tr_b16 a[136:137], v247 offset:33952
v_mfma_f32_16x16x32_bf16 v[156:159], a[156:159], a[188:191], v[156:159]
buffer_load_dwordx4 a[24:27], v240, s[16:19], s34 offen sc1
v_mfma_f32_16x16x32_bf16 v[152:155], a[156:159], a[180:183], v[152:155]
ds_read_b64_tr_b16 a[138:139], v247 offset:34208
v_mfma_f32_16x16x32_bf16 v[152:155], a[152:155], a[176:179], v[152:155]
v_mfma_f32_16x16x32_bf16 v[148:151], a[152:155], a[168:171], v[148:151]
ds_read_b64_tr_b16 a[140:141], v247 offset:42400
v_mfma_f32_16x16x32_bf16 v[148:151], a[156:159], a[172:175], v[148:151]
s_add_u32 s34, s37, 20480
buffer_load_dwordx4 a[4:7], v237, s[16:19], s34 offen sc1
v_mfma_f32_16x16x32_bf16 v[144:147], a[156:159], a[164:167], v[144:147]
ds_read_b64_tr_b16 a[142:143], v247 offset:42656
v_mfma_f32_16x16x32_bf16 v[144:147], a[152:155], a[160:163], v[144:147]
s_waitcnt lgkmcnt(4)
v_mfma_f32_16x16x32_bf16 v[160:163], a[128:131], a[160:163], v[160:163]
ds_read_b64_tr_b16 a[144:145], v247 offset:33984
v_mfma_f32_16x16x32_bf16 v[160:163], a[132:135], a[164:167], v[160:163]
buffer_load_dwordx4 a[12:15], v238, s[16:19], s34 offen sc1
v_mfma_f32_16x16x32_bf16 v[164:167], a[132:135], a[172:175], v[164:167]
ds_read_b64_tr_b16 a[146:147], v247 offset:34240
v_mfma_f32_16x16x32_bf16 v[164:167], a[128:131], a[168:171], v[164:167]
v_mfma_f32_16x16x32_bf16 v[168:171], a[128:131], a[176:179], v[168:171]
ds_read_b64_tr_b16 a[148:149], v247 offset:42432
v_mfma_f32_16x16x32_bf16 v[168:171], a[132:135], a[180:183], v[168:171]
buffer_load_dwordx4 a[20:23], v239, s[16:19], s34 offen sc1
v_mfma_f32_16x16x32_bf16 v[172:175], a[132:135], a[188:191], v[172:175]
ds_read_b64_tr_b16 a[150:151], v247 offset:42688
v_mfma_f32_16x16x32_bf16 v[172:175], a[128:131], a[184:187], v[172:175]
s_waitcnt lgkmcnt(4)
v_mfma_f32_16x16x32_bf16 v[188:191], a[136:139], a[184:187], v[188:191]
ds_read_b64_tr_b16 a[152:153], v247 offset:34016
v_mfma_f32_16x16x32_bf16 v[188:191], a[140:143], a[188:191], v[188:191]
buffer_load_dwordx4 a[28:31], v240, s[16:19], s34 offen sc1
v_mfma_f32_16x16x32_bf16 v[184:187], a[140:143], a[180:183], v[184:187]
ds_read_b64_tr_b16 a[154:155], v247 offset:34272
v_mfma_f32_16x16x32_bf16 v[184:187], a[136:139], a[176:179], v[184:187]
v_mfma_f32_16x16x32_bf16 v[180:183], a[136:139], a[168:171], v[180:183]
ds_read_b64_tr_b16 a[156:157], v247 offset:42464
v_mfma_f32_16x16x32_bf16 v[180:183], a[140:143], a[172:175], v[180:183]
s_waitcnt vmcnt(33)
s_barrier
v_mfma_f32_16x16x32_bf16 v[176:179], a[140:143], a[164:167], v[176:179]
ds_read_b64_tr_b16 a[158:159], v247 offset:42720
s_add_u32 m0, s4, 113152
v_mfma_f32_16x16x32_bf16 v[176:179], a[136:139], a[160:163], v[176:179]
s_add_u32 s35, s42, 163840
s_waitcnt lgkmcnt(4)
v_mfma_f32_16x16x32_bf16 v[192:195], a[144:147], a[160:163], v[192:195]
ds_read_b64_tr_b16 a[128:129], v247 offset:16896
v_mfma_f32_16x16x32_bf16 v[192:195], a[148:151], a[164:167], v[192:195]
buffer_load_dwordx4 v241, s[20:23], s35 offen offset:0  lds
v_mfma_f32_16x16x32_bf16 v[196:199], a[148:151], a[172:175], v[196:199]
ds_read_b64_tr_b16 a[130:131], v247 offset:17152
v_mfma_f32_16x16x32_bf16 v[196:199], a[144:147], a[168:171], v[196:199]
buffer_load_dwordx4 v242, s[20:23], s35 offen offset:1056  lds
v_mfma_f32_16x16x32_bf16 v[200:203], a[144:147], a[176:179], v[200:203]
ds_read_b64_tr_b16 a[132:133], v247 offset:25344
v_mfma_f32_16x16x32_bf16 v[200:203], a[148:151], a[180:183], v[200:203]
v_mfma_f32_16x16x32_bf16 v[204:207], a[148:151], a[188:191], v[204:207]
ds_read_b64_tr_b16 a[134:135], v247 offset:25600
v_mfma_f32_16x16x32_bf16 v[204:207], a[144:147], a[184:187], v[204:207]
s_waitcnt lgkmcnt(4)
v_mfma_f32_16x16x32_bf16 v[220:223], a[152:155], a[184:187], v[220:223]
ds_read_b64_tr_b16 a[136:137], v247 offset:16928
v_mfma_f32_16x16x32_bf16 v[220:223], a[156:159], a[188:191], v[220:223]
buffer_load_dwordx4 v243, s[20:23], s35 offen offset:2112  lds
v_mfma_f32_16x16x32_bf16 v[216:219], a[156:159], a[180:183], v[216:219]
ds_read_b64_tr_b16 a[138:139], v247 offset:17184
v_mfma_f32_16x16x32_bf16 v[216:219], a[152:155], a[176:179], v[216:219]
buffer_load_dwordx4 v244, s[20:23], s35 offen offset:3168  lds
v_mfma_f32_16x16x32_bf16 v[212:215], a[152:155], a[168:171], v[212:215]
ds_read_b64_tr_b16 a[140:141], v247 offset:25376
v_mfma_f32_16x16x32_bf16 v[212:215], a[156:159], a[172:175], v[212:215]
v_mfma_f32_16x16x32_bf16 v[208:211], a[156:159], a[164:167], v[208:211]
ds_read_b64_tr_b16 a[142:143], v247 offset:25632
s_add_u32 s34, s38, 20480
v_mfma_f32_16x16x32_bf16 v[208:211], a[152:155], a[160:163], v[208:211]
s_waitcnt vmcnt(29) lgkmcnt(4)
v_mfma_f32_16x16x32_bf16 v[96:99], a[128:131], a[192:195], v[96:99]
ds_read_b64_tr_b16 a[144:145], v247 offset:16960
v_mfma_f32_16x16x32_bf16 v[96:99], a[132:135], a[196:199], v[96:99]
buffer_load_dwordx4 a[32:35], v237, s[16:19], s34 offen sc1
v_mfma_f32_16x16x32_bf16 v[100:103], a[132:135], a[204:207], v[100:103]
ds_read_b64_tr_b16 a[146:147], v247 offset:17216
v_mfma_f32_16x16x32_bf16 v[100:103], a[128:131], a[200:203], v[100:103]
buffer_load_dwordx4 a[40:43], v238, s[16:19], s34 offen sc1
v_mfma_f32_16x16x32_bf16 v[104:107], a[128:131], a[208:211], v[104:107]
ds_read_b64_tr_b16 a[148:149], v247 offset:25408
v_mfma_f32_16x16x32_bf16 v[104:107], a[132:135], a[212:215], v[104:107]
v_mfma_f32_16x16x32_bf16 v[108:111], a[132:135], a[220:223], v[108:111]
ds_read_b64_tr_b16 a[150:151], v247 offset:25664
v_mfma_f32_16x16x32_bf16 v[108:111], a[128:131], a[216:219], v[108:111]
s_waitcnt lgkmcnt(4)
v_mfma_f32_16x16x32_bf16 v[124:127], a[136:139], a[216:219], v[124:127]
ds_read_b64_tr_b16 a[152:153], v247 offset:16992
v_mfma_f32_16x16x32_bf16 v[124:127], a[140:143], a[220:223], v[124:127]
buffer_load_dwordx4 a[48:51], v239, s[16:19], s34 offen sc1
v_mfma_f32_16x16x32_bf16 v[120:123], a[140:143], a[212:215], v[120:123]
ds_read_b64_tr_b16 a[154:155], v247 offset:17248
v_mfma_f32_16x16x32_bf16 v[120:123], a[136:139], a[208:211], v[120:123]
buffer_load_dwordx4 a[56:59], v240, s[16:19], s34 offen sc1
v_mfma_f32_16x16x32_bf16 v[116:119], a[136:139], a[200:203], v[116:119]
ds_read_b64_tr_b16 a[156:157], v247 offset:25440
v_mfma_f32_16x16x32_bf16 v[116:119], a[140:143], a[204:207], v[116:119]
v_mfma_f32_16x16x32_bf16 v[112:115], a[140:143], a[196:199], v[112:115]
ds_read_b64_tr_b16 a[158:159], v247 offset:25696
v_mfma_f32_16x16x32_bf16 v[112:115], a[136:139], a[192:195], v[112:115]
s_add_u32 s34, s39, 20480
s_waitcnt lgkmcnt(4)
v_mfma_f32_16x16x32_bf16 v[128:131], a[144:147], a[192:195], v[128:131]
ds_read_b64_tr_b16 a[128:129], v247 offset:17024
v_mfma_f32_16x16x32_bf16 v[128:131], a[148:151], a[196:199], v[128:131]
buffer_load_dwordx4 a[36:39], v237, s[16:19], s34 offen sc1
v_mfma_f32_16x16x32_bf16 v[132:135], a[148:151], a[204:207], v[132:135]
ds_read_b64_tr_b16 a[130:131], v247 offset:17280
v_mfma_f32_16x16x32_bf16 v[132:135], a[144:147], a[200:203], v[132:135]
buffer_load_dwordx4 a[44:47], v238, s[16:19], s34 offen sc1
v_mfma_f32_16x16x32_bf16 v[136:139], a[144:147], a[208:211], v[136:139]
ds_read_b64_tr_b16 a[132:133], v247 offset:25472
v_mfma_f32_16x16x32_bf16 v[136:139], a[148:151], a[212:215], v[136:139]
v_mfma_f32_16x16x32_bf16 v[140:143], a[148:151], a[220:223], v[140:143]
ds_read_b64_tr_b16 a[134:135], v247 offset:25728
v_mfma_f32_16x16x32_bf16 v[140:143], a[144:147], a[216:219], v[140:143]
s_waitcnt lgkmcnt(4)
v_mfma_f32_16x16x32_bf16 v[156:159], a[152:155], a[216:219], v[156:159]
ds_read_b64_tr_b16 a[136:137], v247 offset:17056
v_mfma_f32_16x16x32_bf16 v[156:159], a[156:159], a[220:223], v[156:159]
buffer_load_dwordx4 a[52:55], v239, s[16:19], s34 offen sc1
v_mfma_f32_16x16x32_bf16 v[152:155], a[156:159], a[212:215], v[152:155]
ds_read_b64_tr_b16 a[138:139], v247 offset:17312
v_mfma_f32_16x16x32_bf16 v[152:155], a[152:155], a[208:211], v[152:155]
v_mfma_f32_16x16x32_bf16 v[148:151], a[152:155], a[200:203], v[148:151]
ds_read_b64_tr_b16 a[140:141], v247 offset:25504
v_mfma_f32_16x16x32_bf16 v[148:151], a[156:159], a[204:207], v[148:151]
buffer_load_dwordx4 a[60:63], v240, s[16:19], s34 offen sc1
v_mfma_f32_16x16x32_bf16 v[144:147], a[156:159], a[196:199], v[144:147]
ds_read_b64_tr_b16 a[142:143], v247 offset:25760
v_mfma_f32_16x16x32_bf16 v[144:147], a[152:155], a[192:195], v[144:147]
s_waitcnt lgkmcnt(4)
v_mfma_f32_16x16x32_bf16 v[160:163], a[128:131], a[192:195], v[160:163]
ds_read_b64_tr_b16 a[144:145], v247 offset:17088
s_add_u32 m0, s4, 96256
v_mfma_f32_16x16x32_bf16 v[160:163], a[132:135], a[196:199], v[160:163]
s_add_u32 s35, s56, 0
v_mfma_f32_16x16x32_bf16 v[164:167], a[132:135], a[204:207], v[164:167]
ds_read_b64_tr_b16 a[146:147], v247 offset:17344
v_mfma_f32_16x16x32_bf16 v[164:167], a[128:131], a[200:203], v[164:167]
buffer_load_dwordx4 v22, s[20:23], s35 offen offset:0  lds
v_mfma_f32_16x16x32_bf16 v[168:171], a[128:131], a[208:211], v[168:171]
ds_read_b64_tr_b16 a[148:149], v247 offset:25536
s_add_u32 s35, s56, 992
v_mfma_f32_16x16x32_bf16 v[168:171], a[132:135], a[212:215], v[168:171]
buffer_load_dwordx4 v22, s[20:23], s35 offen offset:1056  lds
v_mfma_f32_16x16x32_bf16 v[172:175], a[132:135], a[220:223], v[172:175]
ds_read_b64_tr_b16 a[150:151], v247 offset:25792
v_mfma_f32_16x16x32_bf16 v[172:175], a[128:131], a[216:219], v[172:175]
s_waitcnt lgkmcnt(4)
v_mfma_f32_16x16x32_bf16 v[188:191], a[136:139], a[216:219], v[188:191]
ds_read_b64_tr_b16 a[152:153], v247 offset:17120
s_add_u32 s35, s56, 1984
v_mfma_f32_16x16x32_bf16 v[188:191], a[140:143], a[220:223], v[188:191]
buffer_load_dwordx4 v22, s[20:23], s35 offen offset:2112  lds
v_mfma_f32_16x16x32_bf16 v[184:187], a[140:143], a[212:215], v[184:187]
ds_read_b64_tr_b16 a[154:155], v247 offset:17376
v_mfma_f32_16x16x32_bf16 v[184:187], a[136:139], a[208:211], v[184:187]
v_mfma_f32_16x16x32_bf16 v[180:183], a[136:139], a[200:203], v[180:183]
ds_read_b64_tr_b16 a[156:157], v247 offset:25568
v_mfma_f32_16x16x32_bf16 v[180:183], a[140:143], a[204:207], v[180:183]
s_waitcnt vmcnt(35)
s_barrier
v_mfma_f32_16x16x32_bf16 v[176:179], a[140:143], a[196:199], v[176:179]
ds_read_b64_tr_b16 a[158:159], v247 offset:25824
s_add_u32 s35, s56, 2976
v_mfma_f32_16x16x32_bf16 v[176:179], a[136:139], a[192:195], v[176:179]
s_waitcnt lgkmcnt(4)
v_mfma_f32_16x16x32_bf16 v[192:195], a[144:147], a[192:195], v[192:195]
ds_read_b64_tr_b16 a[128:129], v245 offset:33792
v_mfma_f32_16x16x32_bf16 v[192:195], a[148:151], a[196:199], v[192:195]
buffer_load_dwordx4 v22, s[20:23], s35 offen offset:3168  lds
v_mfma_f32_16x16x32_bf16 v[196:199], a[148:151], a[204:207], v[196:199]
ds_read_b64_tr_b16 a[130:131], v245 offset:34048
s_add_u32 s34, s57, 8192
v_mfma_f32_16x16x32_bf16 v[196:199], a[144:147], a[200:203], v[196:199]
buffer_load_dwordx4 a[64:67], v23, s[16:19], s34 offen sc1
v_mfma_f32_16x16x32_bf16 v[200:203], a[144:147], a[208:211], v[200:203]
ds_read_b64_tr_b16 a[132:133], v245 offset:42240
v_mfma_f32_16x16x32_bf16 v[200:203], a[148:151], a[212:215], v[200:203]
s_add_u32 s34, s57, 122880
buffer_load_dwordx4 a[72:75], v23, s[16:19], s34 offen sc1
v_mfma_f32_16x16x32_bf16 v[204:207], a[148:151], a[220:223], v[204:207]
ds_read_b64_tr_b16 a[134:135], v245 offset:42496
v_mfma_f32_16x16x32_bf16 v[204:207], a[144:147], a[216:219], v[204:207]
s_waitcnt lgkmcnt(4)
v_mfma_f32_16x16x32_bf16 v[220:223], a[152:155], a[216:219], v[220:223]
ds_read_b64_tr_b16 a[136:137], v245 offset:33824
v_mfma_f32_16x16x32_bf16 v[220:223], a[156:159], a[220:223], v[220:223]
s_add_u32 s34, s57, 237568
v_mfma_f32_16x16x32_bf16 v[216:219], a[156:159], a[212:215], v[216:219]
ds_read_b64_tr_b16 a[138:139], v245 offset:34080
v_mfma_f32_16x16x32_bf16 v[216:219], a[152:155], a[208:211], v[216:219]
buffer_load_dwordx4 a[80:83], v23, s[16:19], s34 offen sc1
v_mfma_f32_16x16x32_bf16 v[212:215], a[152:155], a[200:203], v[212:215]
ds_read_b64_tr_b16 a[140:141], v245 offset:42272
v_mfma_f32_16x16x32_bf16 v[212:215], a[156:159], a[204:207], v[212:215]
v_mfma_f32_16x16x32_bf16 v[208:211], a[156:159], a[196:199], v[208:211]
ds_read_b64_tr_b16 a[142:143], v245 offset:42528
s_add_u32 s34, s57, 352256
v_mfma_f32_16x16x32_bf16 v[208:211], a[152:155], a[192:195], v[208:211]
s_waitcnt vmcnt(31) lgkmcnt(4)
v_mfma_f32_16x16x32_bf16 v[96:99], a[128:131], a[224:227], v[96:99]
ds_read_b64_tr_b16 a[144:145], v245 offset:33856
v_mfma_f32_16x16x32_bf16 v[96:99], a[132:135], a[228:231], v[96:99]
buffer_load_dwordx4 a[88:91], v23, s[16:19], s34 offen sc1
v_mfma_f32_16x16x32_bf16 v[100:103], a[132:135], a[236:239], v[100:103]
ds_read_b64_tr_b16 a[146:147], v245 offset:34112
s_add_u32 s34, s57, 16384
v_mfma_f32_16x16x32_bf16 v[100:103], a[128:131], a[232:235], v[100:103]
buffer_load_dwordx4 a[68:71], v23, s[16:19], s34 offen sc1
v_mfma_f32_16x16x32_bf16 v[104:107], a[128:131], a[240:243], v[104:107]
ds_read_b64_tr_b16 a[148:149], v245 offset:42304
v_mfma_f32_16x16x32_bf16 v[104:107], a[132:135], a[244:247], v[104:107]
v_mfma_f32_16x16x32_bf16 v[108:111], a[132:135], a[252:255], v[108:111]
ds_read_b64_tr_b16 a[150:151], v245 offset:42560
s_add_u32 s34, s57, 131072
v_mfma_f32_16x16x32_bf16 v[108:111], a[128:131], a[248:251], v[108:111]
s_waitcnt lgkmcnt(4)
v_mfma_f32_16x16x32_bf16 v[124:127], a[136:139], a[248:251], v[124:127]
ds_read_b64_tr_b16 a[152:153], v245 offset:33888
v_mfma_f32_16x16x32_bf16 v[124:127], a[140:143], a[252:255], v[124:127]
buffer_load_dwordx4 a[76:79], v23, s[16:19], s34 offen sc1
v_mfma_f32_16x16x32_bf16 v[120:123], a[140:143], a[244:247], v[120:123]
ds_read_b64_tr_b16 a[154:155], v245 offset:34144
s_add_u32 s34, s57, 245760
v_mfma_f32_16x16x32_bf16 v[120:123], a[136:139], a[240:243], v[120:123]
buffer_load_dwordx4 a[84:87], v23, s[16:19], s34 offen sc1
v_mfma_f32_16x16x32_bf16 v[116:119], a[136:139], a[232:235], v[116:119]
ds_read_b64_tr_b16 a[156:157], v245 offset:42336
v_mfma_f32_16x16x32_bf16 v[116:119], a[140:143], a[236:239], v[116:119]
v_mfma_f32_16x16x32_bf16 v[112:115], a[140:143], a[228:231], v[112:115]
ds_read_b64_tr_b16 a[158:159], v245 offset:42592
s_add_u32 s34, s57, 360448
v_mfma_f32_16x16x32_bf16 v[112:115], a[136:139], a[224:227], v[112:115]
s_waitcnt lgkmcnt(4)
v_mfma_f32_16x16x32_bf16 v[128:131], a[144:147], a[224:227], v[128:131]
ds_read_b64_tr_b16 a[128:129], v245 offset:33920
v_mfma_f32_16x16x32_bf16 v[128:131], a[148:151], a[228:231], v[128:131]
buffer_load_dwordx4 a[92:95], v23, s[16:19], s34 offen sc1
v_mfma_f32_16x16x32_bf16 v[132:135], a[148:151], a[236:239], v[132:135]
ds_read_b64_tr_b16 a[130:131], v245 offset:34176
v_mfma_f32_16x16x32_bf16 v[132:135], a[144:147], a[232:235], v[132:135]
s_add_u32 m0, s4, 79360
s_add_u32 s35, s40, 196608
v_mfma_f32_16x16x32_bf16 v[136:139], a[144:147], a[240:243], v[136:139]
ds_read_b64_tr_b16 a[132:133], v245 offset:42368
v_mfma_f32_16x16x32_bf16 v[136:139], a[148:151], a[244:247], v[136:139]
buffer_load_dwordx4 v241, s[20:23], s35 offen offset:0  lds
v_mfma_f32_16x16x32_bf16 v[140:143], a[148:151], a[252:255], v[140:143]
ds_read_b64_tr_b16 a[134:135], v245 offset:42624
v_mfma_f32_16x16x32_bf16 v[140:143], a[144:147], a[248:251], v[140:143]
s_waitcnt lgkmcnt(4)
v_mfma_f32_16x16x32_bf16 v[156:159], a[152:155], a[248:251], v[156:159]
ds_read_b64_tr_b16 a[136:137], v245 offset:33952
v_mfma_f32_16x16x32_bf16 v[156:159], a[156:159], a[252:255], v[156:159]
buffer_load_dwordx4 v242, s[20:23], s35 offen offset:1056  lds
v_mfma_f32_16x16x32_bf16 v[152:155], a[156:159], a[244:247], v[152:155]
ds_read_b64_tr_b16 a[138:139], v245 offset:34208
v_mfma_f32_16x16x32_bf16 v[152:155], a[152:155], a[240:243], v[152:155]
buffer_load_dwordx4 v243, s[20:23], s35 offen offset:2112  lds
v_mfma_f32_16x16x32_bf16 v[148:151], a[152:155], a[232:235], v[148:151]
ds_read_b64_tr_b16 a[140:141], v245 offset:42400
v_mfma_f32_16x16x32_bf16 v[148:151], a[156:159], a[236:239], v[148:151]
v_mfma_f32_16x16x32_bf16 v[144:147], a[156:159], a[228:231], v[144:147]
ds_read_b64_tr_b16 a[142:143], v245 offset:42656
v_mfma_f32_16x16x32_bf16 v[144:147], a[152:155], a[224:227], v[144:147]
s_waitcnt lgkmcnt(4)
v_mfma_f32_16x16x32_bf16 v[160:163], a[128:131], a[224:227], v[160:163]
ds_read_b64_tr_b16 a[144:145], v245 offset:33984
v_mfma_f32_16x16x32_bf16 v[160:163], a[132:135], a[228:231], v[160:163]
buffer_load_dwordx4 v244, s[20:23], s35 offen offset:3168  lds
v_mfma_f32_16x16x32_bf16 v[164:167], a[132:135], a[236:239], v[164:167]
ds_read_b64_tr_b16 a[146:147], v245 offset:34240
v_mfma_f32_16x16x32_bf16 v[164:167], a[128:131], a[232:235], v[164:167]
s_add_u32 s34, s37, 24576
v_mfma_f32_16x16x32_bf16 v[168:171], a[128:131], a[240:243], v[168:171]
ds_read_b64_tr_b16 a[148:149], v245 offset:42432
v_mfma_f32_16x16x32_bf16 v[168:171], a[132:135], a[244:247], v[168:171]
buffer_load_dwordx4 a[160:163], v237, s[16:19], s34 offen sc1
v_mfma_f32_16x16x32_bf16 v[172:175], a[132:135], a[252:255], v[172:175]
ds_read_b64_tr_b16 a[150:151], v245 offset:42688
v_mfma_f32_16x16x32_bf16 v[172:175], a[128:131], a[248:251], v[172:175]
s_waitcnt lgkmcnt(4)
v_mfma_f32_16x16x32_bf16 v[188:191], a[136:139], a[248:251], v[188:191]
ds_read_b64_tr_b16 a[152:153], v245 offset:34016
v_mfma_f32_16x16x32_bf16 v[188:191], a[140:143], a[252:255], v[188:191]
buffer_load_dwordx4 a[168:171], v238, s[16:19], s34 offen sc1
v_mfma_f32_16x16x32_bf16 v[184:187], a[140:143], a[244:247], v[184:187]
ds_read_b64_tr_b16 a[154:155], v245 offset:34272
v_mfma_f32_16x16x32_bf16 v[184:187], a[136:139], a[240:243], v[184:187]
v_mfma_f32_16x16x32_bf16 v[180:183], a[136:139], a[232:235], v[180:183]
ds_read_b64_tr_b16 a[156:157], v245 offset:42464
buffer_load_dwordx4 a[176:179], v239, s[16:19], s34 offen sc1
v_mfma_f32_16x16x32_bf16 v[180:183], a[140:143], a[236:239], v[180:183]
s_waitcnt vmcnt(39)
s_barrier
v_mfma_f32_16x16x32_bf16 v[176:179], a[140:143], a[228:231], v[176:179]
ds_read_b64_tr_b16 a[158:159], v245 offset:42720
v_mfma_f32_16x16x32_bf16 v[176:179], a[136:139], a[224:227], v[176:179]
s_waitcnt lgkmcnt(4)
v_mfma_f32_16x16x32_bf16 v[192:195], a[144:147], a[224:227], v[192:195]
ds_read_b64_tr_b16 a[128:129], v245 offset:16896
v_mfma_f32_16x16x32_bf16 v[192:195], a[148:151], a[228:231], v[192:195]
buffer_load_dwordx4 a[184:187], v240, s[16:19], s34 offen sc1
v_mfma_f32_16x16x32_bf16 v[196:199], a[148:151], a[236:239], v[196:199]
ds_read_b64_tr_b16 a[130:131], v245 offset:17152
v_mfma_f32_16x16x32_bf16 v[196:199], a[144:147], a[232:235], v[196:199]
v_mfma_f32_16x16x32_bf16 v[200:203], a[144:147], a[240:243], v[200:203]
ds_read_b64_tr_b16 a[132:133], v245 offset:25344
s_add_u32 s34, s38, 24576
v_mfma_f32_16x16x32_bf16 v[200:203], a[148:151], a[244:247], v[200:203]
buffer_load_dwordx4 a[164:167], v237, s[16:19], s34 offen sc1
v_mfma_f32_16x16x32_bf16 v[204:207], a[148:151], a[252:255], v[204:207]
ds_read_b64_tr_b16 a[134:135], v245 offset:25600
v_mfma_f32_16x16x32_bf16 v[204:207], a[144:147], a[248:251], v[204:207]
s_waitcnt lgkmcnt(4)
v_mfma_f32_16x16x32_bf16 v[220:223], a[152:155], a[248:251], v[220:223]
ds_read_b64_tr_b16 a[136:137], v245 offset:16928
v_mfma_f32_16x16x32_bf16 v[220:223], a[156:159], a[252:255], v[220:223]
buffer_load_dwordx4 a[172:175], v238, s[16:19], s34 offen sc1
v_mfma_f32_16x16x32_bf16 v[216:219], a[156:159], a[244:247], v[216:219]
ds_read_b64_tr_b16 a[138:139], v245 offset:17184
v_mfma_f32_16x16x32_bf16 v[216:219], a[152:155], a[240:243], v[216:219]
v_mfma_f32_16x16x32_bf16 v[212:215], a[152:155], a[232:235], v[212:215]
ds_read_b64_tr_b16 a[140:141], v245 offset:25376
v_mfma_f32_16x16x32_bf16 v[212:215], a[156:159], a[236:239], v[212:215]
buffer_load_dwordx4 a[180:183], v239, s[16:19], s34 offen sc1
v_mfma_f32_16x16x32_bf16 v[208:211], a[156:159], a[228:231], v[208:211]
ds_read_b64_tr_b16 a[142:143], v245 offset:25632
v_mfma_f32_16x16x32_bf16 v[208:211], a[152:155], a[224:227], v[208:211]
s_waitcnt vmcnt(35) lgkmcnt(4)
v_mfma_f32_16x16x32_bf16 v[96:99], a[128:131], a[0:3], v[96:99]
ds_read_b64_tr_b16 a[144:145], v245 offset:16960
v_mfma_f32_16x16x32_bf16 v[96:99], a[132:135], a[4:7], v[96:99]
buffer_load_dwordx4 a[188:191], v240, s[16:19], s34 offen sc1
v_mfma_f32_16x16x32_bf16 v[100:103], a[132:135], a[12:15], v[100:103]
ds_read_b64_tr_b16 a[146:147], v245 offset:17216
v_mfma_f32_16x16x32_bf16 v[100:103], a[128:131], a[8:11], v[100:103]
v_mfma_f32_16x16x32_bf16 v[104:107], a[128:131], a[16:19], v[104:107]
ds_read_b64_tr_b16 a[148:149], v245 offset:25408
v_mfma_f32_16x16x32_bf16 v[104:107], a[132:135], a[20:23], v[104:107]
s_add_u32 m0, s4, 62464
s_add_u32 s35, s43, 196608
v_mfma_f32_16x16x32_bf16 v[108:111], a[132:135], a[28:31], v[108:111]
ds_read_b64_tr_b16 a[150:151], v245 offset:25664
buffer_load_dwordx4 v241, s[20:23], s35 offen offset:0  lds
v_mfma_f32_16x16x32_bf16 v[108:111], a[128:131], a[24:27], v[108:111]
s_waitcnt lgkmcnt(4)
v_mfma_f32_16x16x32_bf16 v[124:127], a[136:139], a[24:27], v[124:127]
ds_read_b64_tr_b16 a[152:153], v245 offset:16992
v_mfma_f32_16x16x32_bf16 v[124:127], a[140:143], a[28:31], v[124:127]
buffer_load_dwordx4 v242, s[20:23], s35 offen offset:1056  lds
v_mfma_f32_16x16x32_bf16 v[120:123], a[140:143], a[20:23], v[120:123]
ds_read_b64_tr_b16 a[154:155], v245 offset:17248
v_mfma_f32_16x16x32_bf16 v[120:123], a[136:139], a[16:19], v[120:123]
v_mfma_f32_16x16x32_bf16 v[116:119], a[136:139], a[8:11], v[116:119]
ds_read_b64_tr_b16 a[156:157], v245 offset:25440
v_mfma_f32_16x16x32_bf16 v[116:119], a[140:143], a[12:15], v[116:119]
buffer_load_dwordx4 v243, s[20:23], s35 offen offset:2112  lds
v_mfma_f32_16x16x32_bf16 v[112:115], a[140:143], a[4:7], v[112:115]
ds_read_b64_tr_b16 a[158:159], v245 offset:25696
v_mfma_f32_16x16x32_bf16 v[112:115], a[136:139], a[0:3], v[112:115]
s_waitcnt lgkmcnt(4)
v_mfma_f32_16x16x32_bf16 v[128:131], a[144:147], a[0:3], v[128:131]
ds_read_b64_tr_b16 a[128:129], v245 offset:17024
v_mfma_f32_16x16x32_bf16 v[128:131], a[148:151], a[4:7], v[128:131]
v_mfma_f32_16x16x32_bf16 v[132:135], a[148:151], a[12:15], v[132:135]
ds_read_b64_tr_b16 a[130:131], v245 offset:17280
v_mfma_f32_16x16x32_bf16 v[132:135], a[144:147], a[8:11], v[132:135]
buffer_load_dwordx4 v244, s[20:23], s35 offen offset:3168  lds
v_mfma_f32_16x16x32_bf16 v[136:139], a[144:147], a[16:19], v[136:139]
ds_read_b64_tr_b16 a[132:133], v245 offset:25472
v_mfma_f32_16x16x32_bf16 v[136:139], a[148:151], a[20:23], v[136:139]
v_mfma_f32_16x16x32_bf16 v[140:143], a[148:151], a[28:31], v[140:143]
ds_read_b64_tr_b16 a[134:135], v245 offset:25728
s_add_u32 s34, s39, 24576
v_mfma_f32_16x16x32_bf16 v[140:143], a[144:147], a[24:27], v[140:143]
s_waitcnt lgkmcnt(4)
v_mfma_f32_16x16x32_bf16 v[156:159], a[152:155], a[24:27], v[156:159]
ds_read_b64_tr_b16 a[136:137], v245 offset:17056
buffer_load_dword v252, v251, s[44:47], s60 offen sc1
v_mfma_f32_16x16x32_bf16 v[156:159], a[156:159], a[28:31], v[156:159]
buffer_load_dwordx4 a[192:195], v237, s[16:19], s34 offen sc1
v_mfma_f32_16x16x32_bf16 v[152:155], a[156:159], a[20:23], v[152:155]
ds_read_b64_tr_b16 a[138:139], v245 offset:17312
v_mfma_f32_16x16x32_bf16 v[152:155], a[152:155], a[16:19], v[152:155]
buffer_load_dwordx4 a[200:203], v238, s[16:19], s34 offen sc1
v_mfma_f32_16x16x32_bf16 v[148:151], a[152:155], a[8:11], v[148:151]
ds_read_b64_tr_b16 a[140:141], v245 offset:25504
v_mfma_f32_16x16x32_bf16 v[148:151], a[156:159], a[12:15], v[148:151]
v_mfma_f32_16x16x32_bf16 v[144:147], a[156:159], a[4:7], v[144:147]
ds_read_b64_tr_b16 a[142:143], v245 offset:25760
v_mfma_f32_16x16x32_bf16 v[144:147], a[152:155], a[0:3], v[144:147]
s_waitcnt lgkmcnt(4)
v_mfma_f32_16x16x32_bf16 v[160:163], a[128:131], a[0:3], v[160:163]
ds_read_b64_tr_b16 a[144:145], v245 offset:17088
v_mfma_f32_16x16x32_bf16 v[160:163], a[132:135], a[4:7], v[160:163]
buffer_load_dwordx4 a[208:211], v239, s[16:19], s34 offen sc1
v_mfma_f32_16x16x32_bf16 v[164:167], a[132:135], a[12:15], v[164:167]
ds_read_b64_tr_b16 a[146:147], v245 offset:17344
v_mfma_f32_16x16x32_bf16 v[164:167], a[128:131], a[8:11], v[164:167]
buffer_load_dwordx4 a[216:219], v240, s[16:19], s34 offen sc1
v_mfma_f32_16x16x32_bf16 v[168:171], a[128:131], a[16:19], v[168:171]
ds_read_b64_tr_b16 a[148:149], v245 offset:25536
v_mfma_f32_16x16x32_bf16 v[168:171], a[132:135], a[20:23], v[168:171]
v_mfma_f32_16x16x32_bf16 v[172:175], a[132:135], a[28:31], v[172:175]
ds_read_b64_tr_b16 a[150:151], v245 offset:25792
v_mfma_f32_16x16x32_bf16 v[172:175], a[128:131], a[24:27], v[172:175]
s_add_u32 s34, s36, 24576
s_waitcnt lgkmcnt(4)
v_mfma_f32_16x16x32_bf16 v[188:191], a[136:139], a[24:27], v[188:191]
ds_read_b64_tr_b16 a[152:153], v245 offset:17120
v_mfma_f32_16x16x32_bf16 v[188:191], a[140:143], a[28:31], v[188:191]
buffer_load_dwordx4 a[196:199], v237, s[16:19], s34 offen sc1
v_mfma_f32_16x16x32_bf16 v[184:187], a[140:143], a[20:23], v[184:187]
ds_read_b64_tr_b16 a[154:155], v245 offset:17376
v_mfma_f32_16x16x32_bf16 v[184:187], a[136:139], a[16:19], v[184:187]
buffer_load_dwordx4 a[204:207], v238, s[16:19], s34 offen sc1
v_mfma_f32_16x16x32_bf16 v[180:183], a[136:139], a[8:11], v[180:183]
ds_read_b64_tr_b16 a[156:157], v245 offset:25568
v_mfma_f32_16x16x32_bf16 v[180:183], a[140:143], a[12:15], v[180:183]
s_waitcnt vmcnt(31)
s_barrier
v_mfma_f32_16x16x32_bf16 v[176:179], a[140:143], a[4:7], v[176:179]
ds_read_b64_tr_b16 a[158:159], v245 offset:25824
v_mfma_f32_16x16x32_bf16 v[176:179], a[136:139], a[0:3], v[176:179]
s_waitcnt lgkmcnt(4)
v_mfma_f32_16x16x32_bf16 v[192:195], a[144:147], a[0:3], v[192:195]
ds_read_b64_tr_b16 a[128:129], v245 offset:0
v_mfma_f32_16x16x32_bf16 v[192:195], a[148:151], a[4:7], v[192:195]
buffer_load_dwordx4 a[212:215], v239, s[16:19], s34 offen sc1
v_mfma_f32_16x16x32_bf16 v[196:199], a[148:151], a[12:15], v[196:199]
ds_read_b64_tr_b16 a[130:131], v245 offset:256
v_mfma_f32_16x16x32_bf16 v[196:199], a[144:147], a[8:11], v[196:199]
buffer_load_dwordx4 a[220:223], v240, s[16:19], s34 offen sc1
v_mfma_f32_16x16x32_bf16 v[200:203], a[144:147], a[16:19], v[200:203]
ds_read_b64_tr_b16 a[132:133], v245 offset:8448
v_mfma_f32_16x16x32_bf16 v[200:203], a[148:151], a[20:23], v[200:203]
v_mfma_f32_16x16x32_bf16 v[204:207], a[148:151], a[28:31], v[204:207]
ds_read_b64_tr_b16 a[134:135], v245 offset:8704
v_mfma_f32_16x16x32_bf16 v[204:207], a[144:147], a[24:27], v[204:207]
s_waitcnt lgkmcnt(4)
v_mfma_f32_16x16x32_bf16 v[220:223], a[152:155], a[24:27], v[220:223]
ds_read_b64_tr_b16 a[136:137], v245 offset:32
v_mfma_f32_16x16x32_bf16 v[220:223], a[156:159], a[28:31], v[220:223]
v_mfma_f32_16x16x32_bf16 v[216:219], a[156:159], a[20:23], v[216:219]
ds_read_b64_tr_b16 a[138:139], v245 offset:288
v_mfma_f32_16x16x32_bf16 v[216:219], a[152:155], a[16:19], v[216:219]
v_mfma_f32_16x16x32_bf16 v[212:215], a[152:155], a[8:11], v[212:215]
ds_read_b64_tr_b16 a[140:141], v245 offset:8480
v_mfma_f32_16x16x32_bf16 v[212:215], a[156:159], a[12:15], v[212:215]
v_mfma_f32_16x16x32_bf16 v[208:211], a[156:159], a[4:7], v[208:211]
ds_read_b64_tr_b16 a[142:143], v245 offset:8736
v_mfma_f32_16x16x32_bf16 v[208:211], a[152:155], a[0:3], v[208:211]
s_waitcnt vmcnt(37) lgkmcnt(4)
v_mfma_f32_16x16x32_bf16 v[96:99], a[128:131], a[32:35], v[96:99]
ds_read_b64_tr_b16 a[144:145], v246 offset:33792
v_mfma_f32_16x16x32_bf16 v[96:99], a[132:135], a[36:39], v[96:99]
v_mfma_f32_16x16x32_bf16 v[100:103], a[132:135], a[44:47], v[100:103]
ds_read_b64_tr_b16 a[146:147], v246 offset:34048
v_mfma_f32_16x16x32_bf16 v[100:103], a[128:131], a[40:43], v[100:103]
v_mfma_f32_16x16x32_bf16 v[104:107], a[128:131], a[48:51], v[104:107]
ds_read_b64_tr_b16 a[148:149], v246 offset:42240
v_mfma_f32_16x16x32_bf16 v[104:107], a[132:135], a[52:55], v[104:107]
v_mfma_f32_16x16x32_bf16 v[108:111], a[132:135], a[60:63], v[108:111]
ds_read_b64_tr_b16 a[150:151], v246 offset:42496
v_mfma_f32_16x16x32_bf16 v[108:111], a[128:131], a[56:59], v[108:111]
s_waitcnt lgkmcnt(4)
v_mfma_f32_16x16x32_bf16 v[124:127], a[136:139], a[56:59], v[124:127]
ds_read_b64_tr_b16 a[152:153], v246 offset:33824
v_mfma_f32_16x16x32_bf16 v[124:127], a[140:143], a[60:63], v[124:127]
v_mfma_f32_16x16x32_bf16 v[120:123], a[140:143], a[52:55], v[120:123]
ds_read_b64_tr_b16 a[154:155], v246 offset:34080
v_mfma_f32_16x16x32_bf16 v[120:123], a[136:139], a[48:51], v[120:123]
s_waitcnt vmcnt(8)
v_cmp_ne_u32 vcc, v254, v252
v_mfma_f32_16x16x32_bf16 v[116:119], a[136:139], a[40:43], v[116:119]
ds_read_b64_tr_b16 a[156:157], v246 offset:42272
v_mfma_f32_16x16x32_bf16 v[116:119], a[140:143], a[44:47], v[116:119]
s_waitcnt vmcnt(9)
s_barrier
s_cbranch_vccnz L_f_slowq
L_f_contq:
v_mfma_f32_16x16x32_bf16 v[112:115], a[140:143], a[36:39], v[112:115]
ds_read_b64_tr_b16 a[158:159], v246 offset:42528
v_mfma_f32_16x16x32_bf16 v[112:115], a[136:139], a[32:35], v[112:115]
s_waitcnt vmcnt(25) lgkmcnt(4)
v_mfma_f32_16x16x32_bf16 v[96:99], a[144:147], a[64:67], v[96:99]
ds_read_b64_tr_b16 a[128:129], v246 offset:16896
v_mfma_f32_16x16x32_bf16 v[96:99], a[148:151], a[68:71], v[96:99]
v_mfma_f32_16x16x32_bf16 v[100:103], a[148:151], a[76:79], v[100:103]
ds_read_b64_tr_b16 a[130:131], v246 offset:17152
v_mfma_f32_16x16x32_bf16 v[100:103], a[144:147], a[72:75], v[100:103]
buffer_load_dwordx4 v[32:35], v224, s[24:27], s31 offen sc1
v_mfma_f32_16x16x32_bf16 v[104:107], a[144:147], a[80:83], v[104:107]
ds_read_b64_tr_b16 a[132:133], v246 offset:25344
v_mfma_f32_16x16x32_bf16 v[104:107], a[148:151], a[84:87], v[104:107]
buffer_load_dword v48, v231, s[24:27], s33 offen offset:0 sc1
v_mfma_f32_16x16x32_bf16 v[108:111], a[148:151], a[92:95], v[108:111]
ds_read_b64_tr_b16 a[134:135], v246 offset:25600
v_mfma_f32_16x16x32_bf16 v[108:111], a[144:147], a[88:91], v[108:111]
s_waitcnt lgkmcnt(4)
v_mfma_f32_16x16x32_bf16 v[124:127], a[152:155], a[88:91], v[124:127]
ds_read_b64_tr_b16 a[136:137], v246 offset:16928
v_mfma_f32_16x16x32_bf16 v[124:127], a[156:159], a[92:95], v[124:127]
buffer_load_dwordx4 v[36:39], v225, s[24:27], s31 offen sc1
v_mfma_f32_16x16x32_bf16 v[120:123], a[156:159], a[84:87], v[120:123]
ds_read_b64_tr_b16 a[138:139], v246 offset:17184
v_mfma_f32_16x16x32_bf16 v[120:123], a[152:155], a[80:83], v[120:123]
buffer_load_dword v49, v231, s[24:27], s33 offen offset:1024 sc1
v_mfma_f32_16x16x32_bf16 v[116:119], a[152:155], a[72:75], v[116:119]
ds_read_b64_tr_b16 a[140:141], v246 offset:25376
v_mfma_f32_16x16x32_bf16 v[116:119], a[156:159], a[76:79], v[116:119]
v_mfma_f32_16x16x32_bf16 v[112:115], a[156:159], a[68:71], v[112:115]
ds_read_b64_tr_b16 a[142:143], v246 offset:25632
v_mfma_f32_16x16x32_bf16 v[112:115], a[152:155], a[64:67], v[112:115]
s_waitcnt vmcnt(17) lgkmcnt(4)
v_mfma_f32_16x16x32_bf16 v[96:99], a[128:131], a[160:163], v[96:99]
ds_read_b64_tr_b16 a[144:145], v246 offset:0
v_mfma_f32_16x16x32_bf16 v[96:99], a[132:135], a[164:167], v[96:99]
buffer_load_dwordx4 v[40:43], v226, s[24:27], s31 offen sc1
v_mfma_f32_16x16x32_bf16 v[100:103], a[132:135], a[172:175], v[100:103]
ds_read_b64_tr_b16 a[146:147], v246 offset:256
v_mfma_f32_16x16x32_bf16 v[100:103], a[128:131], a[168:171], v[100:103]
buffer_load_dword v50, v231, s[24:27], s33 offen offset:2048 sc1
v_mfma_f32_16x16x32_bf16 v[104:107], a[128:131], a[176:179], v[104:107]
ds_read_b64_tr_b16 a[148:149], v246 offset:8448
v_mfma_f32_16x16x32_bf16 v[104:107], a[132:135], a[180:183], v[104:107]
v_mfma_f32_16x16x32_bf16 v[108:111], a[132:135], a[188:191], v[108:111]
ds_read_b64_tr_b16 a[150:151], v246 offset:8704
v_mfma_f32_16x16x32_bf16 v[108:111], a[128:131], a[184:187], v[108:111]
s_waitcnt lgkmcnt(4)
v_mfma_f32_16x16x32_bf16 v[124:127], a[136:139], a[184:187], v[124:127]
ds_read_b64_tr_b16 a[152:153], v246 offset:32
v_mfma_f32_16x16x32_bf16 v[124:127], a[140:143], a[188:191], v[124:127]
buffer_load_dwordx4 v[44:47], v227, s[24:27], s31 offen sc1
v_mfma_f32_16x16x32_bf16 v[120:123], a[140:143], a[180:183], v[120:123]
ds_read_b64_tr_b16 a[154:155], v246 offset:288
v_mfma_f32_16x16x32_bf16 v[120:123], a[136:139], a[176:179], v[120:123]
buffer_load_dword v51, v231, s[24:27], s33 offen offset:3072 sc1
v_mfma_f32_16x16x32_bf16 v[116:119], a[136:139], a[168:171], v[116:119]
ds_read_b64_tr_b16 a[156:157], v246 offset:8480
v_mfma_f32_16x16x32_bf16 v[116:119], a[140:143], a[172:175], v[116:119]
v_mfma_f32_16x16x32_bf16 v[112:115], a[140:143], a[164:167], v[112:115]
ds_read_b64_tr_b16 a[158:159], v246 offset:8736
v_mfma_f32_16x16x32_bf16 v[112:115], a[136:139], a[160:163], v[112:115]
s_waitcnt vmcnt(8) lgkmcnt(4)
v_mfma_f32_16x16x32_bf16 v[96:99], a[144:147], a[192:195], v[96:99]
ds_read_b64_tr_b16 a[128:129], v245 offset:64
v_mfma_f32_16x16x32_bf16 v[96:99], a[148:151], a[196:199], v[96:99]
v_mfma_f32_16x16x32_bf16 v[100:103], a[148:151], a[204:207], v[100:103]
ds_read_b64_tr_b16 a[130:131], v245 offset:320
v_mfma_f32_16x16x32_bf16 v[100:103], a[144:147], a[200:203], v[100:103]
v_mfma_f32_16x16x32_bf16 v[104:107], a[144:147], a[208:211], v[104:107]
ds_read_b64_tr_b16 a[132:133], v245 offset:8512
v_mfma_f32_16x16x32_bf16 v[104:107], a[148:151], a[212:215], v[104:107]
v_mfma_f32_16x16x32_bf16 v[108:111], a[148:151], a[220:223], v[108:111]
ds_read_b64_tr_b16 a[134:135], v245 offset:8768
v_mfma_f32_16x16x32_bf16 v[108:111], a[144:147], a[216:219], v[108:111]
s_waitcnt lgkmcnt(4)
v_mfma_f32_16x16x32_bf16 v[124:127], a[152:155], a[216:219], v[124:127]
ds_read_b64_tr_b16 a[136:137], v245 offset:96
v_mfma_f32_16x16x32_bf16 v[124:127], a[156:159], a[220:223], v[124:127]
v_mfma_f32_16x16x32_bf16 v[120:123], a[156:159], a[212:215], v[120:123]
ds_read_b64_tr_b16 a[138:139], v245 offset:352
v_mfma_f32_16x16x32_bf16 v[120:123], a[152:155], a[208:211], v[120:123]
v_mfma_f32_16x16x32_bf16 v[116:119], a[152:155], a[200:203], v[116:119]
ds_read_b64_tr_b16 a[140:141], v245 offset:8544
v_mfma_f32_16x16x32_bf16 v[116:119], a[156:159], a[204:207], v[116:119]
v_mfma_f32_16x16x32_bf16 v[112:115], a[156:159], a[196:199], v[112:115]
ds_read_b64_tr_b16 a[142:143], v245 offset:8800
v_mfma_f32_16x16x32_bf16 v[112:115], a[152:155], a[192:195], v[112:115]
s_waitcnt lgkmcnt(4)
v_mfma_f32_16x16x32_bf16 v[128:131], a[128:131], a[32:35], v[128:131]
ds_read_b64_tr_b16 a[144:145], v246 offset:33856
v_mfma_f32_16x16x32_bf16 v[128:131], a[132:135], a[36:39], v[128:131]
v_cvt_pk_bf16_f32 v108, v108, v109
v_mfma_f32_16x16x32_bf16 v[132:135], a[132:135], a[44:47], v[132:135]
ds_read_b64_tr_b16 a[146:147], v246 offset:34112
v_cvt_pk_bf16_f32 v109, v110, v111
v_mfma_f32_16x16x32_bf16 v[132:135], a[128:131], a[40:43], v[132:135]
v_cvt_pk_bf16_f32 v110, v124, v125
v_mfma_f32_16x16x32_bf16 v[136:139], a[128:131], a[48:51], v[136:139]
ds_read_b64_tr_b16 a[148:149], v246 offset:42304
v_cvt_pk_bf16_f32 v111, v126, v127
v_mfma_f32_16x16x32_bf16 v[136:139], a[132:135], a[52:55], v[136:139]
buffer_store_dwordx4 v[108:111], v227, s[24:27], s96 offen sc1
v_mfma_f32_16x16x32_bf16 v[140:143], a[132:135], a[60:63], v[140:143]
ds_read_b64_tr_b16 a[150:151], v246 offset:42560
v_cvt_pk_bf16_f32 v104, v104, v105
v_mfma_f32_16x16x32_bf16 v[140:143], a[128:131], a[56:59], v[140:143]
v_cvt_pk_bf16_f32 v105, v106, v107
s_waitcnt lgkmcnt(4)
v_mfma_f32_16x16x32_bf16 v[156:159], a[136:139], a[56:59], v[156:159]
ds_read_b64_tr_b16 a[152:153], v246 offset:33888
v_cvt_pk_bf16_f32 v106, v120, v121
v_mfma_f32_16x16x32_bf16 v[156:159], a[140:143], a[60:63], v[156:159]
v_cvt_pk_bf16_f32 v107, v122, v123
v_mfma_f32_16x16x32_bf16 v[152:155], a[140:143], a[52:55], v[152:155]
ds_read_b64_tr_b16 a[154:155], v246 offset:34144
v_mfma_f32_16x16x32_bf16 v[152:155], a[136:139], a[48:51], v[152:155]
buffer_store_dwordx4 v[104:107], v226, s[24:27], s96 offen sc1
v_mfma_f32_16x16x32_bf16 v[148:151], a[136:139], a[40:43], v[148:151]
ds_read_b64_tr_b16 a[156:157], v246 offset:42336
v_cvt_pk_bf16_f32 v100, v100, v101
v_mfma_f32_16x16x32_bf16 v[148:151], a[140:143], a[44:47], v[148:151]
v_cvt_pk_bf16_f32 v101, v102, v103
v_cvt_pk_bf16_f32 v102, v116, v117
v_mfma_f32_16x16x32_bf16 v[144:147], a[140:143], a[36:39], v[144:147]
ds_read_b64_tr_b16 a[158:159], v246 offset:42592
v_cvt_pk_bf16_f32 v103, v118, v119
v_mfma_f32_16x16x32_bf16 v[144:147], a[136:139], a[32:35], v[144:147]
s_waitcnt lgkmcnt(4)
v_mfma_f32_16x16x32_bf16 v[128:131], a[144:147], a[64:67], v[128:131]
ds_read_b64_tr_b16 a[128:129], v246 offset:16960
v_mfma_f32_16x16x32_bf16 v[128:131], a[148:151], a[68:71], v[128:131]
buffer_store_dwordx4 v[100:103], v225, s[24:27], s96 offen sc1
v_mfma_f32_16x16x32_bf16 v[132:135], a[148:151], a[76:79], v[132:135]
ds_read_b64_tr_b16 a[130:131], v246 offset:17216
v_cvt_pk_bf16_f32 v96, v96, v97
v_mfma_f32_16x16x32_bf16 v[132:135], a[144:147], a[72:75], v[132:135]
v_cvt_pk_bf16_f32 v97, v98, v99
v_cvt_pk_bf16_f32 v98, v112, v113
v_mfma_f32_16x16x32_bf16 v[136:139], a[144:147], a[80:83], v[136:139]
ds_read_b64_tr_b16 a[132:133], v246 offset:25408
v_cvt_pk_bf16_f32 v99, v114, v115
v_mfma_f32_16x16x32_bf16 v[136:139], a[148:151], a[84:87], v[136:139]
buffer_store_dwordx4 v[96:99], v224, s[24:27], s96 offen sc1
v_mfma_f32_16x16x32_bf16 v[140:143], a[148:151], a[92:95], v[140:143]
ds_read_b64_tr_b16 a[134:135], v246 offset:25664
s_add_u32 s96, s96, 16384
v_mfma_f32_16x16x32_bf16 v[140:143], a[144:147], a[88:91], v[140:143]
s_waitcnt lgkmcnt(4)
v_mfma_f32_16x16x32_bf16 v[156:159], a[152:155], a[88:91], v[156:159]
ds_read_b64_tr_b16 a[136:137], v246 offset:16992
v_mfma_f32_16x16x32_bf16 v[156:159], a[156:159], a[92:95], v[156:159]
v_mfma_f32_16x16x32_bf16 v[152:155], a[156:159], a[84:87], v[152:155]
ds_read_b64_tr_b16 a[138:139], v246 offset:17248
v_mfma_f32_16x16x32_bf16 v[152:155], a[152:155], a[80:83], v[152:155]
v_mfma_f32_16x16x32_bf16 v[148:151], a[152:155], a[72:75], v[148:151]
ds_read_b64_tr_b16 a[140:141], v246 offset:25440
v_mfma_f32_16x16x32_bf16 v[148:151], a[156:159], a[76:79], v[148:151]
v_mfma_f32_16x16x32_bf16 v[144:147], a[156:159], a[68:71], v[144:147]
ds_read_b64_tr_b16 a[142:143], v246 offset:25696
v_mfma_f32_16x16x32_bf16 v[144:147], a[152:155], a[64:67], v[144:147]
s_waitcnt lgkmcnt(4)
v_mfma_f32_16x16x32_bf16 v[128:131], a[128:131], a[160:163], v[128:131]
ds_read_b64_tr_b16 a[144:145], v246 offset:64
v_mfma_f32_16x16x32_bf16 v[128:131], a[132:135], a[164:167], v[128:131]
v_mfma_f32_16x16x32_bf16 v[132:135], a[132:135], a[172:175], v[132:135]
ds_read_b64_tr_b16 a[146:147], v246 offset:320
v_mfma_f32_16x16x32_bf16 v[132:135], a[128:131], a[168:171], v[132:135]
v_mfma_f32_16x16x32_bf16 v[136:139], a[128:131], a[176:179], v[136:139]
ds_read_b64_tr_b16 a[148:149], v246 offset:8512
v_mfma_f32_16x16x32_bf16 v[136:139], a[132:135], a[180:183], v[136:139]
v_mfma_f32_16x16x32_bf16 v[140:143], a[132:135], a[188:191], v[140:143]
ds_read_b64_tr_b16 a[150:151], v246 offset:8768
v_mfma_f32_16x16x32_bf16 v[140:143], a[128:131], a[184:187], v[140:143]
s_waitcnt lgkmcnt(4)
v_mfma_f32_16x16x32_bf16 v[156:159], a[136:139], a[184:187], v[156:159]
ds_read_b64_tr_b16 a[152:153], v246 offset:96
v_mfma_f32_16x16x32_bf16 v[156:159], a[140:143], a[188:191], v[156:159]
v_mfma_f32_16x16x32_bf16 v[152:155], a[140:143], a[180:183], v[152:155]
ds_read_b64_tr_b16 a[154:155], v246 offset:352
v_mfma_f32_16x16x32_bf16 v[152:155], a[136:139], a[176:179], v[152:155]
v_mfma_f32_16x16x32_bf16 v[148:151], a[136:139], a[168:171], v[148:151]
ds_read_b64_tr_b16 a[156:157], v246 offset:8544
v_mfma_f32_16x16x32_bf16 v[148:151], a[140:143], a[172:175], v[148:151]
v_mfma_f32_16x16x32_bf16 v[144:147], a[140:143], a[164:167], v[144:147]
ds_read_b64_tr_b16 a[158:159], v246 offset:8800
v_mfma_f32_16x16x32_bf16 v[144:147], a[136:139], a[160:163], v[144:147]
s_waitcnt lgkmcnt(4)
v_mfma_f32_16x16x32_bf16 v[128:131], a[144:147], a[192:195], v[128:131]
ds_read_b64_tr_b16 a[128:129], v245 offset:128
v_mfma_f32_16x16x32_bf16 v[128:131], a[148:151], a[196:199], v[128:131]
v_mfma_f32_16x16x32_bf16 v[132:135], a[148:151], a[204:207], v[132:135]
ds_read_b64_tr_b16 a[130:131], v245 offset:384
v_mfma_f32_16x16x32_bf16 v[132:135], a[144:147], a[200:203], v[132:135]
v_mfma_f32_16x16x32_bf16 v[136:139], a[144:147], a[208:211], v[136:139]
ds_read_b64_tr_b16 a[132:133], v245 offset:8576
v_mfma_f32_16x16x32_bf16 v[136:139], a[148:151], a[212:215], v[136:139]
v_mfma_f32_16x16x32_bf16 v[140:143], a[148:151], a[220:223], v[140:143]
ds_read_b64_tr_b16 a[134:135], v245 offset:8832
v_mfma_f32_16x16x32_bf16 v[140:143], a[144:147], a[216:219], v[140:143]
s_waitcnt lgkmcnt(4)
v_mfma_f32_16x16x32_bf16 v[156:159], a[152:155], a[216:219], v[156:159]
ds_read_b64_tr_b16 a[136:137], v245 offset:160
v_mfma_f32_16x16x32_bf16 v[156:159], a[156:159], a[220:223], v[156:159]
v_mfma_f32_16x16x32_bf16 v[152:155], a[156:159], a[212:215], v[152:155]
ds_read_b64_tr_b16 a[138:139], v245 offset:416
v_mfma_f32_16x16x32_bf16 v[152:155], a[152:155], a[208:211], v[152:155]
v_mfma_f32_16x16x32_bf16 v[148:151], a[152:155], a[200:203], v[148:151]
ds_read_b64_tr_b16 a[140:141], v245 offset:8608
v_mfma_f32_16x16x32_bf16 v[148:151], a[156:159], a[204:207], v[148:151]
v_mfma_f32_16x16x32_bf16 v[144:147], a[156:159], a[196:199], v[144:147]
ds_read_b64_tr_b16 a[142:143], v245 offset:8864
v_mfma_f32_16x16x32_bf16 v[144:147], a[152:155], a[192:195], v[144:147]
s_waitcnt lgkmcnt(4)
v_mfma_f32_16x16x32_bf16 v[160:163], a[128:131], a[32:35], v[160:163]
ds_read_b64_tr_b16 a[144:145], v246 offset:33920
v_mfma_f32_16x16x32_bf16 v[160:163], a[132:135], a[36:39], v[160:163]
v_cvt_pk_bf16_f32 v140, v140, v141
v_mfma_f32_16x16x32_bf16 v[164:167], a[132:135], a[44:47], v[164:167]
ds_read_b64_tr_b16 a[146:147], v246 offset:34176
v_cvt_pk_bf16_f32 v141, v142, v143
v_mfma_f32_16x16x32_bf16 v[164:167], a[128:131], a[40:43], v[164:167]
v_cvt_pk_bf16_f32 v142, v156, v157
v_mfma_f32_16x16x32_bf16 v[168:171], a[128:131], a[48:51], v[168:171]
ds_read_b64_tr_b16 a[148:149], v246 offset:42368
v_cvt_pk_bf16_f32 v143, v158, v159
v_mfma_f32_16x16x32_bf16 v[168:171], a[132:135], a[52:55], v[168:171]
buffer_store_dwordx4 v[140:143], v227, s[24:27], s96 offen sc1
v_mfma_f32_16x16x32_bf16 v[172:175], a[132:135], a[60:63], v[172:175]
ds_read_b64_tr_b16 a[150:151], v246 offset:42624
v_cvt_pk_bf16_f32 v136, v136, v137
v_mfma_f32_16x16x32_bf16 v[172:175], a[128:131], a[56:59], v[172:175]
v_cvt_pk_bf16_f32 v137, v138, v139
s_waitcnt lgkmcnt(4)
v_mfma_f32_16x16x32_bf16 v[188:191], a[136:139], a[56:59], v[188:191]
ds_read_b64_tr_b16 a[152:153], v246 offset:33952
v_cvt_pk_bf16_f32 v138, v152, v153
v_mfma_f32_16x16x32_bf16 v[188:191], a[140:143], a[60:63], v[188:191]
v_cvt_pk_bf16_f32 v139, v154, v155
v_mfma_f32_16x16x32_bf16 v[184:187], a[140:143], a[52:55], v[184:187]
ds_read_b64_tr_b16 a[154:155], v246 offset:34208
v_mfma_f32_16x16x32_bf16 v[184:187], a[136:139], a[48:51], v[184:187]
buffer_store_dwordx4 v[136:139], v226, s[24:27], s96 offen sc1
v_mfma_f32_16x16x32_bf16 v[180:183], a[136:139], a[40:43], v[180:183]
ds_read_b64_tr_b16 a[156:157], v246 offset:42400
v_cvt_pk_bf16_f32 v132, v132, v133
v_mfma_f32_16x16x32_bf16 v[180:183], a[140:143], a[44:47], v[180:183]
v_cvt_pk_bf16_f32 v133, v134, v135
v_cvt_pk_bf16_f32 v134, v148, v149
v_mfma_f32_16x16x32_bf16 v[176:179], a[140:143], a[36:39], v[176:179]
ds_read_b64_tr_b16 a[158:159], v246 offset:42656
v_cvt_pk_bf16_f32 v135, v150, v151
v_mfma_f32_16x16x32_bf16 v[176:179], a[136:139], a[32:35], v[176:179]
s_waitcnt lgkmcnt(4)
v_mfma_f32_16x16x32_bf16 v[160:163], a[144:147], a[64:67], v[160:163]
ds_read_b64_tr_b16 a[128:129], v246 offset:17024
v_mfma_f32_16x16x32_bf16 v[160:163], a[148:151], a[68:71], v[160:163]
buffer_store_dwordx4 v[132:135], v225, s[24:27], s96 offen sc1
v_mfma_f32_16x16x32_bf16 v[164:167], a[148:151], a[76:79], v[164:167]
ds_read_b64_tr_b16 a[130:131], v246 offset:17280
v_cvt_pk_bf16_f32 v128, v128, v129
v_mfma_f32_16x16x32_bf16 v[164:167], a[144:147], a[72:75], v[164:167]
v_cvt_pk_bf16_f32 v129, v130, v131
v_cvt_pk_bf16_f32 v130, v144, v145
v_mfma_f32_16x16x32_bf16 v[168:171], a[144:147], a[80:83], v[168:171]
ds_read_b64_tr_b16 a[132:133], v246 offset:25472
v_cvt_pk_bf16_f32 v131, v146, v147
v_mfma_f32_16x16x32_bf16 v[168:171], a[148:151], a[84:87], v[168:171]
buffer_store_dwordx4 v[128:131], v224, s[24:27], s96 offen sc1
v_mfma_f32_16x16x32_bf16 v[172:175], a[148:151], a[92:95], v[172:175]
ds_read_b64_tr_b16 a[134:135], v246 offset:25728
s_add_u32 s96, s96, 16384
v_mfma_f32_16x16x32_bf16 v[172:175], a[144:147], a[88:91], v[172:175]
s_waitcnt lgkmcnt(4)
v_mfma_f32_16x16x32_bf16 v[188:191], a[152:155], a[88:91], v[188:191]
ds_read_b64_tr_b16 a[136:137], v246 offset:17056
v_mfma_f32_16x16x32_bf16 v[188:191], a[156:159], a[92:95], v[188:191]
v_mfma_f32_16x16x32_bf16 v[184:187], a[156:159], a[84:87], v[184:187]
ds_read_b64_tr_b16 a[138:139], v246 offset:17312
v_mfma_f32_16x16x32_bf16 v[184:187], a[152:155], a[80:83], v[184:187]
v_mfma_f32_16x16x32_bf16 v[180:183], a[152:155], a[72:75], v[180:183]
ds_read_b64_tr_b16 a[140:141], v246 offset:25504
v_mfma_f32_16x16x32_bf16 v[180:183], a[156:159], a[76:79], v[180:183]
v_mfma_f32_16x16x32_bf16 v[176:179], a[156:159], a[68:71], v[176:179]
ds_read_b64_tr_b16 a[142:143], v246 offset:25760
v_mfma_f32_16x16x32_bf16 v[176:179], a[152:155], a[64:67], v[176:179]
s_waitcnt lgkmcnt(4)
v_mfma_f32_16x16x32_bf16 v[160:163], a[128:131], a[160:163], v[160:163]
ds_read_b64_tr_b16 a[144:145], v246 offset:128
v_mfma_f32_16x16x32_bf16 v[160:163], a[132:135], a[164:167], v[160:163]
v_mfma_f32_16x16x32_bf16 v[164:167], a[132:135], a[172:175], v[164:167]
ds_read_b64_tr_b16 a[146:147], v246 offset:384
v_mfma_f32_16x16x32_bf16 v[164:167], a[128:131], a[168:171], v[164:167]
v_mfma_f32_16x16x32_bf16 v[168:171], a[128:131], a[176:179], v[168:171]
ds_read_b64_tr_b16 a[148:149], v246 offset:8576
v_mfma_f32_16x16x32_bf16 v[168:171], a[132:135], a[180:183], v[168:171]
v_mfma_f32_16x16x32_bf16 v[172:175], a[132:135], a[188:191], v[172:175]
ds_read_b64_tr_b16 a[150:151], v246 offset:8832
v_mfma_f32_16x16x32_bf16 v[172:175], a[128:131], a[184:187], v[172:175]
s_waitcnt lgkmcnt(4)
v_mfma_f32_16x16x32_bf16 v[188:191], a[136:139], a[184:187], v[188:191]
ds_read_b64_tr_b16 a[152:153], v246 offset:160
v_mfma_f32_16x16x32_bf16 v[188:191], a[140:143], a[188:191], v[188:191]
v_mfma_f32_16x16x32_bf16 v[184:187], a[140:143], a[180:183], v[184:187]
ds_read_b64_tr_b16 a[154:155], v246 offset:416
v_mfma_f32_16x16x32_bf16 v[184:187], a[136:139], a[176:179], v[184:187]
v_mfma_f32_16x16x32_bf16 v[180:183], a[136:139], a[168:171], v[180:183]
ds_read_b64_tr_b16 a[156:157], v246 offset:8608
v_mfma_f32_16x16x32_bf16 v[180:183], a[140:143], a[172:175], v[180:183]
v_mfma_f32_16x16x32_bf16 v[176:179], a[140:143], a[164:167], v[176:179]
ds_read_b64_tr_b16 a[158:159], v246 offset:8864
v_mfma_f32_16x16x32_bf16 v[176:179], a[136:139], a[160:163], v[176:179]
s_waitcnt lgkmcnt(4)
v_mfma_f32_16x16x32_bf16 v[160:163], a[144:147], a[192:195], v[160:163]
ds_read_b64_tr_b16 a[128:129], v245 offset:192
v_mfma_f32_16x16x32_bf16 v[160:163], a[148:151], a[196:199], v[160:163]
v_mfma_f32_16x16x32_bf16 v[164:167], a[148:151], a[204:207], v[164:167]
ds_read_b64_tr_b16 a[130:131], v245 offset:448
v_mfma_f32_16x16x32_bf16 v[164:167], a[144:147], a[200:203], v[164:167]
v_mfma_f32_16x16x32_bf16 v[168:171], a[144:147], a[208:211], v[168:171]
ds_read_b64_tr_b16 a[132:133], v245 offset:8640
v_mfma_f32_16x16x32_bf16 v[168:171], a[148:151], a[212:215], v[168:171]
v_mfma_f32_16x16x32_bf16 v[172:175], a[148:151], a[220:223], v[172:175]
ds_read_b64_tr_b16 a[134:135], v245 offset:8896
v_mfma_f32_16x16x32_bf16 v[172:175], a[144:147], a[216:219], v[172:175]
s_waitcnt lgkmcnt(4)
v_mfma_f32_16x16x32_bf16 v[188:191], a[152:155], a[216:219], v[188:191]
ds_read_b64_tr_b16 a[136:137], v245 offset:224
v_mfma_f32_16x16x32_bf16 v[188:191], a[156:159], a[220:223], v[188:191]
v_mfma_f32_16x16x32_bf16 v[184:187], a[156:159], a[212:215], v[184:187]
ds_read_b64_tr_b16 a[138:139], v245 offset:480
v_mfma_f32_16x16x32_bf16 v[184:187], a[152:155], a[208:211], v[184:187]
v_mfma_f32_16x16x32_bf16 v[180:183], a[152:155], a[200:203], v[180:183]
ds_read_b64_tr_b16 a[140:141], v245 offset:8672
v_mfma_f32_16x16x32_bf16 v[180:183], a[156:159], a[204:207], v[180:183]
v_mfma_f32_16x16x32_bf16 v[176:179], a[156:159], a[196:199], v[176:179]
ds_read_b64_tr_b16 a[142:143], v245 offset:8928
v_mfma_f32_16x16x32_bf16 v[176:179], a[152:155], a[192:195], v[176:179]
s_waitcnt lgkmcnt(4)
v_mfma_f32_16x16x32_bf16 v[192:195], a[128:131], a[32:35], v[192:195]
ds_read_b64_tr_b16 a[144:145], v246 offset:33984
v_mfma_f32_16x16x32_bf16 v[192:195], a[132:135], a[36:39], v[192:195]
v_cvt_pk_bf16_f32 v172, v172, v173
v_mfma_f32_16x16x32_bf16 v[196:199], a[132:135], a[44:47], v[196:199]
ds_read_b64_tr_b16 a[146:147], v246 offset:34240
v_cvt_pk_bf16_f32 v173, v174, v175
v_mfma_f32_16x16x32_bf16 v[196:199], a[128:131], a[40:43], v[196:199]
v_cvt_pk_bf16_f32 v174, v188, v189
v_mfma_f32_16x16x32_bf16 v[200:203], a[128:131], a[48:51], v[200:203]
ds_read_b64_tr_b16 a[148:149], v246 offset:42432
v_cvt_pk_bf16_f32 v175, v190, v191
v_mfma_f32_16x16x32_bf16 v[200:203], a[132:135], a[52:55], v[200:203]
buffer_store_dwordx4 v[172:175], v227, s[24:27], s96 offen sc1
v_mfma_f32_16x16x32_bf16 v[204:207], a[132:135], a[60:63], v[204:207]
ds_read_b64_tr_b16 a[150:151], v246 offset:42688
v_cvt_pk_bf16_f32 v168, v168, v169
s_waitcnt vmcnt(1)
buffer_store_dword v254, v250, s[44:47], s49 offen offset:512 sc1
v_mfma_f32_16x16x32_bf16 v[204:207], a[128:131], a[56:59], v[204:207]
v_cvt_pk_bf16_f32 v169, v170, v171
s_waitcnt lgkmcnt(4)
v_mfma_f32_16x16x32_bf16 v[220:223], a[136:139], a[56:59], v[220:223]
ds_read_b64_tr_b16 a[152:153], v246 offset:34016
v_cvt_pk_bf16_f32 v170, v184, v185
v_mfma_f32_16x16x32_bf16 v[220:223], a[140:143], a[60:63], v[220:223]
v_cvt_pk_bf16_f32 v171, v186, v187
v_mfma_f32_16x16x32_bf16 v[216:219], a[140:143], a[52:55], v[216:219]
ds_read_b64_tr_b16 a[154:155], v246 offset:34272
v_mfma_f32_16x16x32_bf16 v[216:219], a[136:139], a[48:51], v[216:219]
buffer_store_dwordx4 v[168:171], v226, s[24:27], s96 offen sc1
v_mfma_f32_16x16x32_bf16 v[212:215], a[136:139], a[40:43], v[212:215]
ds_read_b64_tr_b16 a[156:157], v246 offset:42464
v_cvt_pk_bf16_f32 v164, v164, v165
v_mfma_f32_16x16x32_bf16 v[212:215], a[140:143], a[44:47], v[212:215]
v_cvt_pk_bf16_f32 v165, v166, v167
v_cvt_pk_bf16_f32 v166, v180, v181
v_mfma_f32_16x16x32_bf16 v[208:211], a[140:143], a[36:39], v[208:211]
ds_read_b64_tr_b16 a[158:159], v246 offset:42720
v_cvt_pk_bf16_f32 v167, v182, v183
v_mfma_f32_16x16x32_bf16 v[208:211], a[136:139], a[32:35], v[208:211]
s_waitcnt lgkmcnt(4)
v_mfma_f32_16x16x32_bf16 v[192:195], a[144:147], a[64:67], v[192:195]
ds_read_b64_tr_b16 a[128:129], v246 offset:17088
v_mfma_f32_16x16x32_bf16 v[192:195], a[148:151], a[68:71], v[192:195]
buffer_store_dwordx4 v[164:167], v225, s[24:27], s96 offen sc1
v_mfma_f32_16x16x32_bf16 v[196:199], a[148:151], a[76:79], v[196:199]
ds_read_b64_tr_b16 a[130:131], v246 offset:17344
v_cvt_pk_bf16_f32 v160, v160, v161
v_mfma_f32_16x16x32_bf16 v[196:199], a[144:147], a[72:75], v[196:199]
v_cvt_pk_bf16_f32 v161, v162, v163
v_cvt_pk_bf16_f32 v162, v176, v177
v_mfma_f32_16x16x32_bf16 v[200:203], a[144:147], a[80:83], v[200:203]
ds_read_b64_tr_b16 a[132:133], v246 offset:25536
v_cvt_pk_bf16_f32 v163, v178, v179
v_mfma_f32_16x16x32_bf16 v[200:203], a[148:151], a[84:87], v[200:203]
buffer_store_dwordx4 v[160:163], v224, s[24:27], s96 offen sc1
v_mfma_f32_16x16x32_bf16 v[204:207], a[148:151], a[92:95], v[204:207]
ds_read_b64_tr_b16 a[134:135], v246 offset:25792
s_add_u32 s96, s96, 16384
v_mfma_f32_16x16x32_bf16 v[204:207], a[144:147], a[88:91], v[204:207]
s_waitcnt lgkmcnt(4)
v_mfma_f32_16x16x32_bf16 v[220:223], a[152:155], a[88:91], v[220:223]
ds_read_b64_tr_b16 a[136:137], v246 offset:17120
v_mfma_f32_16x16x32_bf16 v[220:223], a[156:159], a[92:95], v[220:223]
v_mfma_f32_16x16x32_bf16 v[216:219], a[156:159], a[84:87], v[216:219]
ds_read_b64_tr_b16 a[138:139], v246 offset:17376
v_mfma_f32_16x16x32_bf16 v[216:219], a[152:155], a[80:83], v[216:219]
v_mfma_f32_16x16x32_bf16 v[212:215], a[152:155], a[72:75], v[212:215]
ds_read_b64_tr_b16 a[140:141], v246 offset:25568
v_mfma_f32_16x16x32_bf16 v[212:215], a[156:159], a[76:79], v[212:215]
v_mfma_f32_16x16x32_bf16 v[208:211], a[156:159], a[68:71], v[208:211]
ds_read_b64_tr_b16 a[142:143], v246 offset:25824
v_mfma_f32_16x16x32_bf16 v[208:211], a[152:155], a[64:67], v[208:211]
s_waitcnt lgkmcnt(4)
v_mfma_f32_16x16x32_bf16 v[192:195], a[128:131], a[160:163], v[192:195]
ds_read_b64_tr_b16 a[144:145], v246 offset:192
v_mfma_f32_16x16x32_bf16 v[192:195], a[132:135], a[164:167], v[192:195]
v_mfma_f32_16x16x32_bf16 v[196:199], a[132:135], a[172:175], v[196:199]
ds_read_b64_tr_b16 a[146:147], v246 offset:448
v_mfma_f32_16x16x32_bf16 v[196:199], a[128:131], a[168:171], v[196:199]
v_mfma_f32_16x16x32_bf16 v[200:203], a[128:131], a[176:179], v[200:203]
ds_read_b64_tr_b16 a[148:149], v246 offset:8640
v_mfma_f32_16x16x32_bf16 v[200:203], a[132:135], a[180:183], v[200:203]
v_mfma_f32_16x16x32_bf16 v[204:207], a[132:135], a[188:191], v[204:207]
ds_read_b64_tr_b16 a[150:151], v246 offset:8896
v_mfma_f32_16x16x32_bf16 v[204:207], a[128:131], a[184:187], v[204:207]
s_waitcnt lgkmcnt(4)
v_mfma_f32_16x16x32_bf16 v[220:223], a[136:139], a[184:187], v[220:223]
ds_read_b64_tr_b16 a[152:153], v246 offset:224
v_mfma_f32_16x16x32_bf16 v[220:223], a[140:143], a[188:191], v[220:223]
v_mfma_f32_16x16x32_bf16 v[216:219], a[140:143], a[180:183], v[216:219]
ds_read_b64_tr_b16 a[154:155], v246 offset:480
v_mfma_f32_16x16x32_bf16 v[216:219], a[136:139], a[176:179], v[216:219]
v_mfma_f32_16x16x32_bf16 v[212:215], a[136:139], a[168:171], v[212:215]
ds_read_b64_tr_b16 a[156:157], v246 offset:8672
v_mfma_f32_16x16x32_bf16 v[212:215], a[140:143], a[172:175], v[212:215]
v_mfma_f32_16x16x32_bf16 v[208:211], a[140:143], a[164:167], v[208:211]
ds_read_b64_tr_b16 a[158:159], v246 offset:8928
v_mfma_f32_16x16x32_bf16 v[208:211], a[136:139], a[160:163], v[208:211]
s_waitcnt lgkmcnt(4)
v_mfma_f32_16x16x32_bf16 v[192:195], a[144:147], a[192:195], v[192:195]
buffer_load_dword v252, v233, s[44:47], s59 offen offset:512 sc1
v_mfma_f32_16x16x32_bf16 v[192:195], a[148:151], a[196:199], v[192:195]
v_mfma_f32_16x16x32_bf16 v[196:199], a[148:151], a[204:207], v[196:199]
v_mfma_f32_16x16x32_bf16 v[196:199], a[144:147], a[200:203], v[196:199]
v_mfma_f32_16x16x32_bf16 v[200:203], a[144:147], a[208:211], v[200:203]
v_mfma_f32_16x16x32_bf16 v[200:203], a[148:151], a[212:215], v[200:203]
v_mfma_f32_16x16x32_bf16 v[204:207], a[148:151], a[220:223], v[204:207]
v_mfma_f32_16x16x32_bf16 v[204:207], a[144:147], a[216:219], v[204:207]
s_waitcnt lgkmcnt(0)
v_mfma_f32_16x16x32_bf16 v[220:223], a[152:155], a[216:219], v[220:223]
v_mfma_f32_16x16x32_bf16 v[220:223], a[156:159], a[220:223], v[220:223]
v_mfma_f32_16x16x32_bf16 v[216:219], a[156:159], a[212:215], v[216:219]
v_mfma_f32_16x16x32_bf16 v[216:219], a[152:155], a[208:211], v[216:219]
v_mfma_f32_16x16x32_bf16 v[212:215], a[152:155], a[200:203], v[212:215]
v_mfma_f32_16x16x32_bf16 v[212:215], a[156:159], a[204:207], v[212:215]
v_mfma_f32_16x16x32_bf16 v[208:211], a[156:159], a[196:199], v[208:211]
v_mfma_f32_16x16x32_bf16 v[208:211], a[152:155], a[192:195], v[208:211]
s_cmp_lg_u32 s99, 0
s_cbranch_scc1 L_f_fin
v_cvt_pk_bf16_f32 v204, v204, v205
v_cvt_pk_bf16_f32 v205, v206, v207
v_cvt_pk_bf16_f32 v206, v220, v221
v_cvt_pk_bf16_f32 v207, v222, v223
buffer_store_dwordx4 v[204:207], v227, s[24:27], s96 offen sc1
v_cvt_pk_bf16_f32 v200, v200, v201
v_cvt_pk_bf16_f32 v201, v202, v203
v_cvt_pk_bf16_f32 v202, v216, v217
v_cvt_pk_bf16_f32 v203, v218, v219
buffer_store_dwordx4 v[200:203], v226, s[24:27], s96 offen sc1
v_cvt_pk_bf16_f32 v196, v196, v197
v_cvt_pk_bf16_f32 v197, v198, v199
v_cvt_pk_bf16_f32 v198, v212, v213
v_cvt_pk_bf16_f32 v199, v214, v215
buffer_store_dwordx4 v[196:199], v225, s[24:27], s96 offen sc1
v_cvt_pk_bf16_f32 v192, v192, v193
v_cvt_pk_bf16_f32 v193, v194, v195
v_cvt_pk_bf16_f32 v194, v208, v209
v_cvt_pk_bf16_f32 v195, v210, v211
buffer_store_dwordx4 v[192:195], v224, s[24:27], s96 offen sc1
s_add_u32 s96, s96, 16384
L_f_r:
v_mov_b32 v212, v24
v_mov_b32 v210, 0x3f80
v_mov_b32 v211, 0x3f800000
v_lshrrev_b32 v16, 4, v230
v_mov_b32 v19, v230
v_lshlrev_b32 v44, 16, v0
v_and_b32 v45, 0xffff0000, v0
v_lshlrev_b32 v46, 16, v1
v_and_b32 v47, 0xffff0000, v1
v_lshlrev_b32 v48, 16, v2
v_and_b32 v49, 0xffff0000, v2
v_lshlrev_b32 v50, 16, v3
v_and_b32 v51, 0xffff0000, v3
v_lshlrev_b32 v52, 16, v4
v_and_b32 v53, 0xffff0000, v4
v_lshlrev_b32 v54, 16, v5
v_and_b32 v55, 0xffff0000, v5
v_lshlrev_b32 v56, 16, v6
v_and_b32 v57, 0xffff0000, v6
v_lshlrev_b32 v58, 16, v7
v_and_b32 v59, 0xffff0000, v7
v_lshlrev_b32 v60, 16, v8
v_and_b32 v61, 0xffff0000, v8
v_lshlrev_b32 v62, 16, v9
v_and_b32 v63, 0xffff0000, v9
v_lshlrev_b32 v64, 16, v10
v_and_b32 v65, 0xffff0000, v10
v_lshlrev_b32 v66, 16, v11
v_and_b32 v67, 0xffff0000, v11
v_lshlrev_b32 v68, 16, v12
v_and_b32 v69, 0xffff0000, v12
v_lshlrev_b32 v70, 16, v13
v_and_b32 v71, 0xffff0000, v13
v_lshlrev_b32 v72, 16, v14
v_and_b32 v73, 0xffff0000, v14
v_lshlrev_b32 v74, 16, v15
v_and_b32 v75, 0xffff0000, v15
v_and_b32 v17, 7, v16
v_mul_u32_u24 v208, 2064, v17
v_lshrrev_b32 v17, 5, v16
v_lshl_add_u32 v208, v17, 8, v208
v_bfe_u32 v17, v16, 3, 2
v_lshl_add_u32 v208, v17, 3, v208
s_lshl_b32 s30, s29, 9
s_add_u32 s30, s30, 36352
v_add_u32 v208, s30, v208
s_mul_i32 s30, s29, 4128
s_add_u32 s30, s30, 36352
v_add_u32 v209, s30, v230
s_add_u32 s16, s6, 10485760
s_addc_u32 s17, s7, 0
s_and_b32 s17, s17, 0xffff
s_mov_b32 s18, 4227072
s_mov_b32 s19, 0x20000
s_mul_i32 s34, s2, 16512
s_lshl_b32 s30, s29, 12
s_add_u32 s34, s34, s30
s_add_u32 s12, s6, 0
s_addc_u32 s13, s7, 0
s_and_b32 s13, s13, 0xffff
s_mov_b32 s14, 4227072
s_mov_b32 s15, 0x20000
v_and_b32 v22, 31, v16
v_cvt_f32_u32 v22, v22
v_mul_f32 v22, 0x3d000000, v22
v_lshrrev_b32 v23, 5, v16
v_cvt_f32_u32 v23, v23
v_mul_f32 v23, 4.0, v23
v_mul_f32 v23, v23, v22
v_cos_f32 v100, v23
v_sin_f32 v116, v23
v_fmamk_f32 v21, v22, 0x3f800000, v23
v_cos_f32 v101, v21
v_sin_f32 v117, v21
v_fmamk_f32 v20, v22, 0x40000000, v23
v_cos_f32 v102, v20
v_sin_f32 v118, v20
v_fmamk_f32 v21, v22, 0x40400000, v23
v_cos_f32 v103, v21
v_sin_f32 v119, v21
v_fmamk_f32 v20, v22, 0x41000000, v23
v_cos_f32 v104, v20
v_sin_f32 v120, v20
v_fmamk_f32 v21, v22, 0x41100000, v23
v_cos_f32 v105, v21
v_sin_f32 v121, v21
v_fmamk_f32 v20, v22, 0x41200000, v23
v_cos_f32 v106, v20
v_sin_f32 v122, v20
v_fmamk_f32 v21, v22, 0x41300000, v23
v_cos_f32 v107, v21
v_sin_f32 v123, v21
v_fmamk_f32 v20, v22, 0x41800000, v23
v_cos_f32 v108, v20
v_sin_f32 v124, v20
v_fmamk_f32 v21, v22, 0x41880000, v23
v_cos_f32 v109, v21
v_sin_f32 v125, v21
v_fmamk_f32 v20, v22, 0x41900000, v23
v_cos_f32 v110, v20
v_sin_f32 v126, v20
v_fmamk_f32 v21, v22, 0x41980000, v23
v_cos_f32 v111, v21
v_sin_f32 v127, v21
v_fmamk_f32 v20, v22, 0x41c00000, v23
v_cos_f32 v112, v20
v_sin_f32 v128, v20
v_fmamk_f32 v21, v22, 0x41c80000, v23
v_cos_f32 v113, v21
v_sin_f32 v129, v21
v_fmamk_f32 v20, v22, 0x41d00000, v23
v_cos_f32 v114, v20
v_sin_f32 v130, v20
v_fmamk_f32 v21, v22, 0x41d80000, v23
v_cos_f32 v115, v21
v_sin_f32 v131, v21
v_cvt_pk_bf16_f32 v76, v100, v101
v_cvt_pk_bf16_f32 v84, v116, v117
v_cvt_pk_bf16_f32 v92, -v116, -v117
v_cvt_pk_bf16_f32 v77, v102, v103
v_cvt_pk_bf16_f32 v85, v118, v119
v_cvt_pk_bf16_f32 v93, -v118, -v119
v_cvt_pk_bf16_f32 v78, v104, v105
v_cvt_pk_bf16_f32 v86, v120, v121
v_cvt_pk_bf16_f32 v94, -v120, -v121
v_cvt_pk_bf16_f32 v79, v106, v107
v_cvt_pk_bf16_f32 v87, v122, v123
v_cvt_pk_bf16_f32 v95, -v122, -v123
v_cvt_pk_bf16_f32 v80, v108, v109
v_cvt_pk_bf16_f32 v88, v124, v125
v_cvt_pk_bf16_f32 v96, -v124, -v125
v_cvt_pk_bf16_f32 v81, v110, v111
v_cvt_pk_bf16_f32 v89, v126, v127
v_cvt_pk_bf16_f32 v97, -v126, -v127
v_cvt_pk_bf16_f32 v82, v112, v113
v_cvt_pk_bf16_f32 v90, v128, v129
v_cvt_pk_bf16_f32 v98, -v128, -v129
v_cvt_pk_bf16_f32 v83, v114, v115
v_cvt_pk_bf16_f32 v91, v130, v131
v_cvt_pk_bf16_f32 v99, -v130, -v131
v_mul_f32 v22, 0x3d000000, v22
v_mul_f32 v23, 0x3d000000, v23
v_cos_f32 v100, v23
v_sin_f32 v116, v23
v_fmamk_f32 v21, v22, 0x3f800000, v23
v_cos_f32 v101, v21
v_sin_f32 v117, v21
v_fmamk_f32 v20, v22, 0x40000000, v23
v_cos_f32 v102, v20
v_sin_f32 v118, v20
v_fmamk_f32 v21, v22, 0x40400000, v23
v_cos_f32 v103, v21
v_sin_f32 v119, v21
v_fmamk_f32 v20, v22, 0x41000000, v23
v_cos_f32 v104, v20
v_sin_f32 v120, v20
v_fmamk_f32 v21, v22, 0x41100000, v23
buffer_load_dword v252, v229, s[44:47], s101 offen offset:512 sc1
v_cos_f32 v105, v21
v_sin_f32 v121, v21
v_fmamk_f32 v20, v22, 0x41200000, v23
v_cos_f32 v106, v20
v_sin_f32 v122, v20
v_fmamk_f32 v21, v22, 0x41300000, v23
v_cos_f32 v107, v21
v_sin_f32 v123, v21
v_fmamk_f32 v20, v22, 0x41800000, v23
v_cos_f32 v108, v20
v_sin_f32 v124, v20
v_fmamk_f32 v21, v22, 0x41880000, v23
v_cos_f32 v109, v21
v_sin_f32 v125, v21
v_fmamk_f32 v20, v22, 0x41900000, v23
v_cos_f32 v110, v20
v_sin_f32 v126, v20
v_fmamk_f32 v21, v22, 0x41980000, v23
v_cos_f32 v111, v21
v_sin_f32 v127, v21
v_fmamk_f32 v20, v22, 0x41c00000, v23
v_cos_f32 v112, v20
v_sin_f32 v128, v20
v_fmamk_f32 v21, v22, 0x41c80000, v23
v_cos_f32 v113, v21
v_sin_f32 v129, v21
v_fmamk_f32 v20, v22, 0x41d00000, v23
v_cos_f32 v114, v20
v_sin_f32 v130, v20
v_fmamk_f32 v21, v22, 0x41d80000, v23
v_cos_f32 v115, v21
v_sin_f32 v131, v21
s_lshr_b32 s30, s29, 1
s_and_b32 s31, s29, 1
s_lshl_b32 s32, s30, 13
s_lshl_b32 s33, s31, 11
s_add_u32 s32, s32, s33
v_add_u32 v132, s32, v19
v_lshrrev_b32 v17, 5, v16
v_bfe_u32 v18, v16, 2, 2
v_lshl_add_u32 v18, v17, 2, v18
v_lshlrev_b32 v133, 6, v18
v_bfe_u32 v18, v16, 4, 1
v_lshl_add_u32 v133, v18, 5, v133
v_and_b32 v18, 3, v16
v_lshl_add_u32 v133, v18, 3, v133
s_lshl_b32 s32, s29, 12
v_add_u32 v133, s32, v133
s_mul_i32 s32, s30, 9984
s_mul_i32 s33, s31, 4896
s_add_u32 s32, s32, s33
s_add_u32 s32, s32, 16384
v_and_b32 v18, 31, v16
v_mul_u32_u24 v134, 144, v18
v_lshrrev_b32 v18, 3, v18
v_lshl_add_u32 v134, v18, 6, v134
v_lshl_add_u32 v134, v17, 4, v134
v_add_u32 v134, s32, v134
s_lshl_b32 s32, s29, 4
v_lshrrev_b32 v17, 2, v16
v_add_u32 v17, s32, v17
v_mul_u32_u24 v135, 16512, v17
v_and_b32 v18, 3, v16
v_lshl_add_u32 v135, v18, 4, v135
v_bfe_u32 v18, v16, 1, 1
v_lshl_add_u32 v17, v18, 8, v17
v_and_b32 v18, 1, v16
v_mul_u32_u24 v18, 4896, v18
v_add_u32 v18, 16384, v18
v_mov_b32 v24, 512
v_cmp_eq_u32 vcc, 0, v17
v_sub_u32 v25, 1024, v17
s_nop 0
v_cndmask_b32 v26, v17, v24, vcc
v_lshrrev_b32 v20, 5, v26
v_lshl_add_u32 v20, v20, 2, v26
v_lshrrev_b32 v21, 8, v26
v_lshl_add_u32 v20, v21, 4, v20
v_lshl_add_u32 v136, v20, 2, v18
v_cndmask_b32 v26, v25, v24, vcc
v_lshrrev_b32 v20, 5, v26
v_lshl_add_u32 v20, v20, 2, v26
v_lshrrev_b32 v21, 8, v26
v_lshl_add_u32 v20, v21, 4, v20
v_lshl_add_u32 v140, v20, 2, v18
v_add_u32 v26, 64, v17
v_lshrrev_b32 v20, 5, v26
v_lshl_add_u32 v20, v20, 2, v26
v_lshrrev_b32 v21, 8, v26
v_lshl_add_u32 v20, v21, 4, v20
v_lshl_add_u32 v137, v20, 2, v18
v_subrev_u32 v26, 64, v25
v_lshrrev_b32 v20, 5, v26
v_lshl_add_u32 v20, v20, 2, v26
v_lshrrev_b32 v21, 8, v26
v_lshl_add_u32 v20, v21, 4, v20
v_lshl_add_u32 v141, v20, 2, v18
v_add_u32 v138, 288, v137
v_subrev_u32 v142, 288, v141
v_add_u32 v139, 576, v137
v_subrev_u32 v143, 576, v141
s_lshl_b32 s36, s95, 6
s_add_u32 s37, s36, 1056768
s_add_u32 s38, s36, 2113536
s_add_u32 s39, s36, 3170304
s_waitcnt vmcnt(1)
L_f_e1:
buffer_store_dword v254, v250, s[44:47], s49 offen offset:640 sc1
s_waitcnt vmcnt(1)
v_cmp_ne_u32 vcc, v254, v252
s_nop 4
s_cbranch_vccz L_f_pok0
s_mov_b32 s51, 0x40000
L_f_ps0:
buffer_load_dword v252, v229, s[44:47], s101 offen offset:512 sc1
s_sub_u32 s51, s51, 1
s_cmp_eq_u32 s51, 0
s_waitcnt vmcnt(0)
s_cbranch_scc1 L_f_ps0_out
v_cmp_ne_u32 vcc, v254, v252
s_nop 4
s_cbranch_vccnz L_f_ps0
L_f_ps0_out:
L_f_pok0:
s_add_u32 s53, s100, 0
buffer_load_dwordx4 v[144:147], v230, s[24:27], s53 offen sc1
s_add_u32 s53, s100, 4096
buffer_load_dwordx4 v[148:151], v230, s[24:27], s53 offen sc1
s_add_u32 s53, s100, 8192
buffer_load_dwordx4 v[152:155], v230, s[24:27], s53 offen sc1
s_add_u32 s53, s100, 12288
buffer_load_dwordx4 v[156:159], v230, s[24:27], s53 offen sc1
s_add_u32 s53, s100, 16384
buffer_load_dwordx4 v[160:163], v230, s[24:27], s53 offen sc1
s_add_u32 s53, s100, 20480
buffer_load_dwordx4 v[164:167], v230, s[24:27], s53 offen sc1
s_add_u32 s53, s100, 24576
buffer_load_dwordx4 v[168:171], v230, s[24:27], s53 offen sc1
s_add_u32 s53, s100, 28672
buffer_load_dwordx4 v[172:175], v230, s[24:27], s53 offen sc1
L_f_e2:
s_waitcnt vmcnt(4)
buffer_load_dword v252, v229, s[44:47], s101 offen offset:640 sc1
s_barrier
s_waitcnt vmcnt(0)
v_cmp_ne_u32 vcc, v254, v252
s_nop 4
s_cbranch_vccz L_f_pok1
s_mov_b32 s51, 0x40000
L_f_ps1:
buffer_load_dword v252, v229, s[44:47], s101 offen offset:640 sc1
s_sub_u32 s51, s51, 1
s_cmp_eq_u32 s51, 0
s_waitcnt vmcnt(0)
s_cbranch_scc1 L_f_ps1_out
v_cmp_ne_u32 vcc, v254, v252
s_nop 4
s_cbranch_vccnz L_f_ps1
L_f_ps1_out:
L_f_pok1:
s_add_u32 s53, s100, 32768
buffer_load_dwordx4 v[176:179], v230, s[24:27], s53 offen sc1
s_add_u32 s53, s100, 36864
buffer_load_dwordx4 v[180:183], v230, s[24:27], s53 offen sc1
s_add_u32 s53, s100, 40960
buffer_load_dwordx4 v[184:187], v230, s[24:27], s53 offen sc1
s_add_u32 s53, s100, 45056
buffer_load_dwordx4 v[188:191], v230, s[24:27], s53 offen sc1
s_add_u32 s53, s100, 49152
buffer_load_dwordx4 v[192:195], v230, s[24:27], s53 offen sc1
s_add_u32 s53, s100, 53248
buffer_load_dwordx4 v[196:199], v230, s[24:27], s53 offen sc1
s_add_u32 s53, s100, 57344
buffer_load_dwordx4 v[200:203], v230, s[24:27], s53 offen sc1
s_add_u32 s53, s100, 61440
buffer_load_dwordx4 v[204:207], v230, s[24:27], s53 offen sc1
v_dot2_f32_bf16 v28, v144, v210, 0
v_dot2_f32_bf16 v29, v144, v211, 0
v_dot2_f32_bf16 v30, v145, v210, 0
v_dot2_f32_bf16 v31, v145, v211, 0
v_dot2_f32_bf16 v32, v146, v210, 0
v_dot2_f32_bf16 v33, v146, v211, 0
v_dot2_f32_bf16 v34, v147, v210, 0
v_dot2_f32_bf16 v35, v147, v211, 0
v_dot2_f32_bf16 v28, v148, v210, v28
v_dot2_f32_bf16 v29, v148, v211, v29
v_dot2_f32_bf16 v30, v149, v210, v30
v_dot2_f32_bf16 v31, v149, v211, v31
v_dot2_f32_bf16 v32, v150, v210, v32
v_dot2_f32_bf16 v33, v150, v211, v33
v_dot2_f32_bf16 v34, v151, v210, v34
v_dot2_f32_bf16 v35, v151, v211, v35
v_dot2_f32_bf16 v28, v152, v210, v28
v_dot2_f32_bf16 v29, v152, v211, v29
v_dot2_f32_bf16 v30, v153, v210, v30
v_dot2_f32_bf16 v31, v153, v211, v31
v_dot2_f32_bf16 v32, v154, v210, v32
v_dot2_f32_bf16 v33, v154, v211, v33
v_dot2_f32_bf16 v34, v155, v210, v34
v_dot2_f32_bf16 v35, v155, v211, v35
v_dot2_f32_bf16 v28, v156, v210, v28
v_dot2_f32_bf16 v29, v156, v211, v29
v_dot2_f32_bf16 v30, v157, v210, v30
v_dot2_f32_bf16 v31, v157, v211, v31
v_dot2_f32_bf16 v32, v158, v210, v32
v_dot2_f32_bf16 v33, v158, v211, v33
v_dot2_f32_bf16 v34, v159, v210, v34
v_dot2_f32_bf16 v35, v159, v211, v35
s_nop 1
v_pk_fma_f32 v[44:45], v[28:29], v[212:213], v[44:45] op_sel_hi:[1,0,1]
v_pk_fma_f32 v[46:47], v[30:31], v[212:213], v[46:47] op_sel_hi:[1,0,1]
v_pk_fma_f32 v[48:49], v[32:33], v[212:213], v[48:49] op_sel_hi:[1,0,1]
v_pk_fma_f32 v[50:51], v[34:35], v[212:213], v[50:51] op_sel_hi:[1,0,1]
v_cvt_pk_bf16_f32 v0, v44, v45
v_cvt_pk_bf16_f32 v1, v46, v47
v_cvt_pk_bf16_f32 v2, v48, v49
v_cvt_pk_bf16_f32 v3, v50, v51
ds_write2_b64 v208, v[0:1], v[2:3] offset0:0 offset1:4
v_dot2_f32_bf16 v28, v160, v210, 0
v_dot2_f32_bf16 v29, v160, v211, 0
v_dot2_f32_bf16 v30, v161, v210, 0
v_dot2_f32_bf16 v31, v161, v211, 0
v_dot2_f32_bf16 v32, v162, v210, 0
v_dot2_f32_bf16 v33, v162, v211, 0
v_dot2_f32_bf16 v34, v163, v210, 0
v_dot2_f32_bf16 v35, v163, v211, 0
v_dot2_f32_bf16 v28, v164, v210, v28
v_dot2_f32_bf16 v29, v164, v211, v29
v_dot2_f32_bf16 v30, v165, v210, v30
v_dot2_f32_bf16 v31, v165, v211, v31
v_dot2_f32_bf16 v32, v166, v210, v32
v_dot2_f32_bf16 v33, v166, v211, v33
v_dot2_f32_bf16 v34, v167, v210, v34
v_dot2_f32_bf16 v35, v167, v211, v35
v_dot2_f32_bf16 v28, v168, v210, v28
v_dot2_f32_bf16 v29, v168, v211, v29
v_dot2_f32_bf16 v30, v169, v210, v30
v_dot2_f32_bf16 v31, v169, v211, v31
v_dot2_f32_bf16 v32, v170, v210, v32
v_dot2_f32_bf16 v33, v170, v211, v33
v_dot2_f32_bf16 v34, v171, v210, v34
v_dot2_f32_bf16 v35, v171, v211, v35
v_dot2_f32_bf16 v28, v172, v210, v28
v_dot2_f32_bf16 v29, v172, v211, v29
v_dot2_f32_bf16 v30, v173, v210, v30
v_dot2_f32_bf16 v31, v173, v211, v31
v_dot2_f32_bf16 v32, v174, v210, v32
v_dot2_f32_bf16 v33, v174, v211, v33
v_dot2_f32_bf16 v34, v175, v210, v34
v_dot2_f32_bf16 v35, v175, v211, v35
s_nop 1
v_pk_fma_f32 v[52:53], v[28:29], v[212:213], v[52:53] op_sel_hi:[1,0,1]
v_pk_fma_f32 v[54:55], v[30:31], v[212:213], v[54:55] op_sel_hi:[1,0,1]
v_pk_fma_f32 v[56:57], v[32:33], v[212:213], v[56:57] op_sel_hi:[1,0,1]
v_pk_fma_f32 v[58:59], v[34:35], v[212:213], v[58:59] op_sel_hi:[1,0,1]
v_cvt_pk_bf16_f32 v4, v52, v53
v_cvt_pk_bf16_f32 v5, v54, v55
v_cvt_pk_bf16_f32 v6, v56, v57
v_cvt_pk_bf16_f32 v7, v58, v59
ds_write2_b64 v208, v[4:5], v[6:7] offset0:8 offset1:12
s_waitcnt vmcnt(7)
v_dot2_f32_bf16 v28, v176, v210, 0
v_dot2_f32_bf16 v29, v176, v211, 0
v_dot2_f32_bf16 v30, v177, v210, 0
v_dot2_f32_bf16 v31, v177, v211, 0
v_dot2_f32_bf16 v32, v178, v210, 0
v_dot2_f32_bf16 v33, v178, v211, 0
v_dot2_f32_bf16 v34, v179, v210, 0
v_dot2_f32_bf16 v35, v179, v211, 0
s_waitcnt vmcnt(6)
v_dot2_f32_bf16 v28, v180, v210, v28
v_dot2_f32_bf16 v29, v180, v211, v29
v_dot2_f32_bf16 v30, v181, v210, v30
v_dot2_f32_bf16 v31, v181, v211, v31
v_dot2_f32_bf16 v32, v182, v210, v32
v_dot2_f32_bf16 v33, v182, v211, v33
v_dot2_f32_bf16 v34, v183, v210, v34
v_dot2_f32_bf16 v35, v183, v211, v35
s_waitcnt vmcnt(5)
v_dot2_f32_bf16 v28, v184, v210, v28
v_dot2_f32_bf16 v29, v184, v211, v29
v_dot2_f32_bf16 v30, v185, v210, v30
v_dot2_f32_bf16 v31, v185, v211, v31
v_dot2_f32_bf16 v32, v186, v210, v32
v_dot2_f32_bf16 v33, v186, v211, v33
v_dot2_f32_bf16 v34, v187, v210, v34
v_dot2_f32_bf16 v35, v187, v211, v35
s_waitcnt vmcnt(4)
v_dot2_f32_bf16 v28, v188, v210, v28
v_dot2_f32_bf16 v29, v188, v211, v29
v_dot2_f32_bf16 v30, v189, v210, v30
v_dot2_f32_bf16 v31, v189, v211, v31
v_dot2_f32_bf16 v32, v190, v210, v32
v_dot2_f32_bf16 v33, v190, v211, v33
v_dot2_f32_bf16 v34, v191, v210, v34
v_dot2_f32_bf16 v35, v191, v211, v35
s_nop 1
v_pk_fma_f32 v[60:61], v[28:29], v[212:213], v[60:61] op_sel_hi:[1,0,1]
v_pk_fma_f32 v[62:63], v[30:31], v[212:213], v[62:63] op_sel_hi:[1,0,1]
v_pk_fma_f32 v[64:65], v[32:33], v[212:213], v[64:65] op_sel_hi:[1,0,1]
v_pk_fma_f32 v[66:67], v[34:35], v[212:213], v[66:67] op_sel_hi:[1,0,1]
v_cvt_pk_bf16_f32 v8, v60, v61
v_cvt_pk_bf16_f32 v9, v62, v63
v_cvt_pk_bf16_f32 v10, v64, v65
v_cvt_pk_bf16_f32 v11, v66, v67
ds_write2_b64 v208, v[8:9], v[10:11] offset0:16 offset1:20
s_waitcnt vmcnt(3)
v_dot2_f32_bf16 v28, v192, v210, 0
v_dot2_f32_bf16 v29, v192, v211, 0
v_dot2_f32_bf16 v30, v193, v210, 0
v_dot2_f32_bf16 v31, v193, v211, 0
v_dot2_f32_bf16 v32, v194, v210, 0
v_dot2_f32_bf16 v33, v194, v211, 0
v_dot2_f32_bf16 v34, v195, v210, 0
v_dot2_f32_bf16 v35, v195, v211, 0
s_waitcnt vmcnt(2)
v_dot2_f32_bf16 v28, v196, v210, v28
v_dot2_f32_bf16 v29, v196, v211, v29
v_dot2_f32_bf16 v30, v197, v210, v30
v_dot2_f32_bf16 v31, v197, v211, v31
v_dot2_f32_bf16 v32, v198, v210, v32
v_dot2_f32_bf16 v33, v198, v211, v33
v_dot2_f32_bf16 v34, v199, v210, v34
v_dot2_f32_bf16 v35, v199, v211, v35
s_waitcnt vmcnt(1)
v_dot2_f32_bf16 v28, v200, v210, v28
v_dot2_f32_bf16 v29, v200, v211, v29
v_dot2_f32_bf16 v30, v201, v210, v30
v_dot2_f32_bf16 v31, v201, v211, v31
v_dot2_f32_bf16 v32, v202, v210, v32
v_dot2_f32_bf16 v33, v202, v211, v33
v_dot2_f32_bf16 v34, v203, v210, v34
v_dot2_f32_bf16 v35, v203, v211, v35
s_waitcnt vmcnt(0)
v_dot2_f32_bf16 v28, v204, v210, v28
v_dot2_f32_bf16 v29, v204, v211, v29
v_dot2_f32_bf16 v30, v205, v210, v30
v_dot2_f32_bf16 v31, v205, v211, v31
v_dot2_f32_bf16 v32, v206, v210, v32
v_dot2_f32_bf16 v33, v206, v211, v33
v_dot2_f32_bf16 v34, v207, v210, v34
v_dot2_f32_bf16 v35, v207, v211, v35
s_nop 1
v_pk_fma_f32 v[68:69], v[28:29], v[212:213], v[68:69] op_sel_hi:[1,0,1]
v_pk_fma_f32 v[70:71], v[30:31], v[212:213], v[70:71] op_sel_hi:[1,0,1]
v_pk_fma_f32 v[72:73], v[32:33], v[212:213], v[72:73] op_sel_hi:[1,0,1]
v_pk_fma_f32 v[74:75], v[34:35], v[212:213], v[74:75] op_sel_hi:[1,0,1]
v_cvt_pk_bf16_f32 v12, v68, v69
v_cvt_pk_bf16_f32 v13, v70, v71
v_cvt_pk_bf16_f32 v14, v72, v73
v_cvt_pk_bf16_f32 v15, v74, v75
ds_write2_b64 v208, v[12:13], v[14:15] offset0:24 offset1:28
s_waitcnt lgkmcnt(0)
s_barrier
ds_read_b128 v[28:31], v209 offset:0
ds_read_b128 v[32:35], v209 offset:1024
ds_read_b128 v[36:39], v209 offset:2064
ds_read_b128 v[40:43], v209 offset:3088
buffer_load_dwordx4 a[64:67], v230, s[16:19], s34 offen offset:0
buffer_load_dwordx4 a[68:71], v230, s[16:19], s34 offen offset:1024
buffer_load_dwordx4 a[72:75], v230, s[16:19], s34 offen offset:2048
buffer_load_dwordx4 a[76:79], v230, s[16:19], s34 offen offset:3072
v_mov_b32 v24, 0x3f803f80
s_waitcnt lgkmcnt(2)
v_dot2_f32_bf16 v20, v28, v24, 0
v_dot2_f32_bf16 v21, v28, v28, 0
v_dot2_f32_bf16 v20, v29, v24, v20
v_dot2_f32_bf16 v21, v29, v29, v21
v_dot2_f32_bf16 v20, v30, v24, v20
v_dot2_f32_bf16 v21, v30, v30, v21
v_dot2_f32_bf16 v20, v31, v24, v20
v_dot2_f32_bf16 v21, v31, v31, v21
v_dot2_f32_bf16 v20, v32, v24, v20
v_dot2_f32_bf16 v21, v32, v32, v21
v_dot2_f32_bf16 v20, v33, v24, v20
v_dot2_f32_bf16 v21, v33, v33, v21
v_dot2_f32_bf16 v20, v34, v24, v20
v_dot2_f32_bf16 v21, v34, v34, v21
v_dot2_f32_bf16 v20, v35, v24, v20
v_dot2_f32_bf16 v21, v35, v35, v21
s_waitcnt lgkmcnt(0)
v_dot2_f32_bf16 v22, v36, v24, 0
v_dot2_f32_bf16 v23, v36, v36, 0
v_dot2_f32_bf16 v22, v37, v24, v22
v_dot2_f32_bf16 v23, v37, v37, v23
v_dot2_f32_bf16 v22, v38, v24, v22
v_dot2_f32_bf16 v23, v38, v38, v23
v_dot2_f32_bf16 v22, v39, v24, v22
v_dot2_f32_bf16 v23, v39, v39, v23
v_dot2_f32_bf16 v22, v40, v24, v22
v_dot2_f32_bf16 v23, v40, v40, v23
v_dot2_f32_bf16 v22, v41, v24, v22
v_dot2_f32_bf16 v23, v41, v41, v23
v_dot2_f32_bf16 v22, v42, v24, v22
v_dot2_f32_bf16 v23, v42, v42, v23
v_dot2_f32_bf16 v22, v43, v24, v22
v_dot2_f32_bf16 v23, v43, v43, v23
v_lshlrev_b32 v44, 16, v28
v_and_b32 v45, 0xffff0000, v28
v_lshlrev_b32 v46, 16, v29
v_permlane32_swap_b32 v20, v21
v_permlane32_swap_b32 v22, v23
v_add_f32 v20, v20, v21
v_and_b32 v47, 0xffff0000, v29
v_lshlrev_b32 v48, 16, v30
v_add_f32 v22, v22, v23
v_and_b32 v49, 0xffff0000, v30
v_lshlrev_b32 v50, 16, v31
v_permlane16_swap_b32 v20, v22
v_add_f32 v20, v20, v22
v_and_b32 v51, 0xffff0000, v31
v_lshlrev_b32 v52, 16, v32
v_add_f32_dpp v20, v20, v20 row_ror:8 row_mask:0xf bank_mask:0xf
v_and_b32 v53, 0xffff0000, v32
v_lshlrev_b32 v54, 16, v33
v_add_f32_dpp v20, v20, v20 row_ror:4 row_mask:0xf bank_mask:0xf
v_and_b32 v55, 0xffff0000, v33
v_lshlrev_b32 v56, 16, v34
v_add_f32_dpp v20, v20, v20 row_ror:2 row_mask:0xf bank_mask:0xf
v_and_b32 v57, 0xffff0000, v34
v_lshlrev_b32 v58, 16, v35
v_add_f32_dpp v20, v20, v20 row_ror:1 row_mask:0xf bank_mask:0xf
v_and_b32 v59, 0xffff0000, v35
v_lshlrev_b32 v60, 16, v36
v_readlane_b32 s40, v20, 0
v_readlane_b32 s41, v20, 32
v_readlane_b32 s42, v20, 16
v_readlane_b32 s43, v20, 48
v_and_b32 v61, 0xffff0000, v36
v_lshlrev_b32 v62, 16, v37
v_and_b32 v63, 0xffff0000, v37
v_lshlrev_b32 v64, 16, v38
v_and_b32 v65, 0xffff0000, v38
v_lshlrev_b32 v66, 16, v39
v_and_b32 v67, 0xffff0000, v39
v_lshlrev_b32 v68, 16, v40
v_and_b32 v69, 0xffff0000, v40
v_lshlrev_b32 v70, 16, v41
v_and_b32 v71, 0xffff0000, v41
v_lshlrev_b32 v72, 16, v42
v_and_b32 v73, 0xffff0000, v42
v_lshlrev_b32 v74, 16, v43
v_and_b32 v75, 0xffff0000, v43
v_mov_b32 v20, s40
v_mov_b32 v24, s42
v_mov_b32 v22, s41
v_mov_b32 v26, s43
v_mul_f32 v20, 0x3a800000, v20
v_mul_f32 v24, 0x3a800000, v24
v_mul_f32 v22, 0x3a800000, v22
v_mul_f32 v26, 0x3a800000, v26
v_fma_f32 v22, -v20, v20, v22
v_fma_f32 v26, -v24, v24, v26
v_max_f32 v22, 0, v22
v_max_f32 v26, 0, v26
v_add_f32 v22, 0x3727c5ac, v22
v_add_f32 v26, 0x3727c5ac, v26
v_rsq_f32 v22, v22
v_rsq_f32 v26, v26
v_mul_f32 v20, v20, v22
v_mul_f32 v24, v24, v26
v_sub_f32 v20, 0, v20
v_sub_f32 v24, 0, v24
v_pk_fma_f32 v[44:45], v[44:45], v[22:23], v[20:21] op_sel_hi:[1,0,0]
v_pk_fma_f32 v[60:61], v[60:61], v[26:27], v[24:25] op_sel_hi:[1,0,0]
v_pk_add_f32 v[160:161], v[44:45], v[60:61]
v_pk_add_f32 v[162:163], v[44:45], v[60:61] neg_lo:[0,1] neg_hi:[0,1]
v_cvt_pk_bf16_f32 v144, v160, v161
v_cvt_pk_bf16_f32 v152, v162, v163
v_pk_fma_f32 v[46:47], v[46:47], v[22:23], v[20:21] op_sel_hi:[1,0,0]
v_pk_fma_f32 v[62:63], v[62:63], v[26:27], v[24:25] op_sel_hi:[1,0,0]
v_pk_add_f32 v[164:165], v[46:47], v[62:63]
v_pk_add_f32 v[166:167], v[46:47], v[62:63] neg_lo:[0,1] neg_hi:[0,1]
v_cvt_pk_bf16_f32 v145, v164, v165
v_cvt_pk_bf16_f32 v153, v166, v167
v_pk_fma_f32 v[48:49], v[48:49], v[22:23], v[20:21] op_sel_hi:[1,0,0]
v_pk_fma_f32 v[64:65], v[64:65], v[26:27], v[24:25] op_sel_hi:[1,0,0]
v_pk_add_f32 v[160:161], v[48:49], v[64:65]
v_pk_add_f32 v[162:163], v[48:49], v[64:65] neg_lo:[0,1] neg_hi:[0,1]
v_cvt_pk_bf16_f32 v146, v160, v161
v_cvt_pk_bf16_f32 v154, v162, v163
v_pk_fma_f32 v[50:51], v[50:51], v[22:23], v[20:21] op_sel_hi:[1,0,0]
v_pk_fma_f32 v[66:67], v[66:67], v[26:27], v[24:25] op_sel_hi:[1,0,0]
v_pk_add_f32 v[164:165], v[50:51], v[66:67]
v_pk_add_f32 v[166:167], v[50:51], v[66:67] neg_lo:[0,1] neg_hi:[0,1]
v_cvt_pk_bf16_f32 v147, v164, v165
v_cvt_pk_bf16_f32 v155, v166, v167
ds_write_b128 v132, v[144:147]
ds_write_b128 v132, v[152:155] offset:4096
v_pk_fma_f32 v[52:53], v[52:53], v[22:23], v[20:21] op_sel_hi:[1,0,0]
v_pk_fma_f32 v[68:69], v[68:69], v[26:27], v[24:25] op_sel_hi:[1,0,0]
v_pk_add_f32 v[160:161], v[52:53], v[68:69]
v_pk_add_f32 v[162:163], v[52:53], v[68:69] neg_lo:[0,1] neg_hi:[0,1]
v_cvt_pk_bf16_f32 v148, v160, v161
v_cvt_pk_bf16_f32 v156, v162, v163
v_pk_fma_f32 v[54:55], v[54:55], v[22:23], v[20:21] op_sel_hi:[1,0,0]
v_pk_fma_f32 v[70:71], v[70:71], v[26:27], v[24:25] op_sel_hi:[1,0,0]
v_pk_add_f32 v[164:165], v[54:55], v[70:71]
v_pk_add_f32 v[166:167], v[54:55], v[70:71] neg_lo:[0,1] neg_hi:[0,1]
v_cvt_pk_bf16_f32 v149, v164, v165
v_cvt_pk_bf16_f32 v157, v166, v167
v_pk_fma_f32 v[56:57], v[56:57], v[22:23], v[20:21] op_sel_hi:[1,0,0]
v_pk_fma_f32 v[72:73], v[72:73], v[26:27], v[24:25] op_sel_hi:[1,0,0]
v_pk_add_f32 v[160:161], v[56:57], v[72:73]
v_pk_add_f32 v[162:163], v[56:57], v[72:73] neg_lo:[0,1] neg_hi:[0,1]
v_cvt_pk_bf16_f32 v150, v160, v161
v_cvt_pk_bf16_f32 v158, v162, v163
v_pk_fma_f32 v[58:59], v[58:59], v[22:23], v[20:21] op_sel_hi:[1,0,0]
v_pk_fma_f32 v[74:75], v[74:75], v[26:27], v[24:25] op_sel_hi:[1,0,0]
v_pk_add_f32 v[164:165], v[58:59], v[74:75]
v_pk_add_f32 v[166:167], v[58:59], v[74:75] neg_lo:[0,1] neg_hi:[0,1]
v_cvt_pk_bf16_f32 v151, v164, v165
v_cvt_pk_bf16_f32 v159, v166, v167
ds_write_b128 v132, v[148:151] offset:1024
ds_write_b128 v132, v[156:159] offset:5120
s_waitcnt lgkmcnt(0)
s_barrier
ds_read_b64_tr_b16 v[144:145], v133 offset:0
ds_read_b64_tr_b16 v[146:147], v133 offset:512
ds_read_b64_tr_b16 v[152:153], v133 offset:2048
ds_read_b64_tr_b16 v[154:155], v133 offset:2560
ds_read_b64_tr_b16 v[148:149], v133 offset:1024
ds_read_b64_tr_b16 v[150:151], v133 offset:1536
ds_read_b64_tr_b16 v[156:157], v133 offset:3072
ds_read_b64_tr_b16 v[158:159], v133 offset:3584
s_waitcnt lgkmcnt(4)
v_mfma_f32_32x32x16_bf16 v[160:175], v[144:147], v[76:79], 0
v_mfma_f32_32x32x16_bf16 v[176:191], v[152:155], v[76:79], 0
v_mfma_f32_32x32x16_bf16 v[160:175], v[152:155], v[84:87], v[160:175]
v_mfma_f32_32x32x16_bf16 v[176:191], v[144:147], v[92:95], v[176:191]
s_waitcnt lgkmcnt(0)
v_mfma_f32_32x32x16_bf16 v[160:175], v[148:151], v[80:83], v[160:175]
v_mfma_f32_32x32x16_bf16 v[176:191], v[156:159], v[80:83], v[176:191]
v_mfma_f32_32x32x16_bf16 v[160:175], v[156:159], v[88:91], v[160:175]
v_mfma_f32_32x32x16_bf16 v[176:191], v[148:151], v[96:99], v[176:191]
s_nop 10
v_pk_mul_f32 v[20:21], v[160:161], v[100:101]
v_pk_mul_f32 v[22:23], v[176:177], v[100:101]
v_pk_fma_f32 v[20:21], v[176:177], v[116:117], v[20:21]
v_pk_fma_f32 v[22:23], v[160:161], v[116:117], v[22:23] neg_lo:[0,1,0] neg_hi:[0,1,0]
v_cvt_pk_bf16_f32 v144, v20, v21
v_cvt_pk_bf16_f32 v152, v22, v23
v_pk_mul_f32 v[24:25], v[162:163], v[102:103]
v_pk_mul_f32 v[26:27], v[178:179], v[102:103]
v_pk_fma_f32 v[24:25], v[178:179], v[118:119], v[24:25]
v_pk_fma_f32 v[26:27], v[162:163], v[118:119], v[26:27] neg_lo:[0,1,0] neg_hi:[0,1,0]
v_cvt_pk_bf16_f32 v145, v24, v25
v_cvt_pk_bf16_f32 v153, v26, v27
v_pk_mul_f32 v[20:21], v[164:165], v[104:105]
v_pk_mul_f32 v[22:23], v[180:181], v[104:105]
v_pk_fma_f32 v[20:21], v[180:181], v[120:121], v[20:21]
v_pk_fma_f32 v[22:23], v[164:165], v[120:121], v[22:23] neg_lo:[0,1,0] neg_hi:[0,1,0]
v_cvt_pk_bf16_f32 v146, v20, v21
v_cvt_pk_bf16_f32 v154, v22, v23
v_pk_mul_f32 v[24:25], v[166:167], v[106:107]
v_pk_mul_f32 v[26:27], v[182:183], v[106:107]
v_pk_fma_f32 v[24:25], v[182:183], v[122:123], v[24:25]
v_pk_fma_f32 v[26:27], v[166:167], v[122:123], v[26:27] neg_lo:[0,1,0] neg_hi:[0,1,0]
v_cvt_pk_bf16_f32 v147, v24, v25
v_cvt_pk_bf16_f32 v155, v26, v27
v_mul_f32 v20, v168, v108
v_mul_f32 v22, v184, v108
v_mfma_f32_32x32x16_bf16 v[44:59], v[144:147], v[76:79], 0
v_mul_f32 v21, v169, v109
v_mul_f32 v23, v185, v109
v_fmac_f32 v20, v184, v124
v_fma_f32 v22, -v168, v124, v22
v_fmac_f32 v21, v185, v125
v_fma_f32 v23, -v169, v125, v23
v_cvt_pk_bf16_f32 v148, v20, v21
v_cvt_pk_bf16_f32 v156, v22, v23
v_mul_f32 v24, v170, v110
v_mul_f32 v26, v186, v110
v_mfma_f32_32x32x16_bf16 v[60:75], v[152:155], v[76:79], 0
v_mul_f32 v25, v171, v111
v_mul_f32 v27, v187, v111
v_fmac_f32 v24, v186, v126
v_fma_f32 v26, -v170, v126, v26
v_fmac_f32 v25, v187, v127
v_fma_f32 v27, -v171, v127, v27
v_cvt_pk_bf16_f32 v149, v24, v25
v_cvt_pk_bf16_f32 v157, v26, v27
v_mul_f32 v20, v172, v112
v_mul_f32 v22, v188, v112
v_mfma_f32_32x32x16_bf16 v[44:59], v[152:155], v[84:87], v[44:59]
v_mul_f32 v21, v173, v113
v_mul_f32 v23, v189, v113
v_fmac_f32 v20, v188, v128
v_fma_f32 v22, -v172, v128, v22
v_fmac_f32 v21, v189, v129
v_fma_f32 v23, -v173, v129, v23
v_cvt_pk_bf16_f32 v150, v20, v21
v_cvt_pk_bf16_f32 v158, v22, v23
v_mul_f32 v24, v174, v114
v_mul_f32 v26, v190, v114
v_mfma_f32_32x32x16_bf16 v[60:75], v[144:147], v[92:95], v[60:75]
v_mul_f32 v25, v175, v115
v_mul_f32 v27, v191, v115
v_fmac_f32 v24, v190, v130
v_fma_f32 v26, -v174, v130, v26
v_fmac_f32 v25, v191, v131
v_fma_f32 v27, -v175, v131, v27
v_cvt_pk_bf16_f32 v151, v24, v25
v_cvt_pk_bf16_f32 v159, v26, v27
s_nop 0
v_mfma_f32_32x32x16_bf16 v[44:59], v[148:151], v[80:83], v[44:59]
v_mfma_f32_32x32x16_bf16 v[60:75], v[156:159], v[80:83], v[60:75]
v_mfma_f32_32x32x16_bf16 v[44:59], v[156:159], v[88:91], v[44:59]
v_mfma_f32_32x32x16_bf16 v[60:75], v[148:151], v[96:99], v[60:75]
s_nop 11
v_cvt_pk_bf16_f32 v28, v44, v60
v_cvt_pk_bf16_f32 v29, v45, v61
v_cvt_pk_bf16_f32 v30, v46, v62
v_cvt_pk_bf16_f32 v31, v47, v63
ds_write_b128 v134, v[28:31] offset:0
v_cvt_pk_bf16_f32 v32, v48, v64
v_cvt_pk_bf16_f32 v33, v49, v65
v_cvt_pk_bf16_f32 v34, v50, v66
v_cvt_pk_bf16_f32 v35, v51, v67
ds_write_b128 v134, v[32:35] offset:32
v_cvt_pk_bf16_f32 v36, v52, v68
v_cvt_pk_bf16_f32 v37, v53, v69
v_cvt_pk_bf16_f32 v38, v54, v70
v_cvt_pk_bf16_f32 v39, v55, v71
ds_write_b128 v134, v[36:39] offset:64
v_cvt_pk_bf16_f32 v40, v56, v72
v_cvt_pk_bf16_f32 v41, v57, v73
v_cvt_pk_bf16_f32 v42, v58, v74
v_cvt_pk_bf16_f32 v43, v59, v75
ds_write_b128 v134, v[40:43] offset:96
s_waitcnt lgkmcnt(0)
s_barrier
ds_read2st64_b32 v[28:29], v136 offset0:0 offset1:39
ds_read2st64_b32 v[30:31], v140 offset0:0 offset1:39
ds_read2st64_b32 v[32:33], v137 offset0:0 offset1:39
ds_read2st64_b32 v[34:35], v141 offset0:0 offset1:39
ds_read2st64_b32 v[36:37], v138 offset0:0 offset1:39
ds_read2st64_b32 v[38:39], v142 offset0:0 offset1:39
ds_read2st64_b32 v[40:41], v139 offset0:0 offset1:39
ds_read2st64_b32 v[42:43], v143 offset0:0 offset1:39
s_waitcnt lgkmcnt(6)
v_bfi_b32 v28, 1, 1, v28
buffer_store_dwordx4 v[28:31], v135, s[12:15], s36 offen sc1
s_waitcnt lgkmcnt(4)
v_bfi_b32 v32, 1, 1, v32
buffer_store_dwordx4 v[32:35], v135, s[12:15], s37 offen sc1
s_waitcnt lgkmcnt(2)
v_bfi_b32 v36, 1, 1, v36
buffer_store_dwordx4 v[36:39], v135, s[12:15], s38 offen sc1
s_waitcnt lgkmcnt(0)
v_bfi_b32 v40, 1, 1, v40
buffer_store_dwordx4 v[40:43], v135, s[12:15], s39 offen sc1
s_mov_b32 s99, 1
s_mov_b32 s58, 0
s_lshl_b32 s53, s29, 6
v_add_u32 v0, s53, v16
s_branch L_f_top
L_f_fin:
s_load_dwordx2 s[54:55], s[0:1], 56
s_waitcnt vmcnt(1)
buffer_store_dword v254, v250, s[44:47], s49 offen offset:640 sc1
s_lshr_b32 s30, s48, 3
s_lshl_b32 s53, s30, 12
s_sub_u32 s31, s31, s53
s_sub_u32 s31, s31, 49152
s_waitcnt vmcnt(1)
v_cmp_ne_u32 vcc, v254, v252
s_nop 1
s_mov_b32 s34, vcc_hi
s_cmp_eq_u32 vcc_lo, 0
s_cbranch_scc1 L_f_qok0
s_mov_b32 s51, 0x40000
L_f_qs0:
buffer_load_dword v252, v232, s[44:47], s59 offen offset:512 sc1
s_sub_u32 s51, s51, 1
s_cmp_eq_u32 s51, 0
s_waitcnt vmcnt(0)
s_cbranch_scc1 L_f_qs0_out
v_cmp_ne_u32 vcc, v254, v252
s_nop 4
s_cbranch_vccnz L_f_qs0
L_f_qs0_out:
L_f_qok0:
s_xor_b32 s53, s30, 3
s_lshl_b32 s53, s53, 12
s_add_u32 s53, s53, s31
buffer_load_dwordx4 v[96:99], v224, s[24:27], s53 offen sc1
buffer_load_dwordx4 v[100:103], v225, s[24:27], s53 offen sc1
buffer_load_dwordx4 v[104:107], v226, s[24:27], s53 offen sc1
buffer_load_dwordx4 v[108:111], v227, s[24:27], s53 offen sc1
s_xor_b32 s53, s30, 2
s_lshl_b32 s53, s53, 12
s_add_u32 s53, s53, s31
s_add_u32 s53, s53, 16384
buffer_load_dwordx4 v[112:115], v224, s[24:27], s53 offen sc1
buffer_load_dwordx4 v[116:119], v225, s[24:27], s53 offen sc1
buffer_load_dwordx4 v[120:123], v226, s[24:27], s53 offen sc1
buffer_load_dwordx4 v[124:127], v227, s[24:27], s53 offen sc1
s_cmp_lg_u32 s34, 0
s_cbranch_scc1 L_f_q2
s_xor_b32 s53, s30, 1
s_lshl_b32 s53, s53, 12
s_add_u32 s53, s53, s31
s_add_u32 s53, s53, 32768
buffer_load_dwordx4 v[128:131], v224, s[24:27], s53 offen sc1
buffer_load_dwordx4 v[132:135], v225, s[24:27], s53 offen sc1
buffer_load_dwordx4 v[136:139], v226, s[24:27], s53 offen sc1
buffer_load_dwordx4 v[140:143], v227, s[24:27], s53 offen sc1
L_f_q2:
s_xor_b32 s53, s30, 1
s_mul_i32 s53, s53, 32768
v_mov_b32 v232, s53
v_mov_b32 v88, 0x3f80
v_mov_b32 v89, 0x3f800000
v_lshlrev_b32 v56, 16, v32
v_and_b32 v57, 0xffff0000, v32
v_lshlrev_b32 v58, 16, v33
v_and_b32 v59, 0xffff0000, v33
v_lshlrev_b32 v60, 16, v34
v_and_b32 v61, 0xffff0000, v34
v_lshlrev_b32 v62, 16, v35
v_and_b32 v63, 0xffff0000, v35
v_lshlrev_b32 v64, 16, v36
v_and_b32 v65, 0xffff0000, v36
v_lshlrev_b32 v66, 16, v37
v_and_b32 v67, 0xffff0000, v37
v_lshlrev_b32 v68, 16, v38
v_and_b32 v69, 0xffff0000, v38
v_lshlrev_b32 v70, 16, v39
v_and_b32 v71, 0xffff0000, v39
v_lshlrev_b32 v72, 16, v40
v_and_b32 v73, 0xffff0000, v40
v_lshlrev_b32 v74, 16, v41
v_and_b32 v75, 0xffff0000, v41
v_lshlrev_b32 v76, 16, v42
v_and_b32 v77, 0xffff0000, v42
v_lshlrev_b32 v78, 16, v43
v_and_b32 v79, 0xffff0000, v43
v_lshlrev_b32 v80, 16, v44
v_and_b32 v81, 0xffff0000, v44
v_lshlrev_b32 v82, 16, v45
v_and_b32 v83, 0xffff0000, v45
v_lshlrev_b32 v84, 16, v46
v_and_b32 v85, 0xffff0000, v46
v_lshlrev_b32 v86, 16, v47
v_and_b32 v87, 0xffff0000, v47
v_lshrrev_b32 v90, 4, v230
v_mov_b32 v52, 0
v_bfe_u32 v91, v90, 0, 1
v_lshl_add_u32 v52, v91, 21, v52
v_bfe_u32 v91, v90, 1, 1
v_lshl_add_u32 v52, v91, 20, v52
v_bfe_u32 v91, v90, 2, 1
v_lshl_add_u32 v52, v91, 16, v52
v_bfe_u32 v91, v90, 3, 1
v_lshl_add_u32 v52, v91, 11, v52
v_bfe_u32 v91, v90, 4, 1
v_lshl_add_u32 v52, v91, 5, v52
v_bfe_u32 v91, v90, 5, 1
v_lshl_add_u32 v52, v91, 4, v52
v_add_u32 v53, 4096, v52
v_add_u32 v54, 8192, v52
v_add_u32 v55, 12288, v52
s_lshl_b32 s40, s94, 3
s_add_u32 s40, s40, s29
s_lshl_b32 s40, s40, 14
s_and_b32 s53, s48, 7
s_lshl_b32 s53, s53, 2
s_add_u32 s53, s53, s30
s_lshl_b32 s53, s53, 6
s_add_u32 s40, s40, s53
s_waitcnt lgkmcnt(0)
s_mov_b32 s20, s54
s_and_b32 s21, s55, 0xffff
s_mov_b32 s22, 4194304
s_mov_b32 s23, 0x20000
s_cmp_eq_u32 s34, 0
s_cbranch_scc1 L_f_q3
s_waitcnt vmcnt(7)
buffer_load_dword v252, v232, s[44:47], s59 offen offset:640 sc1
s_waitcnt vmcnt(0)
v_cmp_ne_u32 vcc, v254, v252
s_nop 4
s_cbranch_vccz L_f_qok1
s_mov_b32 s51, 0x40000
L_f_qs1:
buffer_load_dword v252, v232, s[44:47], s59 offen offset:640 sc1
s_sub_u32 s51, s51, 1
s_cmp_eq_u32 s51, 0
s_waitcnt vmcnt(0)
s_cbranch_scc1 L_f_qs1_out
v_cmp_ne_u32 vcc, v254, v252
s_nop 4
s_cbranch_vccnz L_f_qs1
L_f_qs1_out:
L_f_qok1:
s_xor_b32 s53, s30, 1
s_lshl_b32 s53, s53, 12
s_add_u32 s53, s53, s31
s_add_u32 s53, s53, 32768
buffer_load_dwordx4 v[128:131], v224, s[24:27], s53 offen sc1
buffer_load_dwordx4 v[132:135], v225, s[24:27], s53 offen sc1
buffer_load_dwordx4 v[136:139], v226, s[24:27], s53 offen sc1
buffer_load_dwordx4 v[140:143], v227, s[24:27], s53 offen sc1
L_f_q3:
s_waitcnt vmcnt(11)
v_dot2_f32_bf16 v192, v96, v88, v192
v_dot2_f32_bf16 v193, v96, v89, v193
v_dot2_f32_bf16 v194, v97, v88, v194
v_dot2_f32_bf16 v195, v97, v89, v195
v_dot2_f32_bf16 v208, v98, v88, v208
v_dot2_f32_bf16 v209, v98, v89, v209
v_dot2_f32_bf16 v210, v99, v88, v210
v_dot2_f32_bf16 v211, v99, v89, v211
s_waitcnt vmcnt(10)
v_dot2_f32_bf16 v196, v100, v88, v196
v_dot2_f32_bf16 v197, v100, v89, v197
v_dot2_f32_bf16 v198, v101, v88, v198
v_dot2_f32_bf16 v199, v101, v89, v199
v_dot2_f32_bf16 v212, v102, v88, v212
v_dot2_f32_bf16 v213, v102, v89, v213
v_dot2_f32_bf16 v214, v103, v88, v214
v_dot2_f32_bf16 v215, v103, v89, v215
s_waitcnt vmcnt(9)
v_dot2_f32_bf16 v200, v104, v88, v200
v_dot2_f32_bf16 v201, v104, v89, v201
v_dot2_f32_bf16 v202, v105, v88, v202
v_dot2_f32_bf16 v203, v105, v89, v203
v_dot2_f32_bf16 v216, v106, v88, v216
v_dot2_f32_bf16 v217, v106, v89, v217
v_dot2_f32_bf16 v218, v107, v88, v218
v_dot2_f32_bf16 v219, v107, v89, v219
s_waitcnt vmcnt(8)
v_dot2_f32_bf16 v204, v108, v88, v204
v_dot2_f32_bf16 v205, v108, v89, v205
v_dot2_f32_bf16 v206, v109, v88, v206
v_dot2_f32_bf16 v207, v109, v89, v207
v_dot2_f32_bf16 v220, v110, v88, v220
v_dot2_f32_bf16 v221, v110, v89, v221
v_dot2_f32_bf16 v222, v111, v88, v222
v_dot2_f32_bf16 v223, v111, v89, v223
s_waitcnt vmcnt(7)
v_dot2_f32_bf16 v192, v112, v88, v192
v_dot2_f32_bf16 v193, v112, v89, v193
v_dot2_f32_bf16 v194, v113, v88, v194
v_dot2_f32_bf16 v195, v113, v89, v195
v_dot2_f32_bf16 v208, v114, v88, v208
v_dot2_f32_bf16 v209, v114, v89, v209
v_dot2_f32_bf16 v210, v115, v88, v210
v_dot2_f32_bf16 v211, v115, v89, v211
s_waitcnt vmcnt(6)
v_dot2_f32_bf16 v196, v116, v88, v196
v_dot2_f32_bf16 v197, v116, v89, v197
v_dot2_f32_bf16 v198, v117, v88, v198
v_dot2_f32_bf16 v199, v117, v89, v199
v_dot2_f32_bf16 v212, v118, v88, v212
v_dot2_f32_bf16 v213, v118, v89, v213
v_dot2_f32_bf16 v214, v119, v88, v214
v_dot2_f32_bf16 v215, v119, v89, v215
s_waitcnt vmcnt(5)
v_dot2_f32_bf16 v200, v120, v88, v200
v_dot2_f32_bf16 v201, v120, v89, v201
v_dot2_f32_bf16 v202, v121, v88, v202
v_dot2_f32_bf16 v203, v121, v89, v203
v_dot2_f32_bf16 v216, v122, v88, v216
v_dot2_f32_bf16 v217, v122, v89, v217
v_dot2_f32_bf16 v218, v123, v88, v218
v_dot2_f32_bf16 v219, v123, v89, v219
s_waitcnt vmcnt(4)
v_dot2_f32_bf16 v204, v124, v88, v204
v_dot2_f32_bf16 v205, v124, v89, v205
v_dot2_f32_bf16 v206, v125, v88, v206
v_dot2_f32_bf16 v207, v125, v89, v207
v_dot2_f32_bf16 v220, v126, v88, v220
v_dot2_f32_bf16 v221, v126, v89, v221
v_dot2_f32_bf16 v222, v127, v88, v222
v_dot2_f32_bf16 v223, v127, v89, v223
s_waitcnt vmcnt(3)
v_dot2_f32_bf16 v192, v128, v88, v192
v_dot2_f32_bf16 v193, v128, v89, v193
v_dot2_f32_bf16 v194, v129, v88, v194
v_dot2_f32_bf16 v195, v129, v89, v195
v_dot2_f32_bf16 v208, v130, v88, v208
v_dot2_f32_bf16 v209, v130, v89, v209
v_dot2_f32_bf16 v210, v131, v88, v210
v_dot2_f32_bf16 v211, v131, v89, v211
s_nop 1
v_fma_f32 v56, v192, v48, v56
v_fma_f32 v57, v193, v48, v57
v_fma_f32 v58, v194, v48, v58
v_fma_f32 v59, v195, v48, v59
v_fma_f32 v60, v208, v48, v60
v_fma_f32 v61, v209, v48, v61
v_fma_f32 v62, v210, v48, v62
v_fma_f32 v63, v211, v48, v63
v_cvt_pk_bf16_f32 v192, v56, v57
v_cvt_pk_bf16_f32 v193, v58, v59
v_cvt_pk_bf16_f32 v194, v60, v61
v_cvt_pk_bf16_f32 v195, v62, v63
s_nop 0
v_permlane16_swap_b32 v192, v194
v_permlane16_swap_b32 v193, v195
buffer_store_dwordx4 v[192:195], v52, s[20:23], s40 offen sc1
s_waitcnt vmcnt(3)
v_dot2_f32_bf16 v196, v132, v88, v196
v_dot2_f32_bf16 v197, v132, v89, v197
v_dot2_f32_bf16 v198, v133, v88, v198
v_dot2_f32_bf16 v199, v133, v89, v199
v_dot2_f32_bf16 v212, v134, v88, v212
v_dot2_f32_bf16 v213, v134, v89, v213
v_dot2_f32_bf16 v214, v135, v88, v214
v_dot2_f32_bf16 v215, v135, v89, v215
s_nop 1
v_fma_f32 v64, v196, v49, v64
v_fma_f32 v65, v197, v49, v65
v_fma_f32 v66, v198, v49, v66
v_fma_f32 v67, v199, v49, v67
v_fma_f32 v68, v212, v49, v68
v_fma_f32 v69, v213, v49, v69
v_fma_f32 v70, v214, v49, v70
v_fma_f32 v71, v215, v49, v71
v_cvt_pk_bf16_f32 v196, v64, v65
v_cvt_pk_bf16_f32 v197, v66, v67
v_cvt_pk_bf16_f32 v198, v68, v69
v_cvt_pk_bf16_f32 v199, v70, v71
s_nop 0
v_permlane16_swap_b32 v196, v198
v_permlane16_swap_b32 v197, v199
buffer_store_dwordx4 v[196:199], v53, s[20:23], s40 offen sc1
s_waitcnt vmcnt(3)
v_dot2_f32_bf16 v200, v136, v88, v200
v_dot2_f32_bf16 v201, v136, v89, v201
v_dot2_f32_bf16 v202, v137, v88, v202
v_dot2_f32_bf16 v203, v137, v89, v203
v_dot2_f32_bf16 v216, v138, v88, v216
v_dot2_f32_bf16 v217, v138, v89, v217
v_dot2_f32_bf16 v218, v139, v88, v218
v_dot2_f32_bf16 v219, v139, v89, v219
s_nop 1
v_fma_f32 v72, v200, v50, v72
v_fma_f32 v73, v201, v50, v73
v_fma_f32 v74, v202, v50, v74
v_fma_f32 v75, v203, v50, v75
v_fma_f32 v76, v216, v50, v76
v_fma_f32 v77, v217, v50, v77
v_fma_f32 v78, v218, v50, v78
v_fma_f32 v79, v219, v50, v79
v_cvt_pk_bf16_f32 v200, v72, v73
v_cvt_pk_bf16_f32 v201, v74, v75
v_cvt_pk_bf16_f32 v202, v76, v77
v_cvt_pk_bf16_f32 v203, v78, v79
s_nop 0
v_permlane16_swap_b32 v200, v202
v_permlane16_swap_b32 v201, v203
buffer_store_dwordx4 v[200:203], v54, s[20:23], s40 offen sc1
s_waitcnt vmcnt(3)
v_dot2_f32_bf16 v204, v140, v88, v204
v_dot2_f32_bf16 v205, v140, v89, v205
v_dot2_f32_bf16 v206, v141, v88, v206
v_dot2_f32_bf16 v207, v141, v89, v207
v_dot2_f32_bf16 v220, v142, v88, v220
v_dot2_f32_bf16 v221, v142, v89, v221
v_dot2_f32_bf16 v222, v143, v88, v222
v_dot2_f32_bf16 v223, v143, v89, v223
s_nop 1
v_fma_f32 v80, v204, v51, v80
v_fma_f32 v81, v205, v51, v81
v_fma_f32 v82, v206, v51, v82
v_fma_f32 v83, v207, v51, v83
v_fma_f32 v84, v220, v51, v84
v_fma_f32 v85, v221, v51, v85
v_fma_f32 v86, v222, v51, v86
v_fma_f32 v87, v223, v51, v87
v_cvt_pk_bf16_f32 v204, v80, v81
v_cvt_pk_bf16_f32 v205, v82, v83
v_cvt_pk_bf16_f32 v206, v84, v85
v_cvt_pk_bf16_f32 v207, v86, v87
s_nop 0
v_permlane16_swap_b32 v204, v206
v_permlane16_swap_b32 v205, v207
buffer_store_dwordx4 v[204:207], v55, s[20:23], s40 offen sc1
L_f_end:
s_endpgm
L_f_a0c:
s_lshl_b32 s30, s94, 19
s_mov_b32 s51, 0x40000
L_f_a0:
buffer_load_dwordx4 a[0:3], v224, s[8:11], s30 offen offset:0 sc1
buffer_load_dwordx4 a[8:11], v225, s[8:11], s30 offen offset:0 sc1
buffer_load_dwordx4 a[16:19], v226, s[8:11], s30 offen offset:0 sc1
buffer_load_dwordx4 a[24:27], v227, s[8:11], s30 offen offset:0 sc1
buffer_load_dwordx4 a[4:7], v224, s[8:11], s30 offen offset:1024 sc1
buffer_load_dwordx4 a[12:15], v225, s[8:11], s30 offen offset:1024 sc1
buffer_load_dwordx4 a[20:23], v226, s[8:11], s30 offen offset:1024 sc1
buffer_load_dwordx4 a[28:31], v227, s[8:11], s30 offen offset:1024 sc1
s_sub_u32 s51, s51, 1
s_cmp_eq_u32 s51, 0
s_waitcnt vmcnt(0)
s_cbranch_scc1 L_f_a0_out
v_accvgpr_read_b32 v1, a0
v_xor_b32 v1, s99, v1
v_accvgpr_read_b32 v2, a8
v_xor_b32 v2, s99, v2
v_or_b32 v1, v1, v2
v_accvgpr_read_b32 v2, a16
v_xor_b32 v2, s99, v2
v_or_b32 v1, v1, v2
v_accvgpr_read_b32 v2, a24
v_xor_b32 v2, s99, v2
v_or_b32 v1, v1, v2
v_accvgpr_read_b32 v2, a4
v_xor_b32 v2, s99, v2
v_or_b32 v1, v1, v2
v_accvgpr_read_b32 v2, a12
v_xor_b32 v2, s99, v2
v_or_b32 v1, v1, v2
v_accvgpr_read_b32 v2, a20
v_xor_b32 v2, s99, v2
v_or_b32 v1, v1, v2
v_accvgpr_read_b32 v2, a28
v_xor_b32 v2, s99, v2
v_or_b32 v1, v1, v2
v_and_b32 v1, 1, v1
v_cmp_ne_u32 vcc, 0, v1
s_nop 4
s_cbranch_vccnz L_f_a0
L_f_a0_out:
s_branch L_f_a0ok
L_f_slowa:
s_lshl_b32 s30, s94, 19
s_add_u32 s30, s30, 2048
s_mov_b32 s51, 0x40000
L_f_a1:
buffer_load_dwordx4 a[32:35], v224, s[8:11], s30 offen offset:0 sc1
buffer_load_dwordx4 a[40:43], v225, s[8:11], s30 offen offset:0 sc1
buffer_load_dwordx4 a[48:51], v226, s[8:11], s30 offen offset:0 sc1
buffer_load_dwordx4 a[56:59], v227, s[8:11], s30 offen offset:0 sc1
buffer_load_dwordx4 a[36:39], v224, s[8:11], s30 offen offset:1024 sc1
buffer_load_dwordx4 a[44:47], v225, s[8:11], s30 offen offset:1024 sc1
buffer_load_dwordx4 a[52:55], v226, s[8:11], s30 offen offset:1024 sc1
buffer_load_dwordx4 a[60:63], v227, s[8:11], s30 offen offset:1024 sc1
s_sub_u32 s51, s51, 1
s_cmp_eq_u32 s51, 0
s_waitcnt vmcnt(0)
s_cbranch_scc1 L_f_a1_out
v_accvgpr_read_b32 v252, a32
v_xor_b32 v252, s99, v252
v_accvgpr_read_b32 v255, a40
v_xor_b32 v255, s99, v255
v_or_b32 v252, v252, v255
v_accvgpr_read_b32 v255, a48
v_xor_b32 v255, s99, v255
v_or_b32 v252, v252, v255
v_accvgpr_read_b32 v255, a56
v_xor_b32 v255, s99, v255
v_or_b32 v252, v252, v255
v_accvgpr_read_b32 v255, a36
v_xor_b32 v255, s99, v255
v_or_b32 v252, v252, v255
v_accvgpr_read_b32 v255, a44
v_xor_b32 v255, s99, v255
v_or_b32 v252, v252, v255
v_accvgpr_read_b32 v255, a52
v_xor_b32 v255, s99, v255
v_or_b32 v252, v252, v255
v_accvgpr_read_b32 v255, a60
v_xor_b32 v255, s99, v255
v_or_b32 v252, v252, v255
v_and_b32 v252, 1, v252
v_cmp_ne_u32 vcc, 0, v252
s_nop 4
s_cbranch_vccnz L_f_a1
L_f_a1_out:
s_branch L_f_conta
L_f_slowx:
s_mov_b32 s51, 0x40000
L_f_xn:
buffer_load_dword v252, v251, s[44:47], s32 offen offset:896 sc1
s_sub_u32 s51, s51, 1
s_cmp_eq_u32 s51, 0
s_waitcnt vmcnt(0)
s_cbranch_scc1 L_f_xn_out
v_cmp_ne_u32 vcc, v254, v252
s_nop 4
s_cbranch_vccnz L_f_xn
L_f_xn_out:
s_branch L_f_contx
L_f_slowq:
s_mov_b32 s51, 0x40000
L_f_q:
buffer_load_dword v252, v251, s[44:47], s60 offen offset:0 sc1
s_sub_u32 s51, s51, 1
s_cmp_eq_u32 s51, 0
s_waitcnt vmcnt(0)
s_cbranch_scc1 L_f_q_out
v_cmp_ne_u32 vcc, v254, v252
s_nop 4
s_cbranch_vccnz L_f_q
L_f_q_out:
s_branch L_f_contq
L_f_slow0:
s_mov_b32 s51, 0x40000
L_f_spin0:
buffer_load_dword v252, v251, s[44:47], s50 offen offset:0 sc1
s_sub_u32 s51, s51, 1
s_cmp_eq_u32 s51, 0
s_waitcnt vmcnt(0)
s_cbranch_scc1 L_f_spin0_out
v_cmp_ne_u32 vcc, v254, v252
s_nop 4
s_cbranch_vccnz L_f_spin0
L_f_spin0_out:
s_branch L_f_cont0
L_f_slow1:
s_mov_b32 s51, 0x40000
L_f_spin1:
buffer_load_dword v252, v251, s[44:47], s50 offen offset:128 sc1
s_sub_u32 s51, s51, 1
s_cmp_eq_u32 s51, 0
s_waitcnt vmcnt(0)
s_cbranch_scc1 L_f_spin1_out
v_cmp_ne_u32 vcc, v254, v252
s_nop 4
s_cbranch_vccnz L_f_spin1
L_f_spin1_out:
s_branch L_f_cont1
L_f_slow2:
s_mov_b32 s51, 0x40000
L_f_spin2:
buffer_load_dword v252, v251, s[44:47], s50 offen offset:256 sc1
s_sub_u32 s51, s51, 1
s_cmp_eq_u32 s51, 0
s_waitcnt vmcnt(0)
s_cbranch_scc1 L_f_spin2_out
v_cmp_ne_u32 vcc, v254, v252
s_nop 4
s_cbranch_vccnz L_f_spin2
L_f_spin2_out:
L_f_last:
s_branch L_f_cont2
.section .rodata,"a"
.p2align 6
.amdhsa_kernel m_kernel
  .amdhsa_next_free_vgpr 512
  .amdhsa_next_free_sgpr 102
  .amdhsa_accum_offset 256
  .amdhsa_group_segment_fixed_size 0
  .amdhsa_kernarg_size 80
  .amdhsa_user_sgpr_count 2
  .amdhsa_user_sgpr_kernarg_segment_ptr 1
  .amdhsa_system_sgpr_workgroup_id_x 1
  .amdhsa_float_denorm_mode_32 3
.end_amdhsa_kernel
.text
```
